```python
import torch

def _softmax(x, axis=-1):
    return torch.softmax(x, dim=axis)
def _gelu(x):
    return torch.nn.functional.gelu(x, approximate="tanh")
def _silu(x):
    return torch.nn.functional.silu(x)
def _sigmoid(x):
    return torch.sigmoid(x)
def _layernorm(x, axis=-1, eps=1e-5):
    m = x.mean(dim=axis, keepdim=True)
    v = x.var(dim=axis, keepdim=True, unbiased=False)
    return (x - m) / torch.sqrt(v + eps)
def _scatter_add(tgt, idx, src, axis=0):
    return tgt.clone().index_add_(axis, idx, src)
def _segment_sum(src, seg, n):
    out = torch.zeros((n,) + src.shape[1:], dtype=src.dtype)
    return out.index_add_(0, seg, src)
def _pad(x, pw):
    flat = tuple(v for pair in reversed(pw) for v in pair)
    return torch.nn.functional.pad(x, flat)

kernel_name = 'sequential_preLN__sliding_local_dilated__mixer_s_mlp__prompt'

def setup_inputs():

    _w = (lambda a: (lambda t: t.to(torch.bfloat16) if t.is_floating_point() else t)(torch.as_tensor(a)))
    def _A_setup():
        B, S, D = 1, 2048, 512
        return {
            "x": _w((lambda *s: torch.randn(*s, dtype=torch.bfloat16) * 0.05)(B, S, D)),
            "wqkv": _w((lambda *s: torch.randn(*s, dtype=torch.bfloat16) * 0.05)(D, 3 * D)),
            "wo": _w((lambda *s: torch.randn(*s, dtype=torch.bfloat16) * 0.05)(D, D)),
        }
    _A_in = _A_setup()

    def _B_setup():
        B, S, D, F = 1, 2048, 512, 1792
        return {
            "x":  _w((lambda *s: torch.randn(*s, dtype=torch.bfloat16) * 0.05)(B, S, D)),
            "w1": _w((lambda *s: torch.randn(*s, dtype=torch.bfloat16) * 3.2)(D, D) * (D ** -0.5)),
            "w2": _w((lambda *s: torch.randn(*s, dtype=torch.bfloat16) * 3.2)(D, D) * (D ** -0.5)),
            "w3": _w((lambda *s: torch.randn(*s, dtype=torch.bfloat16) * 3.2)(D, F) * (D ** -0.5)),
            "w4": _w((lambda *s: torch.randn(*s, dtype=torch.bfloat16) * 3.2)(F, D) * (F ** -0.5)),
        }
    _B_in = _B_setup()

    return {
        "A_x": _A_in["x"],
        "A_wqkv": _A_in["wqkv"],
        "A_wo": _A_in["wo"],
        "B_x": _B_in["x"],
        "B_w1": _B_in["w1"],
        "B_w2": _B_in["w2"],
        "B_w3": _B_in["w3"],
        "B_w4": _B_in["w4"],
    }

def reference(A_x, A_wqkv, A_wo, B_x, B_w1, B_w2, B_w3, B_w4):
    def _A_ref(x, wqkv, wo):
        B, S, D = x.shape
        H = 32; Dh = D // H
        W, dil = 8, 2
        qkv = (lambda x, *d: x.permute(*d))((x @ wqkv).reshape(B, S, 3, H, Dh), 2, 0, 3, 1, 4)
        q, k, v = qkv[0], qkv[1], qkv[2]
        scale = Dh ** -0.5
        pos = torch.arange(S)
        off = torch.arange(W) * dil
        idx = pos[:, None] - off[None, :]
        mask = idx >= 0
        idx_c = torch.where(mask, idx, 0).reshape(-1)
        kg = k[:, :, idx_c, :].reshape(B, H, S, W, Dh)
        vg = v[:, :, idx_c, :].reshape(B, H, S, W, Dh)
        logits = torch.einsum("bhsd,bhswd->bhsw", q, kg) * scale
        logits = torch.where(mask[None, None, :, :], logits, -1e9)
        attn = _softmax(logits, axis=-1)
        o = torch.einsum("bhsw,bhswd->bhsd", attn, vg)
        return (lambda x, *d: x.permute(*d))(o, 0, 2, 1, 3).reshape(B, S, D) @ wo

    def _B_ref(x, w1, w2, w3, w4):
        B, S, D = x.shape
        h = _gelu(_layernorm(x, axis=-1) @ w1)
        c = D // 4
        g0 = _pad(h[:, :, 0*c:1*c], ((0, 0), (1, 0), (0, 0)))[:, :S, :]
        g1 = _pad(h[:, :, 1*c:2*c], ((0, 0), (0, 1), (0, 0)))[:, 1:, :]
        g2 = _pad(h[:, :, 2*c:3*c], ((0, 0), (2, 0), (0, 0)))[:, :S, :]
        g3 = _pad(h[:, :, 3*c:   ], ((0, 0), (0, 2), (0, 0)))[:, 2:, :]
        hs = torch.concatenate([g0, g1, g2, g3], axis=-1) @ w2
        x1 = x + hs
        h2 = _gelu(_layernorm(x1, axis=-1) @ w3) @ w4
        return x1 + h2

    x = A_x
    h = x + _A_ref(_layernorm(x, axis=-1), A_wqkv, A_wo)
    h2 = h + _B_ref(_layernorm(h, axis=-1), B_w1, B_w2, B_w3, B_w4)
    return h2
```

```asm
; @launch grid=(256,1,1) block=(512,1,1) lds=163840
.amdgcn_target "amdgcn-amd-amdhsa--gfx950"
.text
.globl sequential_preLN__sliding_local_dilated__mixer_s_mlp__prompt_kernel
.p2align 8
.type sequential_preLN__sliding_local_dilated__mixer_s_mlp__prompt_kernel,@function
sequential_preLN__sliding_local_dilated__mixer_s_mlp__prompt_kernel:
    s_cmp_ge_u32 s2, 256
    s_cbranch_scc1 L_end
    s_load_dwordx16 s[4:19], s[0:1], 0
    s_load_dwordx2 s[24:25], s[0:1], 80
    s_load_dwordx4 s[20:23], s[0:1], 64
    v_lshrrev_b32 v8, 6, v0
    v_and_b32 v1, 63, v0
    v_readfirstlane_b32 s28, v8
    s_getpc_b64 s[44:45]
L_pc:
    s_bitcmp1_b32 s2, 4
    s_cbranch_scc1 L_sequential_preLN__sliding_local_dilated__mixer_s_mlp__prompt_kernel_nopf_1
    s_and_b32 s3, s2, 8
    s_add_u32 s3, s3, s28
    s_lshl_b32 s3, s3, 12
    v_lshl_add_u32 v20, v1, 6, s3
    v_min_u32 v20, 0xe480, v20
    v_mov_b32 v21, s45
    v_add_co_u32 v20, vcc, s44, v20
    s_nop 1
    v_addc_co_u32 v21, vcc, 0, v21, vcc
    global_load_dword v22, v[20:21], off
L_sequential_preLN__sliding_local_dilated__mixer_s_mlp__prompt_kernel_nopf_1:
    v_and_b32 v2, 15, v0
    v_bfe_u32 v3, v0, 4, 2
    s_and_b32 s3, s2, 7
    s_lshr_b32 s27, s2, 3
    s_and_b32 s30, s27, 15
    s_and_b32 s32, s27, 7
    s_lshr_b32 s31, s27, 3
    s_lshl_b32 s3, s3, 2
    s_add_u32 s31, s31, s3
    s_lshr_b32 s29, s31, 1
    s_and_b32 s26, s28, 3
    s_cmp_lt_u32 s28, 4
    s_cbranch_scc1 L_compute
    s_cmp_ge_u32 s28, 6
    s_cbranch_scc1 L_aux0
    s_mov_b32 s39, 1
    v_lshrrev_b32 v8, 3, v1
    s_lshl_b32 s33, s26, 2
    v_or_b32 v9, s33, v3
    v_and_b32 v10, 7, v1
    v_xor_b32 v9, v9, v10
    v_lshlrev_b32 v9, 4, v9
    v_lshl_or_b32 v9, v8, 11, v9
    s_lshl_b32 s33, s29, 17
    s_lshl_b32 s34, s26, 14
    s_add_u32 s34, s33, s34
    v_add_u32 v24, s34, v9
    s_lshl_b32 s34, s26, 10
    s_add_u32 s34, s33, s34
    s_sub_u32 s34, s34, 0x4000
    s_cmp_eq_u32 s29, 0
    s_cselect_b32 s34, 0x40000000, s34
    v_add_u32 v25, s34, v9
    s_mul_i32 s52, s26, 98304
    s_lshl_b32 s34, s30, 6
    s_add_u32 s52, s52, s34
    v_add_u32 v8, 0, v1
    v_mul_u32_u24 v9, 5462, v8
    v_lshrrev_b32 v9, 16, v9
    v_mul_u32_u24 v10, 12, v9
    v_sub_u32 v8, v8, v10
    v_lshrrev_b32 v10, 3, v9
    v_lshlrev_b32 v10, 1, v10
    v_xor_b32 v8, v8, v10
    v_lshrrev_b32 v10, 2, v8
    v_and_b32 v8, 3, v8
    v_lshlrev_b32 v8, 4, v8
    v_lshl_or_b32 v8, v10, 10, v8
    v_mul_u32_u24 v9, 3072, v9
    v_add3_u32 v26, v8, v9, s52
    v_add_u32 v8, 64, v1
    v_mul_u32_u24 v9, 5462, v8
    v_lshrrev_b32 v9, 16, v9
    v_mul_u32_u24 v10, 12, v9
    v_sub_u32 v8, v8, v10
    v_lshrrev_b32 v10, 3, v9
    v_lshlrev_b32 v10, 1, v10
    v_xor_b32 v8, v8, v10
    v_lshrrev_b32 v10, 2, v8
    v_and_b32 v8, 3, v8
    v_lshlrev_b32 v8, 4, v8
    v_lshl_or_b32 v8, v10, 10, v8
    v_mul_u32_u24 v9, 3072, v9
    v_add3_u32 v27, v8, v9, s52
    v_add_u32 v8, 128, v1
    v_mul_u32_u24 v9, 5462, v8
    v_lshrrev_b32 v9, 16, v9
    v_mul_u32_u24 v10, 12, v9
    v_sub_u32 v8, v8, v10
    v_lshrrev_b32 v10, 3, v9
    v_lshlrev_b32 v10, 1, v10
    v_xor_b32 v8, v8, v10
    v_lshrrev_b32 v10, 2, v8
    v_and_b32 v8, 3, v8
    v_lshlrev_b32 v8, 4, v8
    v_lshl_or_b32 v8, v10, 10, v8
    v_mul_u32_u24 v9, 3072, v9
    v_add3_u32 v28, v8, v9, s52
    s_lshl_b32 s53, s26, 10
    s_mul_i32 s54, s26, 6144
    s_mul_i32 s55, s26, 14336
    s_and_b32 s56, s29, 1
    s_lshl_b32 s56, s56, 2
    s_add_u32 s56, s56, s30
    s_lshr_b32 s33, s29, 1
    s_add_u32 s56, s56, s33
    v_mov_b32 v4, 0x26c00
    s_lshl_b32 s3, s26, 2
    v_add_u32 v5, s3, v4
    v_mov_b32 v16, 0x3f803f80
    v_mov_b32 v17, 0x3f803f80
    v_mov_b32 v18, 0x3f803f80
    v_mov_b32 v19, 0x3f803f80
    v_mov_b32 v7, 0
    s_mov_b32 s37, 0
    s_mov_b32 s60, 0
    s_waitcnt lgkmcnt(0)
    s_barrier
    s_mov_b32 s64, s4
    s_mov_b32 s65, s5
    s_mov_b32 s66, 0x200000
    s_mov_b32 s67, 0x20000
    s_mov_b32 s68, s6
    s_mov_b32 s69, s7
    s_mov_b32 s70, 0x180000
    s_mov_b32 s71, 0x20000
    s_add_u32 s58, s56, 0
    s_and_b32 s58, s58, 7
    s_mul_i32 s59, s58, 196608
    s_lshl_b32 s58, s58, 7
    s_add_u32 m0, s54, 0x4800
    s_add_u32 s57, s59, 0x0
    buffer_load_dwordx4 v26, s[68:71], s57 offen lds
    s_add_u32 m0, s54, 0x4c00
    s_nop 0
    buffer_load_dwordx4 v27, s[68:71], s57 offen lds
    s_add_u32 m0, s54, 0x5000
    s_nop 0
    buffer_load_dwordx4 v28, s[68:71], s57 offen lds
    s_add_u32 m0, s54, 0x5400
    s_add_u32 s57, s59, 0xc000
    buffer_load_dwordx4 v26, s[68:71], s57 offen lds
    s_add_u32 m0, s54, 0x5800
    s_nop 0
    buffer_load_dwordx4 v27, s[68:71], s57 offen lds
    s_add_u32 m0, s54, 0x5c00
    s_nop 0
    buffer_load_dwordx4 v28, s[68:71], s57 offen lds
    s_add_u32 m0, s53, 0x800
    s_add_u32 s57, s58, 0x0
    buffer_load_dwordx4 v24, s[64:67], s57 offen lds
    s_add_u32 m0, s53, 0x1000
    s_add_u32 s57, s58, 0x400
    buffer_load_dwordx4 v24, s[64:67], s57 offen lds
    s_add_u32 m0, s53, 0x1800
    s_add_u32 s57, s58, 0x8000
    buffer_load_dwordx4 v24, s[64:67], s57 offen lds
    s_add_u32 m0, s53, 0x2000
    s_add_u32 s57, s58, 0x8400
    buffer_load_dwordx4 v24, s[64:67], s57 offen lds
    s_add_u32 m0, s53, 0x2800
    s_add_u32 s57, s58, 0x10000
    buffer_load_dwordx4 v24, s[64:67], s57 offen lds
    s_add_u32 m0, s53, 0x3000
    s_add_u32 s57, s58, 0x10400
    buffer_load_dwordx4 v24, s[64:67], s57 offen lds
    s_add_u32 m0, s53, 0x3800
    s_add_u32 s57, s58, 0x18000
    buffer_load_dwordx4 v24, s[64:67], s57 offen lds
    s_add_u32 m0, s53, 0x4000
    s_add_u32 s57, s58, 0x18400
    buffer_load_dwordx4 v24, s[64:67], s57 offen lds
    s_add_u32 m0, s53, 0x0
    s_mov_b32 s57, s58
    buffer_load_dwordx4 v25, s[64:67], s57 offen lds
    v_mov_b32 v12, 32767
    s_mov_b64 exec, 1
    ds_max_u32 v5, v12 offset:32
    s_mov_b64 exec, -1
    v_mov_b32 v12, 32767
    s_mov_b64 exec, 1
    ds_max_u32 v5, v12 offset:64
    s_mov_b64 exec, -1
    s_mov_b32 s48, s24
    s_mov_b32 s49, s25
    s_mov_b32 s50, 0xfe8000
    s_mov_b32 s51, 0x20000
    v_lshlrev_b32 v36, 4, v1
    s_mov_b32 s23, 0x20000
    s_add_u32 s58, s56, 1
    s_and_b32 s58, s58, 7
    s_mul_i32 s59, s58, 196608
    s_lshl_b32 s58, s58, 7
    s_add_u32 m0, s54, 0xc000
    s_add_u32 s57, s59, 0x0
    buffer_load_dwordx4 v26, s[68:71], s57 offen lds
    s_add_u32 m0, s54, 0xc400
    s_nop 0
    buffer_load_dwordx4 v27, s[68:71], s57 offen lds
    s_add_u32 m0, s54, 0xc800
    s_nop 0
    buffer_load_dwordx4 v28, s[68:71], s57 offen lds
    s_add_u32 m0, s54, 0xcc00
    s_add_u32 s57, s59, 0xc000
    buffer_load_dwordx4 v26, s[68:71], s57 offen lds
    s_add_u32 m0, s54, 0xd000
    s_nop 0
    buffer_load_dwordx4 v27, s[68:71], s57 offen lds
    s_add_u32 m0, s54, 0xd400
    s_nop 0
    buffer_load_dwordx4 v28, s[68:71], s57 offen lds
    s_add_u32 m0, s53, 0x8000
    s_add_u32 s57, s58, 0x0
    buffer_load_dwordx4 v24, s[64:67], s57 offen lds
    s_add_u32 m0, s53, 0x8800
    s_add_u32 s57, s58, 0x400
    buffer_load_dwordx4 v24, s[64:67], s57 offen lds
    s_add_u32 m0, s53, 0x9000
    s_add_u32 s57, s58, 0x8000
    buffer_load_dwordx4 v24, s[64:67], s57 offen lds
    s_add_u32 m0, s53, 0x9800
    s_add_u32 s57, s58, 0x8400
    buffer_load_dwordx4 v24, s[64:67], s57 offen lds
    s_add_u32 m0, s53, 0xa000
    s_add_u32 s57, s58, 0x10000
    buffer_load_dwordx4 v24, s[64:67], s57 offen lds
    s_add_u32 m0, s53, 0xa800
    s_add_u32 s57, s58, 0x10400
    buffer_load_dwordx4 v24, s[64:67], s57 offen lds
    s_add_u32 m0, s53, 0xb000
    s_add_u32 s57, s58, 0x18000
    buffer_load_dwordx4 v24, s[64:67], s57 offen lds
    s_add_u32 m0, s53, 0xb800
    s_add_u32 s57, s58, 0x18400
    buffer_load_dwordx4 v24, s[64:67], s57 offen lds
    s_add_u32 m0, s53, 0x7800
    s_mov_b32 s57, s58
    buffer_load_dwordx4 v25, s[64:67], s57 offen lds
    s_waitcnt vmcnt(15)
    v_mov_b32 v12, 1
    s_mov_b64 exec, 1
    ds_max_u32 v5, v12 offset:0
    s_mov_b64 exec, -1
    s_add_u32 s58, s56, 2
    s_and_b32 s58, s58, 7
    s_mul_i32 s59, s58, 196608
    s_lshl_b32 s58, s58, 7
    s_add_u32 m0, s54, 0x13800
    s_add_u32 s57, s59, 0x0
    buffer_load_dwordx4 v26, s[68:71], s57 offen lds
    s_add_u32 m0, s54, 0x13c00
    s_nop 0
    buffer_load_dwordx4 v27, s[68:71], s57 offen lds
    s_add_u32 m0, s54, 0x14000
    s_nop 0
    buffer_load_dwordx4 v28, s[68:71], s57 offen lds
    s_add_u32 m0, s54, 0x14400
    s_add_u32 s57, s59, 0xc000
    buffer_load_dwordx4 v26, s[68:71], s57 offen lds
    s_add_u32 m0, s54, 0x14800
    s_nop 0
    buffer_load_dwordx4 v27, s[68:71], s57 offen lds
    s_add_u32 m0, s54, 0x14c00
    s_nop 0
    buffer_load_dwordx4 v28, s[68:71], s57 offen lds
    s_add_u32 m0, s53, 0xf800
    s_add_u32 s57, s58, 0x0
    buffer_load_dwordx4 v24, s[64:67], s57 offen lds
    s_add_u32 m0, s53, 0x10000
    s_add_u32 s57, s58, 0x400
    buffer_load_dwordx4 v24, s[64:67], s57 offen lds
    s_add_u32 m0, s53, 0x10800
    s_add_u32 s57, s58, 0x8000
    buffer_load_dwordx4 v24, s[64:67], s57 offen lds
    s_add_u32 m0, s53, 0x11000
    s_add_u32 s57, s58, 0x8400
    buffer_load_dwordx4 v24, s[64:67], s57 offen lds
    s_add_u32 m0, s53, 0x11800
    s_add_u32 s57, s58, 0x10000
    buffer_load_dwordx4 v24, s[64:67], s57 offen lds
    s_add_u32 m0, s53, 0x12000
    s_add_u32 s57, s58, 0x10400
    buffer_load_dwordx4 v24, s[64:67], s57 offen lds
    s_add_u32 m0, s53, 0x12800
    s_add_u32 s57, s58, 0x18000
    buffer_load_dwordx4 v24, s[64:67], s57 offen lds
    s_add_u32 m0, s53, 0x13000
    s_add_u32 s57, s58, 0x18400
    buffer_load_dwordx4 v24, s[64:67], s57 offen lds
    s_add_u32 m0, s53, 0xf000
    s_mov_b32 s57, s58
    buffer_load_dwordx4 v25, s[64:67], s57 offen lds
    s_waitcnt vmcnt(15)
    v_mov_b32 v12, 2
    s_mov_b64 exec, 1
    ds_max_u32 v5, v12 offset:0
    s_mov_b64 exec, -1
    s_add_u32 s58, s56, 3
    s_and_b32 s58, s58, 7
    s_mul_i32 s59, s58, 196608
    s_lshl_b32 s58, s58, 7
    s_add_u32 m0, s54, 0x1b000
    s_add_u32 s57, s59, 0x0
    buffer_load_dwordx4 v26, s[68:71], s57 offen lds
    s_add_u32 m0, s54, 0x1b400
    s_nop 0
    buffer_load_dwordx4 v27, s[68:71], s57 offen lds
    s_add_u32 m0, s54, 0x1b800
    s_nop 0
    buffer_load_dwordx4 v28, s[68:71], s57 offen lds
    s_add_u32 m0, s54, 0x1bc00
    s_add_u32 s57, s59, 0xc000
    buffer_load_dwordx4 v26, s[68:71], s57 offen lds
    s_add_u32 m0, s54, 0x1c000
    s_nop 0
    buffer_load_dwordx4 v27, s[68:71], s57 offen lds
    s_add_u32 m0, s54, 0x1c400
    s_nop 0
    buffer_load_dwordx4 v28, s[68:71], s57 offen lds
    s_add_u32 m0, s53, 0x17000
    s_add_u32 s57, s58, 0x0
    buffer_load_dwordx4 v24, s[64:67], s57 offen lds
    s_add_u32 m0, s53, 0x17800
    s_add_u32 s57, s58, 0x400
    buffer_load_dwordx4 v24, s[64:67], s57 offen lds
    s_add_u32 m0, s53, 0x18000
    s_add_u32 s57, s58, 0x8000
    buffer_load_dwordx4 v24, s[64:67], s57 offen lds
    s_add_u32 m0, s53, 0x18800
    s_add_u32 s57, s58, 0x8400
    buffer_load_dwordx4 v24, s[64:67], s57 offen lds
    s_add_u32 m0, s53, 0x19000
    s_add_u32 s57, s58, 0x10000
    buffer_load_dwordx4 v24, s[64:67], s57 offen lds
    s_add_u32 m0, s53, 0x19800
    s_add_u32 s57, s58, 0x10400
    buffer_load_dwordx4 v24, s[64:67], s57 offen lds
    s_add_u32 m0, s53, 0x1a000
    s_add_u32 s57, s58, 0x18000
    buffer_load_dwordx4 v24, s[64:67], s57 offen lds
    s_add_u32 m0, s53, 0x1a800
    s_add_u32 s57, s58, 0x18400
    buffer_load_dwordx4 v24, s[64:67], s57 offen lds
    s_add_u32 m0, s53, 0x16800
    s_mov_b32 s57, s58
    buffer_load_dwordx4 v25, s[64:67], s57 offen lds
    s_waitcnt vmcnt(15)
    v_mov_b32 v12, 3
    s_mov_b64 exec, 1
    ds_max_u32 v5, v12 offset:0
    s_mov_b64 exec, -1
    s_add_u32 s58, s56, 4
    s_and_b32 s58, s58, 7
    s_mul_i32 s59, s58, 196608
    s_lshl_b32 s58, s58, 7
    s_add_u32 m0, s54, 0x22800
    s_add_u32 s57, s59, 0x0
    buffer_load_dwordx4 v26, s[68:71], s57 offen lds
    s_add_u32 m0, s54, 0x22c00
    s_nop 0
    buffer_load_dwordx4 v27, s[68:71], s57 offen lds
    s_add_u32 m0, s54, 0x23000
    s_nop 0
    buffer_load_dwordx4 v28, s[68:71], s57 offen lds
    s_add_u32 m0, s54, 0x23400
    s_add_u32 s57, s59, 0xc000
    buffer_load_dwordx4 v26, s[68:71], s57 offen lds
    s_add_u32 m0, s54, 0x23800
    s_nop 0
    buffer_load_dwordx4 v27, s[68:71], s57 offen lds
    s_add_u32 m0, s54, 0x23c00
    s_nop 0
    buffer_load_dwordx4 v28, s[68:71], s57 offen lds
    s_add_u32 m0, s53, 0x1e800
    s_add_u32 s57, s58, 0x0
    buffer_load_dwordx4 v24, s[64:67], s57 offen lds
    s_add_u32 m0, s53, 0x1f000
    s_add_u32 s57, s58, 0x400
    buffer_load_dwordx4 v24, s[64:67], s57 offen lds
    s_add_u32 m0, s53, 0x1f800
    s_add_u32 s57, s58, 0x8000
    buffer_load_dwordx4 v24, s[64:67], s57 offen lds
    s_add_u32 m0, s53, 0x20000
    s_add_u32 s57, s58, 0x8400
    buffer_load_dwordx4 v24, s[64:67], s57 offen lds
    s_add_u32 m0, s53, 0x20800
    s_add_u32 s57, s58, 0x10000
    buffer_load_dwordx4 v24, s[64:67], s57 offen lds
    s_add_u32 m0, s53, 0x21000
    s_add_u32 s57, s58, 0x10400
    buffer_load_dwordx4 v24, s[64:67], s57 offen lds
    s_add_u32 m0, s53, 0x21800
    s_add_u32 s57, s58, 0x18000
    buffer_load_dwordx4 v24, s[64:67], s57 offen lds
    s_add_u32 m0, s53, 0x22000
    s_add_u32 s57, s58, 0x18400
    buffer_load_dwordx4 v24, s[64:67], s57 offen lds
    s_add_u32 m0, s53, 0x1e000
    s_mov_b32 s57, s58
    buffer_load_dwordx4 v25, s[64:67], s57 offen lds
    s_waitcnt vmcnt(15)
    v_mov_b32 v12, 4
    s_mov_b64 exec, 1
    ds_max_u32 v5, v12 offset:0
    s_mov_b64 exec, -1
    s_mov_b64 exec, 1
    ds_read_b128 v[8:11], v4 offset:16
    ds_read_b128 v[20:23], v4 offset:32
    s_waitcnt lgkmcnt(0)
    v_min3_u32 v8, v8, v9, v10
    v_min3_u32 v20, v20, v21, v22
    v_min3_u32 v8, v8, v20, v23
    v_min_u32 v8, v8, v11
    s_nop 0
    v_readfirstlane_b32 s60, v8
    s_mov_b64 exec, -1
    s_cmp_ge_u32 s60, 1
    s_cbranch_scc1 L_sequential_preLN__sliding_local_dilated__mixer_s_mlp__prompt_kernel_free_2
    s_waitcnt vmcnt(0)
    v_mov_b32 v12, 5
    s_mov_b64 exec, 1
    ds_max_u32 v5, v12 offset:0
    s_mov_b64 exec, -1
    s_cmp_lt_u32 s60, 1
    s_cbranch_scc1 L_sequential_preLN__sliding_local_dilated__mixer_s_mlp__prompt_kernel_lws_4
L_sequential_preLN__sliding_local_dilated__mixer_s_mlp__prompt_kernel_lwb_3:
L_sequential_preLN__sliding_local_dilated__mixer_s_mlp__prompt_kernel_free_2:
    s_add_u32 s58, s56, 5
    s_and_b32 s58, s58, 7
    s_mul_i32 s59, s58, 196608
    s_lshl_b32 s58, s58, 7
    s_add_u32 m0, s54, 0x4800
    s_add_u32 s57, s59, 0x0
    buffer_load_dwordx4 v26, s[68:71], s57 offen lds
    s_add_u32 m0, s54, 0x4c00
    s_nop 0
    buffer_load_dwordx4 v27, s[68:71], s57 offen lds
    s_add_u32 m0, s54, 0x5000
    s_nop 0
    buffer_load_dwordx4 v28, s[68:71], s57 offen lds
    s_add_u32 m0, s54, 0x5400
    s_add_u32 s57, s59, 0xc000
    buffer_load_dwordx4 v26, s[68:71], s57 offen lds
    s_add_u32 m0, s54, 0x5800
    s_nop 0
    buffer_load_dwordx4 v27, s[68:71], s57 offen lds
    s_add_u32 m0, s54, 0x5c00
    s_nop 0
    buffer_load_dwordx4 v28, s[68:71], s57 offen lds
    s_add_u32 m0, s53, 0x800
    s_add_u32 s57, s58, 0x0
    buffer_load_dwordx4 v24, s[64:67], s57 offen lds
    s_add_u32 m0, s53, 0x1000
    s_add_u32 s57, s58, 0x400
    buffer_load_dwordx4 v24, s[64:67], s57 offen lds
    s_add_u32 m0, s53, 0x1800
    s_add_u32 s57, s58, 0x8000
    buffer_load_dwordx4 v24, s[64:67], s57 offen lds
    s_add_u32 m0, s53, 0x2000
    s_add_u32 s57, s58, 0x8400
    buffer_load_dwordx4 v24, s[64:67], s57 offen lds
    s_add_u32 m0, s53, 0x2800
    s_add_u32 s57, s58, 0x10000
    buffer_load_dwordx4 v24, s[64:67], s57 offen lds
    s_add_u32 m0, s53, 0x3000
    s_add_u32 s57, s58, 0x10400
    buffer_load_dwordx4 v24, s[64:67], s57 offen lds
    s_add_u32 m0, s53, 0x3800
    s_add_u32 s57, s58, 0x18000
    buffer_load_dwordx4 v24, s[64:67], s57 offen lds
    s_add_u32 m0, s53, 0x4000
    s_add_u32 s57, s58, 0x18400
    buffer_load_dwordx4 v24, s[64:67], s57 offen lds
    s_add_u32 m0, s53, 0x0
    s_mov_b32 s57, s58
    buffer_load_dwordx4 v25, s[64:67], s57 offen lds
    s_waitcnt vmcnt(15)
    v_mov_b32 v12, 5
    s_mov_b64 exec, 1
    ds_max_u32 v5, v12 offset:0
    s_mov_b64 exec, -1
    s_mov_b64 exec, 1
    ds_read_b128 v[8:11], v4 offset:16
    ds_read_b128 v[20:23], v4 offset:32
    s_waitcnt lgkmcnt(0)
    v_min3_u32 v8, v8, v9, v10
    v_min3_u32 v20, v20, v21, v22
    v_min3_u32 v8, v8, v20, v23
    v_min_u32 v8, v8, v11
    s_nop 0
    v_readfirstlane_b32 s60, v8
    s_mov_b64 exec, -1
    s_cmp_ge_u32 s60, 2
    s_cbranch_scc1 L_sequential_preLN__sliding_local_dilated__mixer_s_mlp__prompt_kernel_free_5
    s_waitcnt vmcnt(0)
    v_mov_b32 v12, 6
    s_mov_b64 exec, 1
    ds_max_u32 v5, v12 offset:0
    s_mov_b64 exec, -1
    s_cmp_lt_u32 s60, 2
    s_cbranch_scc1 L_sequential_preLN__sliding_local_dilated__mixer_s_mlp__prompt_kernel_lws_7
L_sequential_preLN__sliding_local_dilated__mixer_s_mlp__prompt_kernel_lwb_6:
L_sequential_preLN__sliding_local_dilated__mixer_s_mlp__prompt_kernel_free_5:
    s_add_u32 s58, s56, 6
    s_and_b32 s58, s58, 7
    s_mul_i32 s59, s58, 196608
    s_lshl_b32 s58, s58, 7
    s_add_u32 m0, s54, 0xc000
    s_add_u32 s57, s59, 0x0
    buffer_load_dwordx4 v26, s[68:71], s57 offen lds
    s_add_u32 m0, s54, 0xc400
    s_nop 0
    buffer_load_dwordx4 v27, s[68:71], s57 offen lds
    s_add_u32 m0, s54, 0xc800
    s_nop 0
    buffer_load_dwordx4 v28, s[68:71], s57 offen lds
    s_add_u32 m0, s54, 0xcc00
    s_add_u32 s57, s59, 0xc000
    buffer_load_dwordx4 v26, s[68:71], s57 offen lds
    s_add_u32 m0, s54, 0xd000
    s_nop 0
    buffer_load_dwordx4 v27, s[68:71], s57 offen lds
    s_add_u32 m0, s54, 0xd400
    s_nop 0
    buffer_load_dwordx4 v28, s[68:71], s57 offen lds
    s_add_u32 m0, s53, 0x8000
    s_add_u32 s57, s58, 0x0
    buffer_load_dwordx4 v24, s[64:67], s57 offen lds
    s_add_u32 m0, s53, 0x8800
    s_add_u32 s57, s58, 0x400
    buffer_load_dwordx4 v24, s[64:67], s57 offen lds
    s_add_u32 m0, s53, 0x9000
    s_add_u32 s57, s58, 0x8000
    buffer_load_dwordx4 v24, s[64:67], s57 offen lds
    s_add_u32 m0, s53, 0x9800
    s_add_u32 s57, s58, 0x8400
    buffer_load_dwordx4 v24, s[64:67], s57 offen lds
    s_add_u32 m0, s53, 0xa000
    s_add_u32 s57, s58, 0x10000
    buffer_load_dwordx4 v24, s[64:67], s57 offen lds
    s_add_u32 m0, s53, 0xa800
    s_add_u32 s57, s58, 0x10400
    buffer_load_dwordx4 v24, s[64:67], s57 offen lds
    s_add_u32 m0, s53, 0xb000
    s_add_u32 s57, s58, 0x18000
    buffer_load_dwordx4 v24, s[64:67], s57 offen lds
    s_add_u32 m0, s53, 0xb800
    s_add_u32 s57, s58, 0x18400
    buffer_load_dwordx4 v24, s[64:67], s57 offen lds
    s_add_u32 m0, s53, 0x7800
    s_mov_b32 s57, s58
    buffer_load_dwordx4 v25, s[64:67], s57 offen lds
    s_waitcnt vmcnt(15)
    v_mov_b32 v12, 6
    s_mov_b64 exec, 1
    ds_max_u32 v5, v12 offset:0
    s_mov_b64 exec, -1
    s_mov_b64 exec, 1
    ds_read_b128 v[8:11], v4 offset:16
    ds_read_b128 v[20:23], v4 offset:32
    s_waitcnt lgkmcnt(0)
    v_min3_u32 v8, v8, v9, v10
    v_min3_u32 v20, v20, v21, v22
    v_min3_u32 v8, v8, v20, v23
    v_min_u32 v8, v8, v11
    s_nop 0
    v_readfirstlane_b32 s60, v8
    s_mov_b64 exec, -1
    s_cmp_ge_u32 s60, 3
    s_cbranch_scc1 L_sequential_preLN__sliding_local_dilated__mixer_s_mlp__prompt_kernel_free_8
    s_waitcnt vmcnt(0)
    v_mov_b32 v12, 7
    s_mov_b64 exec, 1
    ds_max_u32 v5, v12 offset:0
    s_mov_b64 exec, -1
    s_cmp_lt_u32 s60, 3
    s_cbranch_scc1 L_sequential_preLN__sliding_local_dilated__mixer_s_mlp__prompt_kernel_lws_10
L_sequential_preLN__sliding_local_dilated__mixer_s_mlp__prompt_kernel_lwb_9:
L_sequential_preLN__sliding_local_dilated__mixer_s_mlp__prompt_kernel_free_8:
    s_add_u32 s58, s56, 7
    s_and_b32 s58, s58, 7
    s_mul_i32 s59, s58, 196608
    s_lshl_b32 s58, s58, 7
    s_add_u32 m0, s54, 0x13800
    s_add_u32 s57, s59, 0x0
    buffer_load_dwordx4 v26, s[68:71], s57 offen lds
    s_add_u32 m0, s54, 0x13c00
    s_nop 0
    buffer_load_dwordx4 v27, s[68:71], s57 offen lds
    s_add_u32 m0, s54, 0x14000
    s_nop 0
    buffer_load_dwordx4 v28, s[68:71], s57 offen lds
    s_add_u32 m0, s54, 0x14400
    s_add_u32 s57, s59, 0xc000
    buffer_load_dwordx4 v26, s[68:71], s57 offen lds
    s_add_u32 m0, s54, 0x14800
    s_nop 0
    buffer_load_dwordx4 v27, s[68:71], s57 offen lds
    s_add_u32 m0, s54, 0x14c00
    s_nop 0
    buffer_load_dwordx4 v28, s[68:71], s57 offen lds
    s_add_u32 m0, s53, 0xf800
    s_add_u32 s57, s58, 0x0
    buffer_load_dwordx4 v24, s[64:67], s57 offen lds
    s_add_u32 m0, s53, 0x10000
    s_add_u32 s57, s58, 0x400
    buffer_load_dwordx4 v24, s[64:67], s57 offen lds
    s_add_u32 m0, s53, 0x10800
    s_add_u32 s57, s58, 0x8000
    buffer_load_dwordx4 v24, s[64:67], s57 offen lds
    s_add_u32 m0, s53, 0x11000
    s_add_u32 s57, s58, 0x8400
    buffer_load_dwordx4 v24, s[64:67], s57 offen lds
    s_add_u32 m0, s53, 0x11800
    s_add_u32 s57, s58, 0x10000
    buffer_load_dwordx4 v24, s[64:67], s57 offen lds
    s_add_u32 m0, s53, 0x12000
    s_add_u32 s57, s58, 0x10400
    buffer_load_dwordx4 v24, s[64:67], s57 offen lds
    s_add_u32 m0, s53, 0x12800
    s_add_u32 s57, s58, 0x18000
    buffer_load_dwordx4 v24, s[64:67], s57 offen lds
    s_add_u32 m0, s53, 0x13000
    s_add_u32 s57, s58, 0x18400
    buffer_load_dwordx4 v24, s[64:67], s57 offen lds
    s_add_u32 m0, s53, 0xf000
    s_mov_b32 s57, s58
    buffer_load_dwordx4 v25, s[64:67], s57 offen lds
    s_waitcnt vmcnt(15)
    v_mov_b32 v12, 7
    s_mov_b64 exec, 1
    ds_max_u32 v5, v12 offset:0
    s_mov_b64 exec, -1
    v_and_b32 v8, 7, v1
    v_lshlrev_b32 v37, 14, v8
    v_add_u32 v37, 0xfd0000, v37
    s_lshl_b32 s33, s32, 14
    s_add_u32 s34, s33, 0xf80000
    v_writelane_b32 v37, s34, 5
    v_writelane_b32 v37, s34, 13
    s_add_u32 s34, s33, 0xfa0000
    v_writelane_b32 v37, s34, 6
    v_writelane_b32 v37, s34, 14
    v_lshrrev_b32 v8, 3, v1
    v_lshl_add_u32 v37, v8, 7, v37
    s_lshl_b32 s33, s31, 9
    s_lshl_b32 s34, s26, 8
    s_add_u32 s33, s33, s34
    s_mov_b64 exec, 0x7f7f
    buffer_load_dword v32, v37, s[48:51], s33 offen
    s_mov_b64 exec, -1
    s_lshl_b32 s33, s2, 1
    s_add_u32 s33, s33, s26
    s_lshl_b32 s33, s33, 10
    s_mov_b32 s20, s8
    s_mov_b32 s21, s9
    s_mov_b32 s22, 0x80000
    buffer_load_dwordx4 v[32:35], v36, s[20:23], s33 offen offset:0
    s_mov_b32 s20, s12
    s_mov_b32 s21, s13
    s_mov_b32 s22, 0x80000
    buffer_load_dwordx4 v[32:35], v36, s[20:23], s33 offen offset:0
    s_mov_b32 s20, s14
    s_mov_b32 s21, s15
    s_mov_b32 s22, 0x80000
    buffer_load_dwordx4 v[32:35], v36, s[20:23], s33 offen offset:0
    s_waitcnt vmcnt(4)
    v_mov_b32 v12, 8
    s_mov_b64 exec, 1
    ds_max_u32 v5, v12 offset:0
    s_mov_b64 exec, -1
    v_lshrrev_b32 v8, 3, v1
    s_lshl_b32 s33, s26, 13
    s_lshl_b32 s34, s32, 7
    s_add_u32 s33, s33, s34
    s_lshl_b32 s34, s26, 1
    v_bfe_u32 v9, v1, 1, 2
    v_bfe_u32 v10, v8, 1, 1
    v_or_b32 v10, s34, v10
    v_xor_b32 v9, v9, v10
    v_lshlrev_b32 v9, 5, v9
    v_and_b32 v10, 1, v1
    v_lshl_or_b32 v9, v10, 4, v9
    v_lshl_or_b32 v9, v8, 10, v9
    v_add_u32 v39, s33, v9
    v_bfe_u32 v9, v1, 1, 2
    v_bfe_u32 v10, v8, 1, 2
    v_xor_b32 v9, v9, v10
    v_lshlrev_b32 v9, 5, v9
    v_and_b32 v10, 1, v1
    v_lshl_or_b32 v9, v10, 4, v9
    v_lshl_or_b32 v9, v8, 10, v9
    v_add_u32 v38, s33, v9
    s_cmp_lt_u32 s60, 4
    s_cbranch_scc1 L_sequential_preLN__sliding_local_dilated__mixer_s_mlp__prompt_kernel_lws_13
L_sequential_preLN__sliding_local_dilated__mixer_s_mlp__prompt_kernel_lwb_12:
L_sequential_preLN__sliding_local_dilated__mixer_s_mlp__prompt_kernel_free_11:
    s_mov_b32 s68, s8
    s_mov_b32 s69, s9
    s_mov_b32 s70, 0x80000
    s_add_u32 m0, s53, 0x16800
    s_mov_b32 s57, 0x0
    buffer_load_dwordx4 v39, s[68:71], s57 offen lds
    s_add_u32 m0, s53, 0x17000
    s_mov_b32 s57, 0x4000
    buffer_load_dwordx4 v39, s[68:71], s57 offen lds
    s_add_u32 m0, s53, 0x17800
    s_mov_b32 s57, 0x8000
    buffer_load_dwordx4 v39, s[68:71], s57 offen lds
    s_add_u32 m0, s53, 0x18000
    s_mov_b32 s57, 0xc000
    buffer_load_dwordx4 v39, s[68:71], s57 offen lds
    s_add_u32 m0, s53, 0x18800
    s_mov_b32 s57, 0x10000
    buffer_load_dwordx4 v39, s[68:71], s57 offen lds
    s_add_u32 m0, s53, 0x19000
    s_mov_b32 s57, 0x14000
    buffer_load_dwordx4 v39, s[68:71], s57 offen lds
    s_add_u32 m0, s53, 0x19800
    s_mov_b32 s57, 0x18000
    buffer_load_dwordx4 v39, s[68:71], s57 offen lds
    s_add_u32 m0, s53, 0x1a000
    s_mov_b32 s57, 0x1c000
    buffer_load_dwordx4 v39, s[68:71], s57 offen lds
    s_mov_b64 exec, 1
    ds_read_b128 v[8:11], v4 offset:16
    ds_read_b128 v[20:23], v4 offset:32
    s_waitcnt lgkmcnt(0)
    v_min3_u32 v8, v8, v9, v10
    v_min3_u32 v20, v20, v21, v22
    v_min3_u32 v8, v8, v20, v23
    v_min_u32 v8, v8, v11
    s_nop 0
    v_readfirstlane_b32 s60, v8
    s_mov_b64 exec, -1
    s_cmp_ge_u32 s60, 5
    s_cbranch_scc1 L_sequential_preLN__sliding_local_dilated__mixer_s_mlp__prompt_kernel_free_14
    s_waitcnt vmcnt(0)
    v_mov_b32 v12, 9
    s_mov_b64 exec, 1
    ds_max_u32 v5, v12 offset:0
    s_mov_b64 exec, -1
    s_cmp_lt_u32 s60, 5
    s_cbranch_scc1 L_sequential_preLN__sliding_local_dilated__mixer_s_mlp__prompt_kernel_lws_16
L_sequential_preLN__sliding_local_dilated__mixer_s_mlp__prompt_kernel_lwb_15:
L_sequential_preLN__sliding_local_dilated__mixer_s_mlp__prompt_kernel_free_14:
    s_add_u32 m0, s53, 0x1a800
    s_mov_b32 s57, 0x20000
    buffer_load_dwordx4 v39, s[68:71], s57 offen lds
    s_add_u32 m0, s53, 0x1b000
    s_mov_b32 s57, 0x24000
    buffer_load_dwordx4 v39, s[68:71], s57 offen lds
    s_add_u32 m0, s53, 0x1b800
    s_mov_b32 s57, 0x28000
    buffer_load_dwordx4 v39, s[68:71], s57 offen lds
    s_add_u32 m0, s53, 0x1c000
    s_mov_b32 s57, 0x2c000
    buffer_load_dwordx4 v39, s[68:71], s57 offen lds
    s_add_u32 m0, s53, 0x1c800
    s_mov_b32 s57, 0x30000
    buffer_load_dwordx4 v39, s[68:71], s57 offen lds
    s_add_u32 m0, s53, 0x1d000
    s_mov_b32 s57, 0x34000
    buffer_load_dwordx4 v39, s[68:71], s57 offen lds
    s_add_u32 m0, s53, 0x1d800
    s_mov_b32 s57, 0x38000
    buffer_load_dwordx4 v39, s[68:71], s57 offen lds
    s_add_u32 m0, s53, 0x1e000
    s_mov_b32 s57, 0x3c000
    buffer_load_dwordx4 v39, s[68:71], s57 offen lds
    s_mov_b64 exec, 1
    ds_read_b128 v[8:11], v4 offset:16
    ds_read_b128 v[20:23], v4 offset:32
    s_waitcnt lgkmcnt(0)
    v_min3_u32 v8, v8, v9, v10
    v_min3_u32 v20, v20, v21, v22
    v_min3_u32 v8, v8, v20, v23
    v_min_u32 v8, v8, v11
    s_nop 0
    v_readfirstlane_b32 s60, v8
    s_mov_b64 exec, -1
    s_cmp_ge_u32 s60, 5
    s_cbranch_scc1 L_sequential_preLN__sliding_local_dilated__mixer_s_mlp__prompt_kernel_free_17
    s_waitcnt vmcnt(8)
    v_mov_b32 v12, 9
    s_mov_b64 exec, 1
    ds_max_u32 v5, v12 offset:0
    s_mov_b64 exec, -1
    s_waitcnt vmcnt(0)
    v_mov_b32 v12, 10
    s_mov_b64 exec, 1
    ds_max_u32 v5, v12 offset:0
    s_mov_b64 exec, -1
    s_cmp_lt_u32 s60, 5
    s_cbranch_scc1 L_sequential_preLN__sliding_local_dilated__mixer_s_mlp__prompt_kernel_lws_19
L_sequential_preLN__sliding_local_dilated__mixer_s_mlp__prompt_kernel_lwb_18:
L_sequential_preLN__sliding_local_dilated__mixer_s_mlp__prompt_kernel_free_17:
    s_add_u32 m0, s53, 0x1e800
    s_mov_b32 s57, 0x40000
    buffer_load_dwordx4 v39, s[68:71], s57 offen lds
    s_add_u32 m0, s53, 0x1f000
    s_mov_b32 s57, 0x44000
    buffer_load_dwordx4 v39, s[68:71], s57 offen lds
    s_add_u32 m0, s53, 0x1f800
    s_mov_b32 s57, 0x48000
    buffer_load_dwordx4 v39, s[68:71], s57 offen lds
    s_add_u32 m0, s53, 0x20000
    s_mov_b32 s57, 0x4c000
    buffer_load_dwordx4 v39, s[68:71], s57 offen lds
    s_add_u32 m0, s53, 0x20800
    s_mov_b32 s57, 0x50000
    buffer_load_dwordx4 v39, s[68:71], s57 offen lds
    s_add_u32 m0, s53, 0x21000
    s_mov_b32 s57, 0x54000
    buffer_load_dwordx4 v39, s[68:71], s57 offen lds
    s_add_u32 m0, s53, 0x21800
    s_mov_b32 s57, 0x58000
    buffer_load_dwordx4 v39, s[68:71], s57 offen lds
    s_add_u32 m0, s53, 0x22000
    s_mov_b32 s57, 0x5c000
    buffer_load_dwordx4 v39, s[68:71], s57 offen lds
    s_waitcnt vmcnt(16)
    v_mov_b32 v12, 9
    s_mov_b64 exec, 1
    ds_max_u32 v5, v12 offset:0
    s_mov_b64 exec, -1
    s_mov_b64 exec, 1
    ds_read_b128 v[8:11], v4 offset:16
    ds_read_b128 v[20:23], v4 offset:32
    s_waitcnt lgkmcnt(0)
    v_min3_u32 v8, v8, v9, v10
    v_min3_u32 v20, v20, v21, v22
    v_min3_u32 v8, v8, v20, v23
    v_min_u32 v8, v8, v11
    s_nop 0
    v_readfirstlane_b32 s60, v8
    s_mov_b64 exec, -1
    s_cmp_ge_u32 s60, 5
    s_cbranch_scc1 L_sequential_preLN__sliding_local_dilated__mixer_s_mlp__prompt_kernel_free_20
    s_waitcnt vmcnt(8)
    v_mov_b32 v12, 10
    s_mov_b64 exec, 1
    ds_max_u32 v5, v12 offset:0
    s_mov_b64 exec, -1
    s_waitcnt vmcnt(0)
    v_mov_b32 v12, 11
    s_mov_b64 exec, 1
    ds_max_u32 v5, v12 offset:0
    s_mov_b64 exec, -1
    s_cmp_lt_u32 s60, 5
    s_cbranch_scc1 L_sequential_preLN__sliding_local_dilated__mixer_s_mlp__prompt_kernel_lws_22
L_sequential_preLN__sliding_local_dilated__mixer_s_mlp__prompt_kernel_lwb_21:
L_sequential_preLN__sliding_local_dilated__mixer_s_mlp__prompt_kernel_free_20:
    s_add_u32 m0, s53, 0x22800
    s_mov_b32 s57, 0x60000
    buffer_load_dwordx4 v39, s[68:71], s57 offen lds
    s_add_u32 m0, s53, 0x23000
    s_mov_b32 s57, 0x64000
    buffer_load_dwordx4 v39, s[68:71], s57 offen lds
    s_add_u32 m0, s53, 0x23800
    s_mov_b32 s57, 0x68000
    buffer_load_dwordx4 v39, s[68:71], s57 offen lds
    s_add_u32 m0, s53, 0x24000
    s_mov_b32 s57, 0x6c000
    buffer_load_dwordx4 v39, s[68:71], s57 offen lds
    s_add_u32 m0, s53, 0x24800
    s_mov_b32 s57, 0x70000
    buffer_load_dwordx4 v39, s[68:71], s57 offen lds
    s_add_u32 m0, s53, 0x25000
    s_mov_b32 s57, 0x74000
    buffer_load_dwordx4 v39, s[68:71], s57 offen lds
    s_add_u32 m0, s53, 0x25800
    s_mov_b32 s57, 0x78000
    buffer_load_dwordx4 v39, s[68:71], s57 offen lds
    s_add_u32 m0, s53, 0x26000
    s_mov_b32 s57, 0x7c000
    buffer_load_dwordx4 v39, s[68:71], s57 offen lds
    s_waitcnt vmcnt(16)
    v_mov_b32 v12, 10
    s_mov_b64 exec, 1
    ds_max_u32 v5, v12 offset:0
    s_mov_b64 exec, -1
    s_mov_b64 exec, 1
    ds_read_b128 v[8:11], v4 offset:16
    ds_read_b128 v[20:23], v4 offset:32
    s_waitcnt lgkmcnt(0)
    v_min3_u32 v8, v8, v9, v10
    v_min3_u32 v20, v20, v21, v22
    v_min3_u32 v8, v8, v20, v23
    v_min_u32 v8, v8, v11
    s_nop 0
    v_readfirstlane_b32 s60, v8
    s_mov_b64 exec, -1
    s_cmp_ge_u32 s60, 6
    s_cbranch_scc1 L_sequential_preLN__sliding_local_dilated__mixer_s_mlp__prompt_kernel_free_23
    s_waitcnt vmcnt(8)
    v_mov_b32 v12, 11
    s_mov_b64 exec, 1
    ds_max_u32 v5, v12 offset:0
    s_mov_b64 exec, -1
    s_waitcnt vmcnt(0)
    v_mov_b32 v12, 12
    s_mov_b64 exec, 1
    ds_max_u32 v5, v12 offset:0
    s_mov_b64 exec, -1
    s_cmp_lt_u32 s60, 6
    s_cbranch_scc1 L_sequential_preLN__sliding_local_dilated__mixer_s_mlp__prompt_kernel_lws_25
L_sequential_preLN__sliding_local_dilated__mixer_s_mlp__prompt_kernel_lwb_24:
L_sequential_preLN__sliding_local_dilated__mixer_s_mlp__prompt_kernel_free_23:
    s_mov_b32 s68, s12
    s_mov_b32 s69, s13
    s_mov_b32 s70, 0x80000
    s_add_u32 m0, s53, 0x0
    s_mov_b32 s57, 0x0
    buffer_load_dwordx4 v38, s[68:71], s57 offen lds
    s_add_u32 m0, s53, 0x800
    s_mov_b32 s57, 0x4000
    buffer_load_dwordx4 v38, s[68:71], s57 offen lds
    s_add_u32 m0, s53, 0x1000
    s_mov_b32 s57, 0x8000
    buffer_load_dwordx4 v38, s[68:71], s57 offen lds
    s_add_u32 m0, s53, 0x1800
    s_mov_b32 s57, 0xc000
    buffer_load_dwordx4 v38, s[68:71], s57 offen lds
    s_add_u32 m0, s53, 0x2000
    s_mov_b32 s57, 0x10000
    buffer_load_dwordx4 v38, s[68:71], s57 offen lds
    s_add_u32 m0, s53, 0x2800
    s_mov_b32 s57, 0x14000
    buffer_load_dwordx4 v38, s[68:71], s57 offen lds
    s_add_u32 m0, s53, 0x3000
    s_mov_b32 s57, 0x18000
    buffer_load_dwordx4 v38, s[68:71], s57 offen lds
    s_add_u32 m0, s53, 0x3800
    s_mov_b32 s57, 0x1c000
    buffer_load_dwordx4 v38, s[68:71], s57 offen lds
    s_waitcnt vmcnt(16)
    v_mov_b32 v12, 11
    s_mov_b64 exec, 1
    ds_max_u32 v5, v12 offset:0
    s_mov_b64 exec, -1
    s_mov_b64 exec, 1
    ds_read_b128 v[8:11], v4 offset:16
    ds_read_b128 v[20:23], v4 offset:32
    s_waitcnt lgkmcnt(0)
    v_min3_u32 v8, v8, v9, v10
    v_min3_u32 v20, v20, v21, v22
    v_min3_u32 v8, v8, v20, v23
    v_min_u32 v8, v8, v11
    s_nop 0
    v_readfirstlane_b32 s60, v8
    s_mov_b64 exec, -1
    s_cmp_ge_u32 s60, 7
    s_cbranch_scc1 L_sequential_preLN__sliding_local_dilated__mixer_s_mlp__prompt_kernel_free_26
    s_waitcnt vmcnt(8)
    v_mov_b32 v12, 12
    s_mov_b64 exec, 1
    ds_max_u32 v5, v12 offset:0
    s_mov_b64 exec, -1
    s_waitcnt vmcnt(0)
    v_mov_b32 v12, 13
    s_mov_b64 exec, 1
    ds_max_u32 v5, v12 offset:0
    s_mov_b64 exec, -1
    s_cmp_lt_u32 s60, 7
    s_cbranch_scc1 L_sequential_preLN__sliding_local_dilated__mixer_s_mlp__prompt_kernel_lws_28
L_sequential_preLN__sliding_local_dilated__mixer_s_mlp__prompt_kernel_lwb_27:
L_sequential_preLN__sliding_local_dilated__mixer_s_mlp__prompt_kernel_free_26:
    s_add_u32 m0, s53, 0x4000
    s_mov_b32 s57, 0x20000
    buffer_load_dwordx4 v38, s[68:71], s57 offen lds
    s_add_u32 m0, s53, 0x4800
    s_mov_b32 s57, 0x24000
    buffer_load_dwordx4 v38, s[68:71], s57 offen lds
    s_add_u32 m0, s53, 0x5000
    s_mov_b32 s57, 0x28000
    buffer_load_dwordx4 v38, s[68:71], s57 offen lds
    s_add_u32 m0, s53, 0x5800
    s_mov_b32 s57, 0x2c000
    buffer_load_dwordx4 v38, s[68:71], s57 offen lds
    s_add_u32 m0, s53, 0x6000
    s_mov_b32 s57, 0x30000
    buffer_load_dwordx4 v38, s[68:71], s57 offen lds
    s_add_u32 m0, s53, 0x6800
    s_mov_b32 s57, 0x34000
    buffer_load_dwordx4 v38, s[68:71], s57 offen lds
    s_add_u32 m0, s53, 0x7000
    s_mov_b32 s57, 0x38000
    buffer_load_dwordx4 v38, s[68:71], s57 offen lds
    s_add_u32 m0, s53, 0x7800
    s_mov_b32 s57, 0x3c000
    buffer_load_dwordx4 v38, s[68:71], s57 offen lds
    s_waitcnt vmcnt(16)
    v_mov_b32 v12, 12
    s_mov_b64 exec, 1
    ds_max_u32 v5, v12 offset:0
    s_mov_b64 exec, -1
    s_mov_b64 exec, 1
    ds_read_b128 v[8:11], v4 offset:16
    ds_read_b128 v[20:23], v4 offset:32
    s_waitcnt lgkmcnt(0)
    v_min3_u32 v8, v8, v9, v10
    v_min3_u32 v20, v20, v21, v22
    v_min3_u32 v8, v8, v20, v23
    v_min_u32 v8, v8, v11
    s_nop 0
    v_readfirstlane_b32 s60, v8
    s_mov_b64 exec, -1
    s_cmp_ge_u32 s60, 7
    s_cbranch_scc1 L_sequential_preLN__sliding_local_dilated__mixer_s_mlp__prompt_kernel_free_29
    s_waitcnt vmcnt(8)
    v_mov_b32 v12, 13
    s_mov_b64 exec, 1
    ds_max_u32 v5, v12 offset:0
    s_mov_b64 exec, -1
    s_waitcnt vmcnt(0)
    v_mov_b32 v12, 14
    s_mov_b64 exec, 1
    ds_max_u32 v5, v12 offset:0
    s_mov_b64 exec, -1
    s_cmp_lt_u32 s60, 7
    s_cbranch_scc1 L_sequential_preLN__sliding_local_dilated__mixer_s_mlp__prompt_kernel_lws_31
L_sequential_preLN__sliding_local_dilated__mixer_s_mlp__prompt_kernel_lwb_30:
L_sequential_preLN__sliding_local_dilated__mixer_s_mlp__prompt_kernel_free_29:
    s_add_u32 m0, s53, 0x8000
    s_mov_b32 s57, 0x40000
    buffer_load_dwordx4 v38, s[68:71], s57 offen lds
    s_add_u32 m0, s53, 0x8800
    s_mov_b32 s57, 0x44000
    buffer_load_dwordx4 v38, s[68:71], s57 offen lds
    s_add_u32 m0, s53, 0x9000
    s_mov_b32 s57, 0x48000
    buffer_load_dwordx4 v38, s[68:71], s57 offen lds
    s_add_u32 m0, s53, 0x9800
    s_mov_b32 s57, 0x4c000
    buffer_load_dwordx4 v38, s[68:71], s57 offen lds
    s_add_u32 m0, s53, 0xa000
    s_mov_b32 s57, 0x50000
    buffer_load_dwordx4 v38, s[68:71], s57 offen lds
    s_add_u32 m0, s53, 0xa800
    s_mov_b32 s57, 0x54000
    buffer_load_dwordx4 v38, s[68:71], s57 offen lds
    s_add_u32 m0, s53, 0xb000
    s_mov_b32 s57, 0x58000
    buffer_load_dwordx4 v38, s[68:71], s57 offen lds
    s_add_u32 m0, s53, 0xb800
    s_mov_b32 s57, 0x5c000
    buffer_load_dwordx4 v38, s[68:71], s57 offen lds
    s_waitcnt vmcnt(16)
    v_mov_b32 v12, 13
    s_mov_b64 exec, 1
    ds_max_u32 v5, v12 offset:0
    s_mov_b64 exec, -1
    s_waitcnt vmcnt(8)
    v_mov_b32 v12, 14
    s_mov_b64 exec, 1
    ds_max_u32 v5, v12 offset:0
    s_mov_b64 exec, -1
    s_waitcnt vmcnt(0)
    v_mov_b32 v12, 15
    s_mov_b64 exec, 1
    ds_max_u32 v5, v12 offset:0
    s_mov_b64 exec, -1
    s_mul_i32 s52, s26, 229376
    s_mul_i32 s34, s30, 224
    s_add_u32 s52, s52, s34
    v_add_u32 v8, 0, v1
    v_mul_u32_u24 v9, 4682, v8
    v_lshrrev_b32 v9, 16, v9
    v_mul_u32_u24 v10, 14, v9
    v_sub_u32 v8, v8, v10
    v_lshlrev_b32 v8, 4, v8
    v_mul_u32_u24 v9, 3584, v9
    v_add3_u32 v40, v8, v9, s52
    v_add_u32 v8, 64, v1
    v_mul_u32_u24 v9, 4682, v8
    v_lshrrev_b32 v9, 16, v9
    v_mul_u32_u24 v10, 14, v9
    v_sub_u32 v8, v8, v10
    v_lshlrev_b32 v8, 4, v8
    v_mul_u32_u24 v9, 3584, v9
    v_add3_u32 v41, v8, v9, s52
    v_add_u32 v8, 128, v1
    v_mul_u32_u24 v9, 4682, v8
    v_lshrrev_b32 v9, 16, v9
    v_mul_u32_u24 v10, 14, v9
    v_sub_u32 v8, v8, v10
    v_lshlrev_b32 v8, 4, v8
    v_mul_u32_u24 v9, 3584, v9
    v_add3_u32 v42, v8, v9, s52
    v_add_u32 v8, 192, v1
    v_mul_u32_u24 v9, 4682, v8
    v_lshrrev_b32 v9, 16, v9
    v_mul_u32_u24 v10, 14, v9
    v_sub_u32 v8, v8, v10
    v_lshlrev_b32 v8, 4, v8
    v_mul_u32_u24 v9, 3584, v9
    v_add3_u32 v43, v8, v9, s52
    v_add_u32 v8, 256, v1
    v_mul_u32_u24 v9, 4682, v8
    v_lshrrev_b32 v9, 16, v9
    v_mul_u32_u24 v10, 14, v9
    v_sub_u32 v8, v8, v10
    v_lshlrev_b32 v8, 4, v8
    v_mul_u32_u24 v9, 3584, v9
    v_add3_u32 v44, v8, v9, s52
    v_add_u32 v8, 320, v1
    v_mul_u32_u24 v9, 4682, v8
    v_lshrrev_b32 v9, 16, v9
    v_mul_u32_u24 v10, 14, v9
    v_sub_u32 v8, v8, v10
    v_lshlrev_b32 v8, 4, v8
    v_mul_u32_u24 v9, 3584, v9
    v_add3_u32 v45, v8, v9, s52
    v_add_u32 v8, 384, v1
    v_mul_u32_u24 v9, 4682, v8
    v_lshrrev_b32 v9, 16, v9
    v_mul_u32_u24 v10, 14, v9
    v_sub_u32 v8, v8, v10
    v_lshlrev_b32 v8, 4, v8
    v_mul_u32_u24 v9, 3584, v9
    v_add3_u32 v46, v8, v9, s52
    s_cmp_lt_u32 s60, 8
    s_cbranch_scc1 L_sequential_preLN__sliding_local_dilated__mixer_s_mlp__prompt_kernel_lws_34
L_sequential_preLN__sliding_local_dilated__mixer_s_mlp__prompt_kernel_lwb_33:
L_sequential_preLN__sliding_local_dilated__mixer_s_mlp__prompt_kernel_free_32:
    s_add_u32 m0, s53, 0xc000
    s_mov_b32 s57, 0x60000
    buffer_load_dwordx4 v38, s[68:71], s57 offen lds
    s_add_u32 m0, s53, 0xc800
    s_mov_b32 s57, 0x64000
    buffer_load_dwordx4 v38, s[68:71], s57 offen lds
    s_add_u32 m0, s53, 0xd000
    s_mov_b32 s57, 0x68000
    buffer_load_dwordx4 v38, s[68:71], s57 offen lds
    s_add_u32 m0, s53, 0xd800
    s_mov_b32 s57, 0x6c000
    buffer_load_dwordx4 v38, s[68:71], s57 offen lds
    s_add_u32 m0, s53, 0xe000
    s_mov_b32 s57, 0x70000
    buffer_load_dwordx4 v38, s[68:71], s57 offen lds
    s_add_u32 m0, s53, 0xe800
    s_mov_b32 s57, 0x74000
    buffer_load_dwordx4 v38, s[68:71], s57 offen lds
    s_add_u32 m0, s53, 0xf000
    s_mov_b32 s57, 0x78000
    buffer_load_dwordx4 v38, s[68:71], s57 offen lds
    s_add_u32 m0, s53, 0xf800
    s_mov_b32 s57, 0x7c000
    buffer_load_dwordx4 v38, s[68:71], s57 offen lds
    s_mov_b64 exec, 1
    ds_read_b128 v[8:11], v4 offset:16
    ds_read_b128 v[20:23], v4 offset:32
    s_waitcnt lgkmcnt(0)
    v_min3_u32 v8, v8, v9, v10
    v_min3_u32 v20, v20, v21, v22
    v_min3_u32 v8, v8, v20, v23
    v_min_u32 v8, v8, v11
    s_nop 0
    v_readfirstlane_b32 s60, v8
    s_mov_b64 exec, -1
    s_cmp_ge_u32 s60, 8
    s_cbranch_scc1 L_sequential_preLN__sliding_local_dilated__mixer_s_mlp__prompt_kernel_free_35
    s_waitcnt vmcnt(0)
    v_mov_b32 v12, 16
    s_mov_b64 exec, 1
    ds_max_u32 v5, v12 offset:0
    s_mov_b64 exec, -1
    s_cmp_lt_u32 s60, 8
    s_cbranch_scc1 L_sequential_preLN__sliding_local_dilated__mixer_s_mlp__prompt_kernel_lws_37
L_sequential_preLN__sliding_local_dilated__mixer_s_mlp__prompt_kernel_lwb_36:
L_sequential_preLN__sliding_local_dilated__mixer_s_mlp__prompt_kernel_free_35:
    s_mov_b32 s68, s14
    s_mov_b32 s69, s15
    s_mov_b32 s70, 0x80000
    s_add_u32 m0, s53, 0x10000
    s_mov_b32 s57, 0x0
    buffer_load_dwordx4 v38, s[68:71], s57 offen lds
    s_add_u32 m0, s53, 0x10800
    s_mov_b32 s57, 0x4000
    buffer_load_dwordx4 v38, s[68:71], s57 offen lds
    s_add_u32 m0, s53, 0x11000
    s_mov_b32 s57, 0x8000
    buffer_load_dwordx4 v38, s[68:71], s57 offen lds
    s_add_u32 m0, s53, 0x11800
    s_mov_b32 s57, 0xc000
    buffer_load_dwordx4 v38, s[68:71], s57 offen lds
    s_add_u32 m0, s53, 0x12000
    s_mov_b32 s57, 0x10000
    buffer_load_dwordx4 v38, s[68:71], s57 offen lds
    s_add_u32 m0, s53, 0x12800
    s_mov_b32 s57, 0x14000
    buffer_load_dwordx4 v38, s[68:71], s57 offen lds
    s_add_u32 m0, s53, 0x13000
    s_mov_b32 s57, 0x18000
    buffer_load_dwordx4 v38, s[68:71], s57 offen lds
    s_add_u32 m0, s53, 0x13800
    s_mov_b32 s57, 0x1c000
    buffer_load_dwordx4 v38, s[68:71], s57 offen lds
    s_mov_b64 exec, 1
    ds_read_b128 v[8:11], v4 offset:16
    ds_read_b128 v[20:23], v4 offset:32
    s_waitcnt lgkmcnt(0)
    v_min3_u32 v8, v8, v9, v10
    v_min3_u32 v20, v20, v21, v22
    v_min3_u32 v8, v8, v20, v23
    v_min_u32 v8, v8, v11
    s_nop 0
    v_readfirstlane_b32 s60, v8
    s_mov_b64 exec, -1
    s_cmp_ge_u32 s60, 9
    s_cbranch_scc1 L_sequential_preLN__sliding_local_dilated__mixer_s_mlp__prompt_kernel_free_38
    s_waitcnt vmcnt(8)
    v_mov_b32 v12, 16
    s_mov_b64 exec, 1
    ds_max_u32 v5, v12 offset:0
    s_mov_b64 exec, -1
    s_waitcnt vmcnt(0)
    v_mov_b32 v12, 17
    s_mov_b64 exec, 1
    ds_max_u32 v5, v12 offset:0
    s_mov_b64 exec, -1
    s_cmp_lt_u32 s60, 9
    s_cbranch_scc1 L_sequential_preLN__sliding_local_dilated__mixer_s_mlp__prompt_kernel_lws_40
L_sequential_preLN__sliding_local_dilated__mixer_s_mlp__prompt_kernel_lwb_39:
L_sequential_preLN__sliding_local_dilated__mixer_s_mlp__prompt_kernel_free_38:
    s_add_u32 m0, s53, 0x14000
    s_mov_b32 s57, 0x20000
    buffer_load_dwordx4 v38, s[68:71], s57 offen lds
    s_add_u32 m0, s53, 0x14800
    s_mov_b32 s57, 0x24000
    buffer_load_dwordx4 v38, s[68:71], s57 offen lds
    s_add_u32 m0, s53, 0x15000
    s_mov_b32 s57, 0x28000
    buffer_load_dwordx4 v38, s[68:71], s57 offen lds
    s_add_u32 m0, s53, 0x15800
    s_mov_b32 s57, 0x2c000
    buffer_load_dwordx4 v38, s[68:71], s57 offen lds
    s_add_u32 m0, s53, 0x16000
    s_mov_b32 s57, 0x30000
    buffer_load_dwordx4 v38, s[68:71], s57 offen lds
    s_add_u32 m0, s53, 0x16800
    s_mov_b32 s57, 0x34000
    buffer_load_dwordx4 v38, s[68:71], s57 offen lds
    s_add_u32 m0, s53, 0x17000
    s_mov_b32 s57, 0x38000
    buffer_load_dwordx4 v38, s[68:71], s57 offen lds
    s_add_u32 m0, s53, 0x17800
    s_mov_b32 s57, 0x3c000
    buffer_load_dwordx4 v38, s[68:71], s57 offen lds
    s_waitcnt vmcnt(16)
    v_mov_b32 v12, 16
    s_mov_b64 exec, 1
    ds_max_u32 v5, v12 offset:0
    s_mov_b64 exec, -1
    s_mov_b64 exec, 1
    ds_read_b128 v[8:11], v4 offset:16
    ds_read_b128 v[20:23], v4 offset:32
    s_waitcnt lgkmcnt(0)
    v_min3_u32 v8, v8, v9, v10
    v_min3_u32 v20, v20, v21, v22
    v_min3_u32 v8, v8, v20, v23
    v_min_u32 v8, v8, v11
    s_nop 0
    v_readfirstlane_b32 s60, v8
    s_mov_b64 exec, -1
    s_cmp_ge_u32 s60, 10
    s_cbranch_scc1 L_sequential_preLN__sliding_local_dilated__mixer_s_mlp__prompt_kernel_free_41
    s_waitcnt vmcnt(8)
    v_mov_b32 v12, 17
    s_mov_b64 exec, 1
    ds_max_u32 v5, v12 offset:0
    s_mov_b64 exec, -1
    s_waitcnt vmcnt(0)
    v_mov_b32 v12, 18
    s_mov_b64 exec, 1
    ds_max_u32 v5, v12 offset:0
    s_mov_b64 exec, -1
    s_cmp_lt_u32 s60, 10
    s_cbranch_scc1 L_sequential_preLN__sliding_local_dilated__mixer_s_mlp__prompt_kernel_lws_43
L_sequential_preLN__sliding_local_dilated__mixer_s_mlp__prompt_kernel_lwb_42:
L_sequential_preLN__sliding_local_dilated__mixer_s_mlp__prompt_kernel_free_41:
    s_add_u32 m0, s53, 0x18000
    s_mov_b32 s57, 0x40000
    buffer_load_dwordx4 v38, s[68:71], s57 offen lds
    s_add_u32 m0, s53, 0x18800
    s_mov_b32 s57, 0x44000
    buffer_load_dwordx4 v38, s[68:71], s57 offen lds
    s_add_u32 m0, s53, 0x19000
    s_mov_b32 s57, 0x48000
    buffer_load_dwordx4 v38, s[68:71], s57 offen lds
    s_add_u32 m0, s53, 0x19800
    s_mov_b32 s57, 0x4c000
    buffer_load_dwordx4 v38, s[68:71], s57 offen lds
    s_add_u32 m0, s53, 0x1a000
    s_mov_b32 s57, 0x50000
    buffer_load_dwordx4 v38, s[68:71], s57 offen lds
    s_add_u32 m0, s53, 0x1a800
    s_mov_b32 s57, 0x54000
    buffer_load_dwordx4 v38, s[68:71], s57 offen lds
    s_add_u32 m0, s53, 0x1b000
    s_mov_b32 s57, 0x58000
    buffer_load_dwordx4 v38, s[68:71], s57 offen lds
    s_add_u32 m0, s53, 0x1b800
    s_mov_b32 s57, 0x5c000
    buffer_load_dwordx4 v38, s[68:71], s57 offen lds
    s_waitcnt vmcnt(16)
    v_mov_b32 v12, 17
    s_mov_b64 exec, 1
    ds_max_u32 v5, v12 offset:0
    s_mov_b64 exec, -1
    s_mov_b64 exec, 1
    ds_read_b128 v[8:11], v4 offset:16
    ds_read_b128 v[20:23], v4 offset:32
    s_waitcnt lgkmcnt(0)
    v_min3_u32 v8, v8, v9, v10
    v_min3_u32 v20, v20, v21, v22
    v_min3_u32 v8, v8, v20, v23
    v_min_u32 v8, v8, v11
    s_nop 0
    v_readfirstlane_b32 s60, v8
    s_mov_b64 exec, -1
    s_cmp_ge_u32 s60, 11
    s_cbranch_scc1 L_sequential_preLN__sliding_local_dilated__mixer_s_mlp__prompt_kernel_free_44
    s_waitcnt vmcnt(8)
    v_mov_b32 v12, 18
    s_mov_b64 exec, 1
    ds_max_u32 v5, v12 offset:0
    s_mov_b64 exec, -1
    s_waitcnt vmcnt(0)
    v_mov_b32 v12, 19
    s_mov_b64 exec, 1
    ds_max_u32 v5, v12 offset:0
    s_mov_b64 exec, -1
    s_cmp_lt_u32 s60, 11
    s_cbranch_scc1 L_sequential_preLN__sliding_local_dilated__mixer_s_mlp__prompt_kernel_lws_46
L_sequential_preLN__sliding_local_dilated__mixer_s_mlp__prompt_kernel_lwb_45:
L_sequential_preLN__sliding_local_dilated__mixer_s_mlp__prompt_kernel_free_44:
    s_add_u32 m0, s53, 0x1c000
    s_mov_b32 s57, 0x60000
    buffer_load_dwordx4 v38, s[68:71], s57 offen lds
    s_add_u32 m0, s53, 0x1c800
    s_mov_b32 s57, 0x64000
    buffer_load_dwordx4 v38, s[68:71], s57 offen lds
    s_add_u32 m0, s53, 0x1d000
    s_mov_b32 s57, 0x68000
    buffer_load_dwordx4 v38, s[68:71], s57 offen lds
    s_add_u32 m0, s53, 0x1d800
    s_mov_b32 s57, 0x6c000
    buffer_load_dwordx4 v38, s[68:71], s57 offen lds
    s_add_u32 m0, s53, 0x1e000
    s_mov_b32 s57, 0x70000
    buffer_load_dwordx4 v38, s[68:71], s57 offen lds
    s_add_u32 m0, s53, 0x1e800
    s_mov_b32 s57, 0x74000
    buffer_load_dwordx4 v38, s[68:71], s57 offen lds
    s_add_u32 m0, s53, 0x1f000
    s_mov_b32 s57, 0x78000
    buffer_load_dwordx4 v38, s[68:71], s57 offen lds
    s_add_u32 m0, s53, 0x1f800
    s_mov_b32 s57, 0x7c000
    buffer_load_dwordx4 v38, s[68:71], s57 offen lds
    s_waitcnt vmcnt(16)
    v_mov_b32 v12, 18
    s_mov_b64 exec, 1
    ds_max_u32 v5, v12 offset:0
    s_mov_b64 exec, -1
    s_mov_b64 exec, 1
    ds_read_b128 v[8:11], v4 offset:16
    ds_read_b128 v[20:23], v4 offset:32
    s_waitcnt lgkmcnt(0)
    v_min3_u32 v8, v8, v9, v10
    v_min3_u32 v20, v20, v21, v22
    v_min3_u32 v8, v8, v20, v23
    v_min_u32 v8, v8, v11
    s_nop 0
    v_readfirstlane_b32 s60, v8
    s_mov_b64 exec, -1
    s_cmp_ge_u32 s60, 14
    s_cbranch_scc1 L_sequential_preLN__sliding_local_dilated__mixer_s_mlp__prompt_kernel_free_47
    s_waitcnt vmcnt(8)
    v_mov_b32 v12, 19
    s_mov_b64 exec, 1
    ds_max_u32 v5, v12 offset:0
    s_mov_b64 exec, -1
    s_waitcnt vmcnt(0)
    v_mov_b32 v12, 20
    s_mov_b64 exec, 1
    ds_max_u32 v5, v12 offset:0
    s_mov_b64 exec, -1
    s_cmp_lt_u32 s60, 14
    s_cbranch_scc1 L_sequential_preLN__sliding_local_dilated__mixer_s_mlp__prompt_kernel_lws_49
L_sequential_preLN__sliding_local_dilated__mixer_s_mlp__prompt_kernel_lwb_48:
L_sequential_preLN__sliding_local_dilated__mixer_s_mlp__prompt_kernel_free_47:
    s_mov_b32 s68, s16
    s_mov_b32 s69, s17
    s_mov_b32 s70, 0x1c0000
    s_add_u32 m0, s55, 0x0
    s_mov_b32 s57, 0x0
    buffer_load_dwordx4 v40, s[68:71], s57 offen lds
    s_add_u32 m0, s55, 0x400
    s_nop 0
    buffer_load_dwordx4 v41, s[68:71], s57 offen lds
    s_add_u32 m0, s55, 0x800
    s_nop 0
    buffer_load_dwordx4 v42, s[68:71], s57 offen lds
    s_add_u32 m0, s55, 0xc00
    s_nop 0
    buffer_load_dwordx4 v43, s[68:71], s57 offen lds
    s_add_u32 m0, s55, 0x1000
    s_nop 0
    buffer_load_dwordx4 v44, s[68:71], s57 offen lds
    s_add_u32 m0, s55, 0x1400
    s_nop 0
    buffer_load_dwordx4 v45, s[68:71], s57 offen lds
    s_add_u32 m0, s55, 0x1800
    s_nop 0
    buffer_load_dwordx4 v46, s[68:71], s57 offen lds
    s_add_u32 m0, s55, 0x1c00
    s_mov_b32 s57, 0x1c000
    buffer_load_dwordx4 v40, s[68:71], s57 offen lds
    s_add_u32 m0, s55, 0x2000
    s_nop 0
    buffer_load_dwordx4 v41, s[68:71], s57 offen lds
    s_add_u32 m0, s55, 0x2400
    s_nop 0
    buffer_load_dwordx4 v42, s[68:71], s57 offen lds
    s_add_u32 m0, s55, 0x2800
    s_nop 0
    buffer_load_dwordx4 v43, s[68:71], s57 offen lds
    s_add_u32 m0, s55, 0x2c00
    s_nop 0
    buffer_load_dwordx4 v44, s[68:71], s57 offen lds
    s_add_u32 m0, s55, 0x3000
    s_nop 0
    buffer_load_dwordx4 v45, s[68:71], s57 offen lds
    s_add_u32 m0, s55, 0x3400
    s_nop 0
    buffer_load_dwordx4 v46, s[68:71], s57 offen lds
    s_waitcnt vmcnt(22)
    v_mov_b32 v12, 19
    s_mov_b64 exec, 1
    ds_max_u32 v5, v12 offset:0
    s_mov_b64 exec, -1
    s_waitcnt vmcnt(14)
    v_mov_b32 v12, 20
    s_mov_b64 exec, 1
    ds_max_u32 v5, v12 offset:0
    s_mov_b64 exec, -1
    s_mov_b64 exec, 1
    ds_read_b128 v[8:11], v4 offset:16
    ds_read_b128 v[20:23], v4 offset:32
    s_waitcnt lgkmcnt(0)
    v_min3_u32 v8, v8, v9, v10
    v_min3_u32 v20, v20, v21, v22
    v_min3_u32 v8, v8, v20, v23
    v_min_u32 v8, v8, v11
    s_nop 0
    v_readfirstlane_b32 s60, v8
    s_mov_b64 exec, -1
    s_cmp_ge_u32 s60, 16
    s_cbranch_scc1 L_sequential_preLN__sliding_local_dilated__mixer_s_mlp__prompt_kernel_free_50
    s_waitcnt vmcnt(0)
    v_mov_b32 v12, 21
    s_mov_b64 exec, 1
    ds_max_u32 v5, v12 offset:0
    s_mov_b64 exec, -1
    s_cmp_lt_u32 s60, 16
    s_cbranch_scc1 L_sequential_preLN__sliding_local_dilated__mixer_s_mlp__prompt_kernel_lws_52
L_sequential_preLN__sliding_local_dilated__mixer_s_mlp__prompt_kernel_lwb_51:
L_sequential_preLN__sliding_local_dilated__mixer_s_mlp__prompt_kernel_free_50:
    s_add_u32 m0, s55, 0x7000
    s_mov_b32 s57, 0x70000
    buffer_load_dwordx4 v40, s[68:71], s57 offen lds
    s_add_u32 m0, s55, 0x7400
    s_nop 0
    buffer_load_dwordx4 v41, s[68:71], s57 offen lds
    s_add_u32 m0, s55, 0x7800
    s_nop 0
    buffer_load_dwordx4 v42, s[68:71], s57 offen lds
    s_add_u32 m0, s55, 0x7c00
    s_nop 0
    buffer_load_dwordx4 v43, s[68:71], s57 offen lds
    s_add_u32 m0, s55, 0x8000
    s_nop 0
    buffer_load_dwordx4 v44, s[68:71], s57 offen lds
    s_add_u32 m0, s55, 0x8400
    s_nop 0
    buffer_load_dwordx4 v45, s[68:71], s57 offen lds
    s_add_u32 m0, s55, 0x8800
    s_nop 0
    buffer_load_dwordx4 v46, s[68:71], s57 offen lds
    s_add_u32 m0, s55, 0x8c00
    s_mov_b32 s57, 0x8c000
    buffer_load_dwordx4 v40, s[68:71], s57 offen lds
    s_add_u32 m0, s55, 0x9000
    s_nop 0
    buffer_load_dwordx4 v41, s[68:71], s57 offen lds
    s_add_u32 m0, s55, 0x9400
    s_nop 0
    buffer_load_dwordx4 v42, s[68:71], s57 offen lds
    s_add_u32 m0, s55, 0x9800
    s_nop 0
    buffer_load_dwordx4 v43, s[68:71], s57 offen lds
    s_add_u32 m0, s55, 0x9c00
    s_nop 0
    buffer_load_dwordx4 v44, s[68:71], s57 offen lds
    s_add_u32 m0, s55, 0xa000
    s_nop 0
    buffer_load_dwordx4 v45, s[68:71], s57 offen lds
    s_add_u32 m0, s55, 0xa400
    s_nop 0
    buffer_load_dwordx4 v46, s[68:71], s57 offen lds
    s_waitcnt vmcnt(14)
    v_mov_b32 v12, 21
    s_mov_b64 exec, 1
    ds_max_u32 v5, v12 offset:0
    s_mov_b64 exec, -1
    s_mov_b64 exec, 1
    ds_read_b128 v[8:11], v4 offset:16
    ds_read_b128 v[20:23], v4 offset:32
    s_waitcnt lgkmcnt(0)
    v_min3_u32 v8, v8, v9, v10
    v_min3_u32 v20, v20, v21, v22
    v_min3_u32 v8, v8, v20, v23
    v_min_u32 v8, v8, v11
    s_nop 0
    v_readfirstlane_b32 s60, v8
    s_mov_b64 exec, -1
    s_cmp_ge_u32 s60, 18
    s_cbranch_scc1 L_sequential_preLN__sliding_local_dilated__mixer_s_mlp__prompt_kernel_free_53
    s_waitcnt vmcnt(0)
    v_mov_b32 v12, 22
    s_mov_b64 exec, 1
    ds_max_u32 v5, v12 offset:0
    s_mov_b64 exec, -1
    s_cmp_lt_u32 s60, 18
    s_cbranch_scc1 L_sequential_preLN__sliding_local_dilated__mixer_s_mlp__prompt_kernel_lws_55
L_sequential_preLN__sliding_local_dilated__mixer_s_mlp__prompt_kernel_lwb_54:
L_sequential_preLN__sliding_local_dilated__mixer_s_mlp__prompt_kernel_free_53:
    s_add_u32 m0, s55, 0xe000
    s_mov_b32 s57, 0xe0000
    buffer_load_dwordx4 v40, s[68:71], s57 offen lds
    s_add_u32 m0, s55, 0xe400
    s_nop 0
    buffer_load_dwordx4 v41, s[68:71], s57 offen lds
    s_add_u32 m0, s55, 0xe800
    s_nop 0
    buffer_load_dwordx4 v42, s[68:71], s57 offen lds
    s_add_u32 m0, s55, 0xec00
    s_nop 0
    buffer_load_dwordx4 v43, s[68:71], s57 offen lds
    s_add_u32 m0, s55, 0xf000
    s_nop 0
    buffer_load_dwordx4 v44, s[68:71], s57 offen lds
    s_add_u32 m0, s55, 0xf400
    s_nop 0
    buffer_load_dwordx4 v45, s[68:71], s57 offen lds
    s_add_u32 m0, s55, 0xf800
    s_nop 0
    buffer_load_dwordx4 v46, s[68:71], s57 offen lds
    s_add_u32 m0, s55, 0xfc00
    s_mov_b32 s57, 0xfc000
    buffer_load_dwordx4 v40, s[68:71], s57 offen lds
    s_add_u32 m0, s55, 0x10000
    s_nop 0
    buffer_load_dwordx4 v41, s[68:71], s57 offen lds
    s_add_u32 m0, s55, 0x10400
    s_nop 0
    buffer_load_dwordx4 v42, s[68:71], s57 offen lds
    s_add_u32 m0, s55, 0x10800
    s_nop 0
    buffer_load_dwordx4 v43, s[68:71], s57 offen lds
    s_add_u32 m0, s55, 0x10c00
    s_nop 0
    buffer_load_dwordx4 v44, s[68:71], s57 offen lds
    s_add_u32 m0, s55, 0x11000
    s_nop 0
    buffer_load_dwordx4 v45, s[68:71], s57 offen lds
    s_add_u32 m0, s55, 0x11400
    s_nop 0
    buffer_load_dwordx4 v46, s[68:71], s57 offen lds
    s_waitcnt vmcnt(14)
    v_mov_b32 v12, 22
    s_mov_b64 exec, 1
    ds_max_u32 v5, v12 offset:0
    s_mov_b64 exec, -1
    s_mov_b64 exec, 1
    ds_read_b128 v[8:11], v4 offset:16
    ds_read_b128 v[20:23], v4 offset:32
    s_waitcnt lgkmcnt(0)
    v_min3_u32 v8, v8, v9, v10
    v_min3_u32 v20, v20, v21, v22
    v_min3_u32 v8, v8, v20, v23
    v_min_u32 v8, v8, v11
    s_nop 0
    v_readfirstlane_b32 s60, v8
    s_mov_b64 exec, -1
    s_cmp_ge_u32 s60, 19
    s_cbranch_scc1 L_sequential_preLN__sliding_local_dilated__mixer_s_mlp__prompt_kernel_free_56
    s_waitcnt vmcnt(0)
    v_mov_b32 v12, 23
    s_mov_b64 exec, 1
    ds_max_u32 v5, v12 offset:0
    s_mov_b64 exec, -1
    s_cmp_lt_u32 s60, 19
    s_cbranch_scc1 L_sequential_preLN__sliding_local_dilated__mixer_s_mlp__prompt_kernel_lws_58
L_sequential_preLN__sliding_local_dilated__mixer_s_mlp__prompt_kernel_lwb_57:
L_sequential_preLN__sliding_local_dilated__mixer_s_mlp__prompt_kernel_free_56:
    s_add_u32 m0, s55, 0x15000
    s_mov_b32 s57, 0x150000
    buffer_load_dwordx4 v40, s[68:71], s57 offen lds
    s_add_u32 m0, s55, 0x15400
    s_nop 0
    buffer_load_dwordx4 v41, s[68:71], s57 offen lds
    s_add_u32 m0, s55, 0x15800
    s_nop 0
    buffer_load_dwordx4 v42, s[68:71], s57 offen lds
    s_add_u32 m0, s55, 0x15c00
    s_nop 0
    buffer_load_dwordx4 v43, s[68:71], s57 offen lds
    s_add_u32 m0, s55, 0x16000
    s_nop 0
    buffer_load_dwordx4 v44, s[68:71], s57 offen lds
    s_add_u32 m0, s55, 0x16400
    s_nop 0
    buffer_load_dwordx4 v45, s[68:71], s57 offen lds
    s_add_u32 m0, s55, 0x16800
    s_nop 0
    buffer_load_dwordx4 v46, s[68:71], s57 offen lds
    s_add_u32 m0, s55, 0x16c00
    s_mov_b32 s57, 0x16c000
    buffer_load_dwordx4 v40, s[68:71], s57 offen lds
    s_add_u32 m0, s55, 0x17000
    s_nop 0
    buffer_load_dwordx4 v41, s[68:71], s57 offen lds
    s_add_u32 m0, s55, 0x17400
    s_nop 0
    buffer_load_dwordx4 v42, s[68:71], s57 offen lds
    s_add_u32 m0, s55, 0x17800
    s_nop 0
    buffer_load_dwordx4 v43, s[68:71], s57 offen lds
    s_add_u32 m0, s55, 0x17c00
    s_nop 0
    buffer_load_dwordx4 v44, s[68:71], s57 offen lds
    s_add_u32 m0, s55, 0x18000
    s_nop 0
    buffer_load_dwordx4 v45, s[68:71], s57 offen lds
    s_add_u32 m0, s55, 0x18400
    s_nop 0
    buffer_load_dwordx4 v46, s[68:71], s57 offen lds
    s_waitcnt vmcnt(14)
    v_mov_b32 v12, 23
    s_mov_b64 exec, 1
    ds_max_u32 v5, v12 offset:0
    s_mov_b64 exec, -1
    s_mov_b64 exec, 1
    ds_read_b128 v[8:11], v4 offset:16
    ds_read_b128 v[20:23], v4 offset:32
    s_waitcnt lgkmcnt(0)
    v_min3_u32 v8, v8, v9, v10
    v_min3_u32 v20, v20, v21, v22
    v_min3_u32 v8, v8, v20, v23
    v_min_u32 v8, v8, v11
    s_nop 0
    v_readfirstlane_b32 s60, v8
    s_mov_b64 exec, -1
    s_cmp_ge_u32 s60, 20
    s_cbranch_scc1 L_sequential_preLN__sliding_local_dilated__mixer_s_mlp__prompt_kernel_free_59
    s_waitcnt vmcnt(0)
    v_mov_b32 v12, 24
    s_mov_b64 exec, 1
    ds_max_u32 v5, v12 offset:0
    s_mov_b64 exec, -1
    s_cmp_lt_u32 s60, 20
    s_cbranch_scc1 L_sequential_preLN__sliding_local_dilated__mixer_s_mlp__prompt_kernel_lws_61
L_sequential_preLN__sliding_local_dilated__mixer_s_mlp__prompt_kernel_lwb_60:
L_sequential_preLN__sliding_local_dilated__mixer_s_mlp__prompt_kernel_free_59:
    s_mov_b32 s68, s18
    s_mov_b32 s69, s19
    s_mov_b32 s70, 0x1c0000
    s_add_u32 m0, s53, 0x1c000
    s_mov_b32 s57, 0x0
    buffer_load_dwordx4 v38, s[68:71], s57 offen lds
    s_add_u32 m0, s53, 0x1c800
    s_mov_b32 s57, 0x4000
    buffer_load_dwordx4 v38, s[68:71], s57 offen lds
    s_add_u32 m0, s53, 0x1d000
    s_mov_b32 s57, 0x8000
    buffer_load_dwordx4 v38, s[68:71], s57 offen lds
    s_add_u32 m0, s53, 0x1d800
    s_mov_b32 s57, 0xc000
    buffer_load_dwordx4 v38, s[68:71], s57 offen lds
    s_add_u32 m0, s53, 0x1e000
    s_mov_b32 s57, 0x10000
    buffer_load_dwordx4 v38, s[68:71], s57 offen lds
    s_add_u32 m0, s53, 0x1e800
    s_mov_b32 s57, 0x14000
    buffer_load_dwordx4 v38, s[68:71], s57 offen lds
    s_add_u32 m0, s53, 0x1f000
    s_mov_b32 s57, 0x18000
    buffer_load_dwordx4 v38, s[68:71], s57 offen lds
    s_add_u32 m0, s53, 0x1f800
    s_mov_b32 s57, 0x34000
    buffer_load_dwordx4 v38, s[68:71], s57 offen lds
    s_mov_b64 exec, 1
    ds_read_b128 v[8:11], v4 offset:16
    ds_read_b128 v[20:23], v4 offset:32
    s_waitcnt lgkmcnt(0)
    v_min3_u32 v8, v8, v9, v10
    v_min3_u32 v20, v20, v21, v22
    v_min3_u32 v8, v8, v20, v23
    v_min_u32 v8, v8, v11
    s_nop 0
    v_readfirstlane_b32 s60, v8
    s_mov_b64 exec, -1
    s_cmp_ge_u32 s60, 12
    s_cbranch_scc1 L_sequential_preLN__sliding_local_dilated__mixer_s_mlp__prompt_kernel_free_62
    s_waitcnt vmcnt(8)
    v_mov_b32 v12, 24
    s_mov_b64 exec, 1
    ds_max_u32 v5, v12 offset:0
    s_mov_b64 exec, -1
    s_waitcnt vmcnt(0)
    v_mov_b32 v12, 25
    s_mov_b64 exec, 1
    ds_max_u32 v5, v12 offset:0
    s_mov_b64 exec, -1
    s_cmp_lt_u32 s60, 12
    s_cbranch_scc1 L_sequential_preLN__sliding_local_dilated__mixer_s_mlp__prompt_kernel_lws_64
L_sequential_preLN__sliding_local_dilated__mixer_s_mlp__prompt_kernel_lwb_63:
L_sequential_preLN__sliding_local_dilated__mixer_s_mlp__prompt_kernel_free_62:
    s_add_u32 m0, s53, 0x20000
    s_mov_b32 s57, 0x1c000
    buffer_load_dwordx4 v38, s[68:71], s57 offen lds
    s_add_u32 m0, s53, 0x20800
    s_mov_b32 s57, 0x20000
    buffer_load_dwordx4 v38, s[68:71], s57 offen lds
    s_add_u32 m0, s53, 0x21000
    s_mov_b32 s57, 0x24000
    buffer_load_dwordx4 v38, s[68:71], s57 offen lds
    s_add_u32 m0, s53, 0x21800
    s_mov_b32 s57, 0x28000
    buffer_load_dwordx4 v38, s[68:71], s57 offen lds
    s_add_u32 m0, s53, 0x22000
    s_mov_b32 s57, 0x2c000
    buffer_load_dwordx4 v38, s[68:71], s57 offen lds
    s_add_u32 m0, s53, 0x22800
    s_mov_b32 s57, 0x30000
    buffer_load_dwordx4 v38, s[68:71], s57 offen lds
    s_add_u32 m0, s53, 0x23000
    s_mov_b32 s57, 0x38000
    buffer_load_dwordx4 v38, s[68:71], s57 offen lds
    s_add_u32 m0, s53, 0x23800
    s_mov_b32 s57, 0x3c000
    buffer_load_dwordx4 v38, s[68:71], s57 offen lds
    s_waitcnt vmcnt(16)
    v_mov_b32 v12, 24
    s_mov_b64 exec, 1
    ds_max_u32 v5, v12 offset:0
    s_mov_b64 exec, -1
    s_mov_b64 exec, 1
    ds_read_b128 v[8:11], v4 offset:16
    ds_read_b128 v[20:23], v4 offset:32
    s_waitcnt lgkmcnt(0)
    v_min3_u32 v8, v8, v9, v10
    v_min3_u32 v20, v20, v21, v22
    v_min3_u32 v8, v8, v20, v23
    v_min_u32 v8, v8, v11
    s_nop 0
    v_readfirstlane_b32 s60, v8
    s_mov_b64 exec, -1
    s_cmp_ge_u32 s60, 21
    s_cbranch_scc1 L_sequential_preLN__sliding_local_dilated__mixer_s_mlp__prompt_kernel_free_65
    s_waitcnt vmcnt(8)
    v_mov_b32 v12, 25
    s_mov_b64 exec, 1
    ds_max_u32 v5, v12 offset:0
    s_mov_b64 exec, -1
    s_waitcnt vmcnt(0)
    v_mov_b32 v12, 26
    s_mov_b64 exec, 1
    ds_max_u32 v5, v12 offset:0
    s_mov_b64 exec, -1
    s_cmp_lt_u32 s60, 21
    s_cbranch_scc1 L_sequential_preLN__sliding_local_dilated__mixer_s_mlp__prompt_kernel_lws_67
L_sequential_preLN__sliding_local_dilated__mixer_s_mlp__prompt_kernel_lwb_66:
L_sequential_preLN__sliding_local_dilated__mixer_s_mlp__prompt_kernel_free_65:
    s_add_u32 m0, s53, 0x0
    s_mov_b32 s57, 0x40000
    buffer_load_dwordx4 v38, s[68:71], s57 offen lds
    s_add_u32 m0, s53, 0x800
    s_mov_b32 s57, 0x44000
    buffer_load_dwordx4 v38, s[68:71], s57 offen lds
    s_add_u32 m0, s53, 0x1000
    s_mov_b32 s57, 0x48000
    buffer_load_dwordx4 v38, s[68:71], s57 offen lds
    s_add_u32 m0, s53, 0x1800
    s_mov_b32 s57, 0x4c000
    buffer_load_dwordx4 v38, s[68:71], s57 offen lds
    s_add_u32 m0, s53, 0x2000
    s_mov_b32 s57, 0x50000
    buffer_load_dwordx4 v38, s[68:71], s57 offen lds
    s_add_u32 m0, s53, 0x2800
    s_mov_b32 s57, 0x6c000
    buffer_load_dwordx4 v38, s[68:71], s57 offen lds
    s_add_u32 m0, s53, 0x3000
    s_mov_b32 s57, 0x54000
    buffer_load_dwordx4 v38, s[68:71], s57 offen lds
    s_add_u32 m0, s53, 0x3800
    s_mov_b32 s57, 0x58000
    buffer_load_dwordx4 v38, s[68:71], s57 offen lds
    s_waitcnt vmcnt(16)
    v_mov_b32 v12, 25
    s_mov_b64 exec, 1
    ds_max_u32 v5, v12 offset:0
    s_mov_b64 exec, -1
    s_mov_b64 exec, 1
    ds_read_b128 v[8:11], v4 offset:16
    ds_read_b128 v[20:23], v4 offset:32
    s_waitcnt lgkmcnt(0)
    v_min3_u32 v8, v8, v9, v10
    v_min3_u32 v20, v20, v21, v22
    v_min3_u32 v8, v8, v20, v23
    v_min_u32 v8, v8, v11
    s_nop 0
    v_readfirstlane_b32 s60, v8
    s_mov_b64 exec, -1
    s_cmp_ge_u32 s60, 22
    s_cbranch_scc1 L_sequential_preLN__sliding_local_dilated__mixer_s_mlp__prompt_kernel_free_68
    s_waitcnt vmcnt(8)
    v_mov_b32 v12, 26
    s_mov_b64 exec, 1
    ds_max_u32 v5, v12 offset:0
    s_mov_b64 exec, -1
    s_waitcnt vmcnt(0)
    v_mov_b32 v12, 27
    s_mov_b64 exec, 1
    ds_max_u32 v5, v12 offset:0
    s_mov_b64 exec, -1
    s_cmp_lt_u32 s60, 22
    s_cbranch_scc1 L_sequential_preLN__sliding_local_dilated__mixer_s_mlp__prompt_kernel_lws_70
L_sequential_preLN__sliding_local_dilated__mixer_s_mlp__prompt_kernel_lwb_69:
L_sequential_preLN__sliding_local_dilated__mixer_s_mlp__prompt_kernel_free_68:
    s_add_u32 m0, s53, 0x4000
    s_mov_b32 s57, 0x5c000
    buffer_load_dwordx4 v38, s[68:71], s57 offen lds
    s_add_u32 m0, s53, 0x4800
    s_mov_b32 s57, 0x60000
    buffer_load_dwordx4 v38, s[68:71], s57 offen lds
    s_add_u32 m0, s53, 0x5000
    s_mov_b32 s57, 0x64000
    buffer_load_dwordx4 v38, s[68:71], s57 offen lds
    s_add_u32 m0, s53, 0x5800
    s_mov_b32 s57, 0x68000
    buffer_load_dwordx4 v38, s[68:71], s57 offen lds
    s_add_u32 m0, s53, 0x6000
    s_mov_b32 s57, 0x70000
    buffer_load_dwordx4 v38, s[68:71], s57 offen lds
    s_add_u32 m0, s53, 0x6800
    s_mov_b32 s57, 0x74000
    buffer_load_dwordx4 v38, s[68:71], s57 offen lds
    s_add_u32 m0, s53, 0x7000
    s_mov_b32 s57, 0x78000
    buffer_load_dwordx4 v38, s[68:71], s57 offen lds
    s_add_u32 m0, s53, 0x7800
    s_mov_b32 s57, 0x7c000
    buffer_load_dwordx4 v38, s[68:71], s57 offen lds
    s_waitcnt vmcnt(16)
    v_mov_b32 v12, 26
    s_mov_b64 exec, 1
    ds_max_u32 v5, v12 offset:0
    s_mov_b64 exec, -1
    s_mov_b64 exec, 1
    ds_read_b128 v[8:11], v4 offset:16
    ds_read_b128 v[20:23], v4 offset:32
    s_waitcnt lgkmcnt(0)
    v_min3_u32 v8, v8, v9, v10
    v_min3_u32 v20, v20, v21, v22
    v_min3_u32 v8, v8, v20, v23
    v_min_u32 v8, v8, v11
    s_nop 0
    v_readfirstlane_b32 s60, v8
    s_mov_b64 exec, -1
    s_cmp_ge_u32 s60, 22
    s_cbranch_scc1 L_sequential_preLN__sliding_local_dilated__mixer_s_mlp__prompt_kernel_free_71
    s_waitcnt vmcnt(8)
    v_mov_b32 v12, 27
    s_mov_b64 exec, 1
    ds_max_u32 v5, v12 offset:0
    s_mov_b64 exec, -1
    s_waitcnt vmcnt(0)
    v_mov_b32 v12, 28
    s_mov_b64 exec, 1
    ds_max_u32 v5, v12 offset:0
    s_mov_b64 exec, -1
    s_cmp_lt_u32 s60, 22
    s_cbranch_scc1 L_sequential_preLN__sliding_local_dilated__mixer_s_mlp__prompt_kernel_lws_73
L_sequential_preLN__sliding_local_dilated__mixer_s_mlp__prompt_kernel_lwb_72:
L_sequential_preLN__sliding_local_dilated__mixer_s_mlp__prompt_kernel_free_71:
    s_add_u32 m0, s53, 0x8000
    s_mov_b32 s57, 0x80000
    buffer_load_dwordx4 v38, s[68:71], s57 offen lds
    s_add_u32 m0, s53, 0x8800
    s_mov_b32 s57, 0x84000
    buffer_load_dwordx4 v38, s[68:71], s57 offen lds
    s_add_u32 m0, s53, 0x9000
    s_mov_b32 s57, 0x88000
    buffer_load_dwordx4 v38, s[68:71], s57 offen lds
    s_add_u32 m0, s53, 0x9800
    s_mov_b32 s57, 0xa4000
    buffer_load_dwordx4 v38, s[68:71], s57 offen lds
    s_add_u32 m0, s53, 0xa000
    s_mov_b32 s57, 0x8c000
    buffer_load_dwordx4 v38, s[68:71], s57 offen lds
    s_add_u32 m0, s53, 0xa800
    s_mov_b32 s57, 0x90000
    buffer_load_dwordx4 v38, s[68:71], s57 offen lds
    s_add_u32 m0, s53, 0xb000
    s_mov_b32 s57, 0x94000
    buffer_load_dwordx4 v38, s[68:71], s57 offen lds
    s_add_u32 m0, s53, 0xb800
    s_mov_b32 s57, 0x98000
    buffer_load_dwordx4 v38, s[68:71], s57 offen lds
    s_waitcnt vmcnt(16)
    v_mov_b32 v12, 27
    s_mov_b64 exec, 1
    ds_max_u32 v5, v12 offset:0
    s_mov_b64 exec, -1
    s_mov_b64 exec, 1
    ds_read_b128 v[8:11], v4 offset:16
    ds_read_b128 v[20:23], v4 offset:32
    s_waitcnt lgkmcnt(0)
    v_min3_u32 v8, v8, v9, v10
    v_min3_u32 v20, v20, v21, v22
    v_min3_u32 v8, v8, v20, v23
    v_min_u32 v8, v8, v11
    s_nop 0
    v_readfirstlane_b32 s60, v8
    s_mov_b64 exec, -1
    s_cmp_ge_u32 s60, 23
    s_cbranch_scc1 L_sequential_preLN__sliding_local_dilated__mixer_s_mlp__prompt_kernel_free_74
    s_waitcnt vmcnt(8)
    v_mov_b32 v12, 28
    s_mov_b64 exec, 1
    ds_max_u32 v5, v12 offset:0
    s_mov_b64 exec, -1
    s_waitcnt vmcnt(0)
    v_mov_b32 v12, 29
    s_mov_b64 exec, 1
    ds_max_u32 v5, v12 offset:0
    s_mov_b64 exec, -1
    s_cmp_lt_u32 s60, 23
    s_cbranch_scc1 L_sequential_preLN__sliding_local_dilated__mixer_s_mlp__prompt_kernel_lws_76
L_sequential_preLN__sliding_local_dilated__mixer_s_mlp__prompt_kernel_lwb_75:
L_sequential_preLN__sliding_local_dilated__mixer_s_mlp__prompt_kernel_free_74:
    s_add_u32 m0, s53, 0xc000
    s_mov_b32 s57, 0x9c000
    buffer_load_dwordx4 v38, s[68:71], s57 offen lds
    s_add_u32 m0, s53, 0xc800
    s_mov_b32 s57, 0xa0000
    buffer_load_dwordx4 v38, s[68:71], s57 offen lds
    s_add_u32 m0, s53, 0xd000
    s_mov_b32 s57, 0xa8000
    buffer_load_dwordx4 v38, s[68:71], s57 offen lds
    s_add_u32 m0, s53, 0xd800
    s_mov_b32 s57, 0xac000
    buffer_load_dwordx4 v38, s[68:71], s57 offen lds
    s_add_u32 m0, s53, 0xe000
    s_mov_b32 s57, 0xb0000
    buffer_load_dwordx4 v38, s[68:71], s57 offen lds
    s_add_u32 m0, s53, 0xe800
    s_mov_b32 s57, 0xb4000
    buffer_load_dwordx4 v38, s[68:71], s57 offen lds
    s_add_u32 m0, s53, 0xf000
    s_mov_b32 s57, 0xb8000
    buffer_load_dwordx4 v38, s[68:71], s57 offen lds
    s_add_u32 m0, s53, 0xf800
    s_mov_b32 s57, 0xbc000
    buffer_load_dwordx4 v38, s[68:71], s57 offen lds
    s_waitcnt vmcnt(16)
    v_mov_b32 v12, 28
    s_mov_b64 exec, 1
    ds_max_u32 v5, v12 offset:0
    s_mov_b64 exec, -1
    s_mov_b64 exec, 1
    ds_read_b128 v[8:11], v4 offset:16
    ds_read_b128 v[20:23], v4 offset:32
    s_waitcnt lgkmcnt(0)
    v_min3_u32 v8, v8, v9, v10
    v_min3_u32 v20, v20, v21, v22
    v_min3_u32 v8, v8, v20, v23
    v_min_u32 v8, v8, v11
    s_nop 0
    v_readfirstlane_b32 s60, v8
    s_mov_b64 exec, -1
    s_cmp_ge_u32 s60, 23
    s_cbranch_scc1 L_sequential_preLN__sliding_local_dilated__mixer_s_mlp__prompt_kernel_free_77
    s_waitcnt vmcnt(8)
    v_mov_b32 v12, 29
    s_mov_b64 exec, 1
    ds_max_u32 v5, v12 offset:0
    s_mov_b64 exec, -1
    s_waitcnt vmcnt(0)
    v_mov_b32 v12, 30
    s_mov_b64 exec, 1
    ds_max_u32 v5, v12 offset:0
    s_mov_b64 exec, -1
    s_cmp_lt_u32 s60, 23
    s_cbranch_scc1 L_sequential_preLN__sliding_local_dilated__mixer_s_mlp__prompt_kernel_lws_79
L_sequential_preLN__sliding_local_dilated__mixer_s_mlp__prompt_kernel_lwb_78:
L_sequential_preLN__sliding_local_dilated__mixer_s_mlp__prompt_kernel_free_77:
    s_add_u32 m0, s53, 0x10000
    s_mov_b32 s57, 0xc0000
    buffer_load_dwordx4 v38, s[68:71], s57 offen lds
    s_add_u32 m0, s53, 0x10800
    s_mov_b32 s57, 0xdc000
    buffer_load_dwordx4 v38, s[68:71], s57 offen lds
    s_add_u32 m0, s53, 0x11000
    s_mov_b32 s57, 0xc4000
    buffer_load_dwordx4 v38, s[68:71], s57 offen lds
    s_add_u32 m0, s53, 0x11800
    s_mov_b32 s57, 0xc8000
    buffer_load_dwordx4 v38, s[68:71], s57 offen lds
    s_add_u32 m0, s53, 0x12000
    s_mov_b32 s57, 0xcc000
    buffer_load_dwordx4 v38, s[68:71], s57 offen lds
    s_add_u32 m0, s53, 0x12800
    s_mov_b32 s57, 0xd0000
    buffer_load_dwordx4 v38, s[68:71], s57 offen lds
    s_add_u32 m0, s53, 0x13000
    s_mov_b32 s57, 0xd4000
    buffer_load_dwordx4 v38, s[68:71], s57 offen lds
    s_add_u32 m0, s53, 0x13800
    s_mov_b32 s57, 0xd8000
    buffer_load_dwordx4 v38, s[68:71], s57 offen lds
    s_waitcnt vmcnt(16)
    v_mov_b32 v12, 29
    s_mov_b64 exec, 1
    ds_max_u32 v5, v12 offset:0
    s_mov_b64 exec, -1
    s_mov_b64 exec, 1
    ds_read_b128 v[8:11], v4 offset:16
    ds_read_b128 v[20:23], v4 offset:32
    s_waitcnt lgkmcnt(0)
    v_min3_u32 v8, v8, v9, v10
    v_min3_u32 v20, v20, v21, v22
    v_min3_u32 v8, v8, v20, v23
    v_min_u32 v8, v8, v11
    s_nop 0
    v_readfirstlane_b32 s60, v8
    s_mov_b64 exec, -1
    s_cmp_ge_u32 s60, 24
    s_cbranch_scc1 L_sequential_preLN__sliding_local_dilated__mixer_s_mlp__prompt_kernel_free_80
    s_waitcnt vmcnt(8)
    v_mov_b32 v12, 30
    s_mov_b64 exec, 1
    ds_max_u32 v5, v12 offset:0
    s_mov_b64 exec, -1
    s_waitcnt vmcnt(0)
    v_mov_b32 v12, 31
    s_mov_b64 exec, 1
    ds_max_u32 v5, v12 offset:0
    s_mov_b64 exec, -1
    s_cmp_lt_u32 s60, 24
    s_cbranch_scc1 L_sequential_preLN__sliding_local_dilated__mixer_s_mlp__prompt_kernel_lws_82
L_sequential_preLN__sliding_local_dilated__mixer_s_mlp__prompt_kernel_lwb_81:
L_sequential_preLN__sliding_local_dilated__mixer_s_mlp__prompt_kernel_free_80:
    s_add_u32 m0, s53, 0x14000
    s_mov_b32 s57, 0xe0000
    buffer_load_dwordx4 v38, s[68:71], s57 offen lds
    s_add_u32 m0, s53, 0x14800
    s_mov_b32 s57, 0xe4000
    buffer_load_dwordx4 v38, s[68:71], s57 offen lds
    s_add_u32 m0, s53, 0x15000
    s_mov_b32 s57, 0xe8000
    buffer_load_dwordx4 v38, s[68:71], s57 offen lds
    s_add_u32 m0, s53, 0x15800
    s_mov_b32 s57, 0xec000
    buffer_load_dwordx4 v38, s[68:71], s57 offen lds
    s_add_u32 m0, s53, 0x16000
    s_mov_b32 s57, 0xf0000
    buffer_load_dwordx4 v38, s[68:71], s57 offen lds
    s_add_u32 m0, s53, 0x16800
    s_mov_b32 s57, 0xf4000
    buffer_load_dwordx4 v38, s[68:71], s57 offen lds
    s_add_u32 m0, s53, 0x17000
    s_mov_b32 s57, 0xf8000
    buffer_load_dwordx4 v38, s[68:71], s57 offen lds
    s_add_u32 m0, s53, 0x17800
    s_mov_b32 s57, 0x114000
    buffer_load_dwordx4 v38, s[68:71], s57 offen lds
    s_waitcnt vmcnt(16)
    v_mov_b32 v12, 30
    s_mov_b64 exec, 1
    ds_max_u32 v5, v12 offset:0
    s_mov_b64 exec, -1
    s_mov_b64 exec, 1
    ds_read_b128 v[8:11], v4 offset:16
    ds_read_b128 v[20:23], v4 offset:32
    s_waitcnt lgkmcnt(0)
    v_min3_u32 v8, v8, v9, v10
    v_min3_u32 v20, v20, v21, v22
    v_min3_u32 v8, v8, v20, v23
    v_min_u32 v8, v8, v11
    s_nop 0
    v_readfirstlane_b32 s60, v8
    s_mov_b64 exec, -1
    s_cmp_ge_u32 s60, 24
    s_cbranch_scc1 L_sequential_preLN__sliding_local_dilated__mixer_s_mlp__prompt_kernel_free_83
    s_waitcnt vmcnt(8)
    v_mov_b32 v12, 31
    s_mov_b64 exec, 1
    ds_max_u32 v5, v12 offset:0
    s_mov_b64 exec, -1
    s_waitcnt vmcnt(0)
    v_mov_b32 v12, 32
    s_mov_b64 exec, 1
    ds_max_u32 v5, v12 offset:0
    s_mov_b64 exec, -1
    s_cmp_lt_u32 s60, 24
    s_cbranch_scc1 L_sequential_preLN__sliding_local_dilated__mixer_s_mlp__prompt_kernel_lws_85
L_sequential_preLN__sliding_local_dilated__mixer_s_mlp__prompt_kernel_lwb_84:
L_sequential_preLN__sliding_local_dilated__mixer_s_mlp__prompt_kernel_free_83:
    s_add_u32 m0, s53, 0x18000
    s_mov_b32 s57, 0xfc000
    buffer_load_dwordx4 v38, s[68:71], s57 offen lds
    s_add_u32 m0, s53, 0x18800
    s_mov_b32 s57, 0x100000
    buffer_load_dwordx4 v38, s[68:71], s57 offen lds
    s_add_u32 m0, s53, 0x19000
    s_mov_b32 s57, 0x104000
    buffer_load_dwordx4 v38, s[68:71], s57 offen lds
    s_add_u32 m0, s53, 0x19800
    s_mov_b32 s57, 0x108000
    buffer_load_dwordx4 v38, s[68:71], s57 offen lds
    s_add_u32 m0, s53, 0x1a000
    s_mov_b32 s57, 0x10c000
    buffer_load_dwordx4 v38, s[68:71], s57 offen lds
    s_add_u32 m0, s53, 0x1a800
    s_mov_b32 s57, 0x110000
    buffer_load_dwordx4 v38, s[68:71], s57 offen lds
    s_add_u32 m0, s53, 0x1b000
    s_mov_b32 s57, 0x118000
    buffer_load_dwordx4 v38, s[68:71], s57 offen lds
    s_add_u32 m0, s53, 0x1b800
    s_mov_b32 s57, 0x11c000
    buffer_load_dwordx4 v38, s[68:71], s57 offen lds
    s_waitcnt vmcnt(16)
    v_mov_b32 v12, 31
    s_mov_b64 exec, 1
    ds_max_u32 v5, v12 offset:0
    s_mov_b64 exec, -1
    s_mov_b64 exec, 1
    ds_read_b128 v[8:11], v4 offset:16
    ds_read_b128 v[20:23], v4 offset:32
    s_waitcnt lgkmcnt(0)
    v_min3_u32 v8, v8, v9, v10
    v_min3_u32 v20, v20, v21, v22
    v_min3_u32 v8, v8, v20, v23
    v_min_u32 v8, v8, v11
    s_nop 0
    v_readfirstlane_b32 s60, v8
    s_mov_b64 exec, -1
    s_cmp_ge_u32 s60, 25
    s_cbranch_scc1 L_sequential_preLN__sliding_local_dilated__mixer_s_mlp__prompt_kernel_free_86
    s_waitcnt vmcnt(8)
    v_mov_b32 v12, 32
    s_mov_b64 exec, 1
    ds_max_u32 v5, v12 offset:0
    s_mov_b64 exec, -1
    s_waitcnt vmcnt(0)
    v_mov_b32 v12, 33
    s_mov_b64 exec, 1
    ds_max_u32 v5, v12 offset:0
    s_mov_b64 exec, -1
    s_cmp_lt_u32 s60, 25
    s_cbranch_scc1 L_sequential_preLN__sliding_local_dilated__mixer_s_mlp__prompt_kernel_lws_88
L_sequential_preLN__sliding_local_dilated__mixer_s_mlp__prompt_kernel_lwb_87:
L_sequential_preLN__sliding_local_dilated__mixer_s_mlp__prompt_kernel_free_86:
    s_add_u32 m0, s53, 0x1c000
    s_mov_b32 s57, 0x120000
    buffer_load_dwordx4 v38, s[68:71], s57 offen lds
    s_add_u32 m0, s53, 0x1c800
    s_mov_b32 s57, 0x124000
    buffer_load_dwordx4 v38, s[68:71], s57 offen lds
    s_add_u32 m0, s53, 0x1d000
    s_mov_b32 s57, 0x128000
    buffer_load_dwordx4 v38, s[68:71], s57 offen lds
    s_add_u32 m0, s53, 0x1d800
    s_mov_b32 s57, 0x12c000
    buffer_load_dwordx4 v38, s[68:71], s57 offen lds
    s_add_u32 m0, s53, 0x1e000
    s_mov_b32 s57, 0x130000
    buffer_load_dwordx4 v38, s[68:71], s57 offen lds
    s_add_u32 m0, s53, 0x1e800
    s_mov_b32 s57, 0x14c000
    buffer_load_dwordx4 v38, s[68:71], s57 offen lds
    s_add_u32 m0, s53, 0x1f000
    s_mov_b32 s57, 0x134000
    buffer_load_dwordx4 v38, s[68:71], s57 offen lds
    s_add_u32 m0, s53, 0x1f800
    s_mov_b32 s57, 0x138000
    buffer_load_dwordx4 v38, s[68:71], s57 offen lds
    s_waitcnt vmcnt(16)
    v_mov_b32 v12, 32
    s_mov_b64 exec, 1
    ds_max_u32 v5, v12 offset:0
    s_mov_b64 exec, -1
    s_mov_b64 exec, 1
    ds_read_b128 v[8:11], v4 offset:16
    ds_read_b128 v[20:23], v4 offset:32
    s_waitcnt lgkmcnt(0)
    v_min3_u32 v8, v8, v9, v10
    v_min3_u32 v20, v20, v21, v22
    v_min3_u32 v8, v8, v20, v23
    v_min_u32 v8, v8, v11
    s_nop 0
    v_readfirstlane_b32 s60, v8
    s_mov_b64 exec, -1
    s_cmp_ge_u32 s60, 26
    s_cbranch_scc1 L_sequential_preLN__sliding_local_dilated__mixer_s_mlp__prompt_kernel_free_89
    s_waitcnt vmcnt(8)
    v_mov_b32 v12, 33
    s_mov_b64 exec, 1
    ds_max_u32 v5, v12 offset:0
    s_mov_b64 exec, -1
    s_waitcnt vmcnt(0)
    v_mov_b32 v12, 34
    s_mov_b64 exec, 1
    ds_max_u32 v5, v12 offset:0
    s_mov_b64 exec, -1
    s_cmp_lt_u32 s60, 26
    s_cbranch_scc1 L_sequential_preLN__sliding_local_dilated__mixer_s_mlp__prompt_kernel_lws_91
L_sequential_preLN__sliding_local_dilated__mixer_s_mlp__prompt_kernel_lwb_90:
L_sequential_preLN__sliding_local_dilated__mixer_s_mlp__prompt_kernel_free_89:
    s_add_u32 m0, s53, 0x20000
    s_mov_b32 s57, 0x13c000
    buffer_load_dwordx4 v38, s[68:71], s57 offen lds
    s_add_u32 m0, s53, 0x20800
    s_mov_b32 s57, 0x140000
    buffer_load_dwordx4 v38, s[68:71], s57 offen lds
    s_add_u32 m0, s53, 0x21000
    s_mov_b32 s57, 0x144000
    buffer_load_dwordx4 v38, s[68:71], s57 offen lds
    s_add_u32 m0, s53, 0x21800
    s_mov_b32 s57, 0x148000
    buffer_load_dwordx4 v38, s[68:71], s57 offen lds
    s_add_u32 m0, s53, 0x22000
    s_mov_b32 s57, 0x150000
    buffer_load_dwordx4 v38, s[68:71], s57 offen lds
    s_add_u32 m0, s53, 0x22800
    s_mov_b32 s57, 0x154000
    buffer_load_dwordx4 v38, s[68:71], s57 offen lds
    s_add_u32 m0, s53, 0x23000
    s_mov_b32 s57, 0x158000
    buffer_load_dwordx4 v38, s[68:71], s57 offen lds
    s_add_u32 m0, s53, 0x23800
    s_mov_b32 s57, 0x15c000
    buffer_load_dwordx4 v38, s[68:71], s57 offen lds
    s_waitcnt vmcnt(16)
    v_mov_b32 v12, 33
    s_mov_b64 exec, 1
    ds_max_u32 v5, v12 offset:0
    s_mov_b64 exec, -1
    s_mov_b64 exec, 1
    ds_read_b128 v[8:11], v4 offset:16
    ds_read_b128 v[20:23], v4 offset:32
    s_waitcnt lgkmcnt(0)
    v_min3_u32 v8, v8, v9, v10
    v_min3_u32 v20, v20, v21, v22
    v_min3_u32 v8, v8, v20, v23
    v_min_u32 v8, v8, v11
    s_nop 0
    v_readfirstlane_b32 s60, v8
    s_mov_b64 exec, -1
    s_cmp_ge_u32 s60, 27
    s_cbranch_scc1 L_sequential_preLN__sliding_local_dilated__mixer_s_mlp__prompt_kernel_free_92
    s_waitcnt vmcnt(8)
    v_mov_b32 v12, 34
    s_mov_b64 exec, 1
    ds_max_u32 v5, v12 offset:0
    s_mov_b64 exec, -1
    s_waitcnt vmcnt(0)
    v_mov_b32 v12, 35
    s_mov_b64 exec, 1
    ds_max_u32 v5, v12 offset:0
    s_mov_b64 exec, -1
    s_cmp_lt_u32 s60, 27
    s_cbranch_scc1 L_sequential_preLN__sliding_local_dilated__mixer_s_mlp__prompt_kernel_lws_94
L_sequential_preLN__sliding_local_dilated__mixer_s_mlp__prompt_kernel_lwb_93:
L_sequential_preLN__sliding_local_dilated__mixer_s_mlp__prompt_kernel_free_92:
    s_add_u32 m0, s53, 0x0
    s_mov_b32 s57, 0x160000
    buffer_load_dwordx4 v38, s[68:71], s57 offen lds
    s_add_u32 m0, s53, 0x800
    s_mov_b32 s57, 0x164000
    buffer_load_dwordx4 v38, s[68:71], s57 offen lds
    s_add_u32 m0, s53, 0x1000
    s_mov_b32 s57, 0x168000
    buffer_load_dwordx4 v38, s[68:71], s57 offen lds
    s_add_u32 m0, s53, 0x1800
    s_mov_b32 s57, 0x184000
    buffer_load_dwordx4 v38, s[68:71], s57 offen lds
    s_add_u32 m0, s53, 0x2000
    s_mov_b32 s57, 0x16c000
    buffer_load_dwordx4 v38, s[68:71], s57 offen lds
    s_add_u32 m0, s53, 0x2800
    s_mov_b32 s57, 0x170000
    buffer_load_dwordx4 v38, s[68:71], s57 offen lds
    s_add_u32 m0, s53, 0x3000
    s_mov_b32 s57, 0x174000
    buffer_load_dwordx4 v38, s[68:71], s57 offen lds
    s_add_u32 m0, s53, 0x3800
    s_mov_b32 s57, 0x178000
    buffer_load_dwordx4 v38, s[68:71], s57 offen lds
    s_waitcnt vmcnt(16)
    v_mov_b32 v12, 34
    s_mov_b64 exec, 1
    ds_max_u32 v5, v12 offset:0
    s_mov_b64 exec, -1
    s_mov_b64 exec, 1
    ds_read_b128 v[8:11], v4 offset:16
    ds_read_b128 v[20:23], v4 offset:32
    s_waitcnt lgkmcnt(0)
    v_min3_u32 v8, v8, v9, v10
    v_min3_u32 v20, v20, v21, v22
    v_min3_u32 v8, v8, v20, v23
    v_min_u32 v8, v8, v11
    s_nop 0
    v_readfirstlane_b32 s60, v8
    s_mov_b64 exec, -1
    s_cmp_ge_u32 s60, 28
    s_cbranch_scc1 L_sequential_preLN__sliding_local_dilated__mixer_s_mlp__prompt_kernel_free_95
    s_waitcnt vmcnt(8)
    v_mov_b32 v12, 35
    s_mov_b64 exec, 1
    ds_max_u32 v5, v12 offset:0
    s_mov_b64 exec, -1
    s_waitcnt vmcnt(0)
    v_mov_b32 v12, 36
    s_mov_b64 exec, 1
    ds_max_u32 v5, v12 offset:0
    s_mov_b64 exec, -1
    s_cmp_lt_u32 s60, 28
    s_cbranch_scc1 L_sequential_preLN__sliding_local_dilated__mixer_s_mlp__prompt_kernel_lws_97
L_sequential_preLN__sliding_local_dilated__mixer_s_mlp__prompt_kernel_lwb_96:
L_sequential_preLN__sliding_local_dilated__mixer_s_mlp__prompt_kernel_free_95:
    s_add_u32 m0, s53, 0x4000
    s_mov_b32 s57, 0x17c000
    buffer_load_dwordx4 v38, s[68:71], s57 offen lds
    s_add_u32 m0, s53, 0x4800
    s_mov_b32 s57, 0x180000
    buffer_load_dwordx4 v38, s[68:71], s57 offen lds
    s_add_u32 m0, s53, 0x5000
    s_mov_b32 s57, 0x188000
    buffer_load_dwordx4 v38, s[68:71], s57 offen lds
    s_add_u32 m0, s53, 0x5800
    s_mov_b32 s57, 0x18c000
    buffer_load_dwordx4 v38, s[68:71], s57 offen lds
    s_add_u32 m0, s53, 0x6000
    s_mov_b32 s57, 0x190000
    buffer_load_dwordx4 v38, s[68:71], s57 offen lds
    s_add_u32 m0, s53, 0x6800
    s_mov_b32 s57, 0x194000
    buffer_load_dwordx4 v38, s[68:71], s57 offen lds
    s_add_u32 m0, s53, 0x7000
    s_mov_b32 s57, 0x198000
    buffer_load_dwordx4 v38, s[68:71], s57 offen lds
    s_add_u32 m0, s53, 0x7800
    s_mov_b32 s57, 0x19c000
    buffer_load_dwordx4 v38, s[68:71], s57 offen lds
    s_waitcnt vmcnt(16)
    v_mov_b32 v12, 35
    s_mov_b64 exec, 1
    ds_max_u32 v5, v12 offset:0
    s_mov_b64 exec, -1
    s_mov_b64 exec, 1
    ds_read_b128 v[8:11], v4 offset:16
    ds_read_b128 v[20:23], v4 offset:32
    s_waitcnt lgkmcnt(0)
    v_min3_u32 v8, v8, v9, v10
    v_min3_u32 v20, v20, v21, v22
    v_min3_u32 v8, v8, v20, v23
    v_min_u32 v8, v8, v11
    s_nop 0
    v_readfirstlane_b32 s60, v8
    s_mov_b64 exec, -1
    s_cmp_ge_u32 s60, 29
    s_cbranch_scc1 L_sequential_preLN__sliding_local_dilated__mixer_s_mlp__prompt_kernel_free_98
    s_waitcnt vmcnt(8)
    v_mov_b32 v12, 36
    s_mov_b64 exec, 1
    ds_max_u32 v5, v12 offset:0
    s_mov_b64 exec, -1
    s_waitcnt vmcnt(0)
    v_mov_b32 v12, 37
    s_mov_b64 exec, 1
    ds_max_u32 v5, v12 offset:0
    s_mov_b64 exec, -1
    s_cmp_lt_u32 s60, 29
    s_cbranch_scc1 L_sequential_preLN__sliding_local_dilated__mixer_s_mlp__prompt_kernel_lws_100
L_sequential_preLN__sliding_local_dilated__mixer_s_mlp__prompt_kernel_lwb_99:
L_sequential_preLN__sliding_local_dilated__mixer_s_mlp__prompt_kernel_free_98:
    s_add_u32 m0, s53, 0x8000
    s_mov_b32 s57, 0x1a0000
    buffer_load_dwordx4 v38, s[68:71], s57 offen lds
    s_add_u32 m0, s53, 0x8800
    s_mov_b32 s57, 0x1bc000
    buffer_load_dwordx4 v38, s[68:71], s57 offen lds
    s_add_u32 m0, s53, 0x9000
    s_mov_b32 s57, 0x1a4000
    buffer_load_dwordx4 v38, s[68:71], s57 offen lds
    s_add_u32 m0, s53, 0x9800
    s_mov_b32 s57, 0x1a8000
    buffer_load_dwordx4 v38, s[68:71], s57 offen lds
    s_add_u32 m0, s53, 0xa000
    s_mov_b32 s57, 0x1ac000
    buffer_load_dwordx4 v38, s[68:71], s57 offen lds
    s_add_u32 m0, s53, 0xa800
    s_mov_b32 s57, 0x1b0000
    buffer_load_dwordx4 v38, s[68:71], s57 offen lds
    s_add_u32 m0, s53, 0xb000
    s_mov_b32 s57, 0x1b4000
    buffer_load_dwordx4 v38, s[68:71], s57 offen lds
    s_add_u32 m0, s53, 0xb800
    s_mov_b32 s57, 0x1b8000
    buffer_load_dwordx4 v38, s[68:71], s57 offen lds
    s_waitcnt vmcnt(16)
    v_mov_b32 v12, 36
    s_mov_b64 exec, 1
    ds_max_u32 v5, v12 offset:0
    s_mov_b64 exec, -1
    s_waitcnt vmcnt(8)
    v_mov_b32 v12, 37
    s_mov_b64 exec, 1
    ds_max_u32 v5, v12 offset:0
    s_mov_b64 exec, -1
    s_waitcnt vmcnt(0)
    v_mov_b32 v12, 38
    s_mov_b64 exec, 1
    ds_max_u32 v5, v12 offset:0
    s_mov_b64 exec, -1
    s_waitcnt lgkmcnt(0)
    s_endpgm
L_sequential_preLN__sliding_local_dilated__mixer_s_mlp__prompt_kernel_lws_4:
    s_movk_i32 s42, 1
    s_call_b64 s[44:45], L_wait_l_16_60_0
    s_branch L_sequential_preLN__sliding_local_dilated__mixer_s_mlp__prompt_kernel_lwb_3
L_sequential_preLN__sliding_local_dilated__mixer_s_mlp__prompt_kernel_lws_7:
    s_movk_i32 s42, 2
    s_call_b64 s[44:45], L_wait_l_16_60_0
    s_branch L_sequential_preLN__sliding_local_dilated__mixer_s_mlp__prompt_kernel_lwb_6
L_sequential_preLN__sliding_local_dilated__mixer_s_mlp__prompt_kernel_lws_10:
    s_movk_i32 s42, 3
    s_call_b64 s[44:45], L_wait_l_16_60_0
    s_branch L_sequential_preLN__sliding_local_dilated__mixer_s_mlp__prompt_kernel_lwb_9
L_sequential_preLN__sliding_local_dilated__mixer_s_mlp__prompt_kernel_lws_13:
    s_movk_i32 s42, 4
    s_call_b64 s[44:45], L_wait_l_16_60_0
    s_branch L_sequential_preLN__sliding_local_dilated__mixer_s_mlp__prompt_kernel_lwb_12
L_sequential_preLN__sliding_local_dilated__mixer_s_mlp__prompt_kernel_lws_16:
    s_movk_i32 s42, 5
    s_call_b64 s[44:45], L_wait_l_16_60_0
    s_branch L_sequential_preLN__sliding_local_dilated__mixer_s_mlp__prompt_kernel_lwb_15
L_sequential_preLN__sliding_local_dilated__mixer_s_mlp__prompt_kernel_lws_19:
    s_movk_i32 s42, 5
    s_call_b64 s[44:45], L_wait_l_16_60_0
    s_branch L_sequential_preLN__sliding_local_dilated__mixer_s_mlp__prompt_kernel_lwb_18
L_sequential_preLN__sliding_local_dilated__mixer_s_mlp__prompt_kernel_lws_22:
    s_movk_i32 s42, 5
    s_call_b64 s[44:45], L_wait_l_16_60_0
    s_branch L_sequential_preLN__sliding_local_dilated__mixer_s_mlp__prompt_kernel_lwb_21
L_sequential_preLN__sliding_local_dilated__mixer_s_mlp__prompt_kernel_lws_25:
    s_movk_i32 s42, 6
    s_call_b64 s[44:45], L_wait_l_16_60_0
    s_branch L_sequential_preLN__sliding_local_dilated__mixer_s_mlp__prompt_kernel_lwb_24
L_sequential_preLN__sliding_local_dilated__mixer_s_mlp__prompt_kernel_lws_28:
    s_movk_i32 s42, 7
    s_call_b64 s[44:45], L_wait_l_16_60_0
    s_branch L_sequential_preLN__sliding_local_dilated__mixer_s_mlp__prompt_kernel_lwb_27
L_sequential_preLN__sliding_local_dilated__mixer_s_mlp__prompt_kernel_lws_31:
    s_movk_i32 s42, 7
    s_call_b64 s[44:45], L_wait_l_16_60_0
    s_branch L_sequential_preLN__sliding_local_dilated__mixer_s_mlp__prompt_kernel_lwb_30
L_sequential_preLN__sliding_local_dilated__mixer_s_mlp__prompt_kernel_lws_34:
    s_movk_i32 s42, 8
    s_call_b64 s[44:45], L_wait_l_16_60_0
    s_branch L_sequential_preLN__sliding_local_dilated__mixer_s_mlp__prompt_kernel_lwb_33
L_sequential_preLN__sliding_local_dilated__mixer_s_mlp__prompt_kernel_lws_37:
    s_movk_i32 s42, 8
    s_call_b64 s[44:45], L_wait_l_16_60_0
    s_branch L_sequential_preLN__sliding_local_dilated__mixer_s_mlp__prompt_kernel_lwb_36
L_sequential_preLN__sliding_local_dilated__mixer_s_mlp__prompt_kernel_lws_40:
    s_movk_i32 s42, 9
    s_call_b64 s[44:45], L_wait_l_16_60_0
    s_branch L_sequential_preLN__sliding_local_dilated__mixer_s_mlp__prompt_kernel_lwb_39
L_sequential_preLN__sliding_local_dilated__mixer_s_mlp__prompt_kernel_lws_43:
    s_movk_i32 s42, 10
    s_call_b64 s[44:45], L_wait_l_16_60_0
    s_branch L_sequential_preLN__sliding_local_dilated__mixer_s_mlp__prompt_kernel_lwb_42
L_sequential_preLN__sliding_local_dilated__mixer_s_mlp__prompt_kernel_lws_46:
    s_movk_i32 s42, 11
    s_call_b64 s[44:45], L_wait_l_16_60_0
    s_branch L_sequential_preLN__sliding_local_dilated__mixer_s_mlp__prompt_kernel_lwb_45
L_sequential_preLN__sliding_local_dilated__mixer_s_mlp__prompt_kernel_lws_49:
    s_movk_i32 s42, 14
    s_call_b64 s[44:45], L_wait_l_16_60_0
    s_branch L_sequential_preLN__sliding_local_dilated__mixer_s_mlp__prompt_kernel_lwb_48
L_sequential_preLN__sliding_local_dilated__mixer_s_mlp__prompt_kernel_lws_52:
    s_movk_i32 s42, 16
    s_call_b64 s[44:45], L_wait_l_16_60_0
    s_branch L_sequential_preLN__sliding_local_dilated__mixer_s_mlp__prompt_kernel_lwb_51
L_sequential_preLN__sliding_local_dilated__mixer_s_mlp__prompt_kernel_lws_55:
    s_movk_i32 s42, 18
    s_call_b64 s[44:45], L_wait_l_16_60_0
    s_branch L_sequential_preLN__sliding_local_dilated__mixer_s_mlp__prompt_kernel_lwb_54
L_sequential_preLN__sliding_local_dilated__mixer_s_mlp__prompt_kernel_lws_58:
    s_movk_i32 s42, 19
    s_call_b64 s[44:45], L_wait_l_16_60_0
    s_branch L_sequential_preLN__sliding_local_dilated__mixer_s_mlp__prompt_kernel_lwb_57
L_sequential_preLN__sliding_local_dilated__mixer_s_mlp__prompt_kernel_lws_61:
    s_movk_i32 s42, 20
    s_call_b64 s[44:45], L_wait_l_16_60_0
    s_branch L_sequential_preLN__sliding_local_dilated__mixer_s_mlp__prompt_kernel_lwb_60
L_sequential_preLN__sliding_local_dilated__mixer_s_mlp__prompt_kernel_lws_64:
    s_movk_i32 s42, 12
    s_call_b64 s[44:45], L_wait_l_16_60_0
    s_branch L_sequential_preLN__sliding_local_dilated__mixer_s_mlp__prompt_kernel_lwb_63
L_sequential_preLN__sliding_local_dilated__mixer_s_mlp__prompt_kernel_lws_67:
    s_movk_i32 s42, 21
    s_call_b64 s[44:45], L_wait_l_16_60_0
    s_branch L_sequential_preLN__sliding_local_dilated__mixer_s_mlp__prompt_kernel_lwb_66
L_sequential_preLN__sliding_local_dilated__mixer_s_mlp__prompt_kernel_lws_70:
    s_movk_i32 s42, 22
    s_call_b64 s[44:45], L_wait_l_16_60_0
    s_branch L_sequential_preLN__sliding_local_dilated__mixer_s_mlp__prompt_kernel_lwb_69
L_sequential_preLN__sliding_local_dilated__mixer_s_mlp__prompt_kernel_lws_73:
    s_movk_i32 s42, 22
    s_call_b64 s[44:45], L_wait_l_16_60_0
    s_branch L_sequential_preLN__sliding_local_dilated__mixer_s_mlp__prompt_kernel_lwb_72
L_sequential_preLN__sliding_local_dilated__mixer_s_mlp__prompt_kernel_lws_76:
    s_movk_i32 s42, 23
    s_call_b64 s[44:45], L_wait_l_16_60_0
    s_branch L_sequential_preLN__sliding_local_dilated__mixer_s_mlp__prompt_kernel_lwb_75
L_sequential_preLN__sliding_local_dilated__mixer_s_mlp__prompt_kernel_lws_79:
    s_movk_i32 s42, 23
    s_call_b64 s[44:45], L_wait_l_16_60_0
    s_branch L_sequential_preLN__sliding_local_dilated__mixer_s_mlp__prompt_kernel_lwb_78
L_sequential_preLN__sliding_local_dilated__mixer_s_mlp__prompt_kernel_lws_82:
    s_movk_i32 s42, 24
    s_call_b64 s[44:45], L_wait_l_16_60_0
    s_branch L_sequential_preLN__sliding_local_dilated__mixer_s_mlp__prompt_kernel_lwb_81
L_sequential_preLN__sliding_local_dilated__mixer_s_mlp__prompt_kernel_lws_85:
    s_movk_i32 s42, 24
    s_call_b64 s[44:45], L_wait_l_16_60_0
    s_branch L_sequential_preLN__sliding_local_dilated__mixer_s_mlp__prompt_kernel_lwb_84
L_sequential_preLN__sliding_local_dilated__mixer_s_mlp__prompt_kernel_lws_88:
    s_movk_i32 s42, 25
    s_call_b64 s[44:45], L_wait_l_16_60_0
    s_branch L_sequential_preLN__sliding_local_dilated__mixer_s_mlp__prompt_kernel_lwb_87
L_sequential_preLN__sliding_local_dilated__mixer_s_mlp__prompt_kernel_lws_91:
    s_movk_i32 s42, 26
    s_call_b64 s[44:45], L_wait_l_16_60_0
    s_branch L_sequential_preLN__sliding_local_dilated__mixer_s_mlp__prompt_kernel_lwb_90
L_sequential_preLN__sliding_local_dilated__mixer_s_mlp__prompt_kernel_lws_94:
    s_movk_i32 s42, 27
    s_call_b64 s[44:45], L_wait_l_16_60_0
    s_branch L_sequential_preLN__sliding_local_dilated__mixer_s_mlp__prompt_kernel_lwb_93
L_sequential_preLN__sliding_local_dilated__mixer_s_mlp__prompt_kernel_lws_97:
    s_movk_i32 s42, 28
    s_call_b64 s[44:45], L_wait_l_16_60_0
    s_branch L_sequential_preLN__sliding_local_dilated__mixer_s_mlp__prompt_kernel_lwb_96
L_sequential_preLN__sliding_local_dilated__mixer_s_mlp__prompt_kernel_lws_100:
    s_movk_i32 s42, 29
    s_call_b64 s[44:45], L_wait_l_16_60_0
    s_branch L_sequential_preLN__sliding_local_dilated__mixer_s_mlp__prompt_kernel_lwb_99
L_wait_l_16_60_0:
    s_mov_b32 s27, 0
    s_mov_b64 exec, 1
L_wait_l_16_60_0_t:
    ds_read_b128 v[8:11], v4 offset:16
    ds_read_b128 v[20:23], v4 offset:32
    s_waitcnt lgkmcnt(0)
    v_min3_u32 v8, v8, v9, v10
    v_min3_u32 v20, v20, v21, v22
    v_min3_u32 v8, v8, v20, v23
    v_min_u32 v8, v8, v11
    s_nop 0
    v_readfirstlane_b32 s60, v8
    s_cmp_ge_u32 s60, s42
    s_cbranch_scc1 L_wait_l_16_60_0_o
    s_sleep 1
    s_add_u32 s27, s27, 1
    s_cmp_lt_u32 s27, 0x40000
    s_cbranch_scc1 L_wait_l_16_60_0_t
L_wait_l_16_60_0_o:
    s_mov_b64 exec, -1
    s_setpc_b64 s[44:45]
L_aux0:
    s_cmp_eq_u32 s28, 7
    s_cbranch_scc1 L_pf
L_aux:
    s_mov_b32 s39, 2
    s_setprio 2
    v_mov_b32 v4, 0x26c00
    s_lshl_b32 s3, s26, 2
    v_add_u32 v5, s3, v4
    v_mov_b32 v16, 0x3f803f80
    v_mov_b32 v17, 0x3f803f80
    v_mov_b32 v18, 0x3f803f80
    v_mov_b32 v19, 0x3f803f80
    v_mov_b32 v7, 0
    s_mov_b32 s37, 0
    s_mov_b32 s52, 0
    v_lshlrev_b32 v24, 4, v1
    v_bfe_u32 v8, v1, 2, 2
    v_lshl_add_u32 v8, v3, 3, v8
    v_mul_u32_u24 v8, 192, v8
    v_and_b32 v9, 1, v3
    v_lshl_add_u32 v8, v9, 5, v8
    v_and_b32 v9, 3, v1
    v_lshl_add_u32 v25, v9, 3, v8
    v_xor_b32 v26, 32, v25
    v_lshl_add_u32 v28, v3, 4, v4
    s_getreg_b32 s53, hwreg(HW_REG_XCC_ID, 0, 4)
    s_waitcnt lgkmcnt(0)
    s_barrier
    s_mov_b32 s48, s24
    s_mov_b32 s49, s25
    s_mov_b32 s50, 0xfe8000
    s_mov_b32 s51, 0x20000
    s_mov_b32 s20, s22
    s_mov_b32 s21, s23
    s_mov_b32 s22, 256
    s_mov_b32 s23, 0x20000
    v_mov_b32 v12, 32767
    s_mov_b64 exec, 1
    ds_max_u32 v5, v12 offset:0
    s_mov_b64 exec, -1
    s_mul_i32 s33, s29, 448
    s_lshr_b32 s34, s30, 1
    s_mul_i32 s34, s34, 7
    s_add_u32 s33, s33, s34
    s_lshl_b32 s33, s33, 10
    s_add_u32 s33, s33, 0x800c00
    s_add_u32 s4, s24, s33
    s_addc_u32 s5, s25, 0
    s_mov_b32 s58, 0
    s_mov_b32 s27, 0
    s_mov_b64 exec, 1
L_sequential_preLN__sliding_local_dilated__mixer_s_mlp__prompt_kernel_npoll_101:
    s_sleep 10
    buffer_load_dword v6, v7, s[20:23], 0 offen sc1
    s_waitcnt vmcnt(0)
    v_readfirstlane_b32 s35, v6
    s_cmp_lg_u32 s35, 0
    s_cbranch_scc1 L_sequential_preLN__sliding_local_dilated__mixer_s_mlp__prompt_kernel_nok_102
    s_sleep 1
    s_add_u32 s27, s27, 1
    s_cmp_lt_u32 s27, 0x40000
    s_cbranch_scc1 L_sequential_preLN__sliding_local_dilated__mixer_s_mlp__prompt_kernel_npoll_101
L_sequential_preLN__sliding_local_dilated__mixer_s_mlp__prompt_kernel_nok_102:
    s_mov_b64 exec, -1
    s_cmp_lt_u32 s37, 1
    s_cbranch_scc1 L_sequential_preLN__sliding_local_dilated__mixer_s_mlp__prompt_kernel_lws_104
L_sequential_preLN__sliding_local_dilated__mixer_s_mlp__prompt_kernel_lwb_103:
    v_lshl_add_u32 v29, v1, 3, v4
    s_mov_b64 exec, 0xff
    ds_read_b64 v[128:129], v29 offset:1216
    s_mov_b64 exec, -1
    v_mov_b32 v6, s35
    v_mov_b32 v117, s35
    v_mov_b32 v119, s35
    s_lshl_b32 s55, s29, 11
    s_add_u32 s55, s55, 0xfc0000
    s_lshl_b32 s33, s30, 7
    s_add_u32 s33, s33, s55
    s_sub_u32 s55, s55, 256
    s_lshl_b32 s54, s29, 8
    s_add_u32 s54, s54, 0xfc8100
    s_lshl_b32 s34, s30, 4
    s_add_u32 s34, s34, s54
    s_waitcnt lgkmcnt(0)
    v_mov_b32 v116, v128
    v_mov_b32 v118, v129
    v_mov_b32 v128, s53
    v_mov_b32 v129, s35
    s_mov_b64 exec, 0xff
    buffer_store_dwordx4 v[116:119], v24, s[48:51], s33 offen sc1
    s_mov_b64 exec, 1
    buffer_store_dwordx2 v[128:129], v7, s[48:51], s34 offen sc1
    s_mov_b64 exec, -1
    s_cmp_lt_u32 s52, 1
    s_cbranch_scc1 L_sequential_preLN__sliding_local_dilated__mixer_s_mlp__prompt_kernel_lws_106
L_sequential_preLN__sliding_local_dilated__mixer_s_mlp__prompt_kernel_lwb_105:
    v_add_u32 v27, 0x0, v25
    ds_read_b64_tr_b16 v[60:61], v27 offset:18432
    ds_read_b64_tr_b16 v[62:63], v27 offset:19200
    ds_read_b64_tr_b16 v[64:65], v27 offset:18496
    ds_read_b64_tr_b16 v[66:67], v27 offset:19264
    ds_read_b64_tr_b16 v[68:69], v27 offset:18560
    ds_read_b64_tr_b16 v[70:71], v27 offset:19328
    ds_read_b64_tr_b16 v[72:73], v27 offset:24576
    ds_read_b64_tr_b16 v[74:75], v27 offset:25344
    ds_read_b64_tr_b16 v[76:77], v27 offset:24640
    ds_read_b64_tr_b16 v[78:79], v27 offset:25408
    ds_read_b64_tr_b16 v[80:81], v27 offset:24704
    ds_read_b64_tr_b16 v[82:83], v27 offset:25472
    v_add_u32 v27, 0x0, v26
    ds_read_b64_tr_b16 v[84:85], v27 offset:18432
    ds_read_b64_tr_b16 v[86:87], v27 offset:19200
    ds_read_b64_tr_b16 v[88:89], v27 offset:18496
    ds_read_b64_tr_b16 v[90:91], v27 offset:19264
    ds_read_b64_tr_b16 v[92:93], v27 offset:18560
    ds_read_b64_tr_b16 v[94:95], v27 offset:19328
    ds_read_b64_tr_b16 v[96:97], v27 offset:24576
    ds_read_b64_tr_b16 v[98:99], v27 offset:25344
    ds_read_b64_tr_b16 v[100:101], v27 offset:24640
    ds_read_b64_tr_b16 v[102:103], v27 offset:25408
    ds_read_b64_tr_b16 v[104:105], v27 offset:24704
    ds_read_b64_tr_b16 v[106:107], v27 offset:25472
    s_waitcnt lgkmcnt(0)
    v_mov_b32 v12, 1
    s_mov_b64 exec, 1
    ds_max_u32 v5, v12 offset:32
    s_mov_b64 exec, -1
    v_mfma_f32_16x16x32_bf16 v[32:35], v[60:63], v[16:19], 0
    v_mfma_f32_16x16x32_bf16 v[40:43], v[64:67], v[16:19], 0
    v_mfma_f32_16x16x32_bf16 v[48:51], v[68:71], v[16:19], 0
    v_mfma_f32_16x16x32_bf16 v[32:35], v[72:75], v[16:19], v[32:35]
    v_mfma_f32_16x16x32_bf16 v[40:43], v[76:79], v[16:19], v[40:43]
    v_mfma_f32_16x16x32_bf16 v[48:51], v[80:83], v[16:19], v[48:51]
    v_mfma_f32_16x16x32_bf16 v[36:39], v[84:87], v[16:19], 0
    v_mfma_f32_16x16x32_bf16 v[44:47], v[88:91], v[16:19], 0
    v_mfma_f32_16x16x32_bf16 v[52:55], v[92:95], v[16:19], 0
    v_mfma_f32_16x16x32_bf16 v[36:39], v[96:99], v[16:19], v[36:39]
    v_mfma_f32_16x16x32_bf16 v[44:47], v[100:103], v[16:19], v[44:47]
    v_mfma_f32_16x16x32_bf16 v[52:55], v[104:107], v[16:19], v[52:55]
    s_cmp_lt_u32 s52, 2
    s_cbranch_scc1 L_sequential_preLN__sliding_local_dilated__mixer_s_mlp__prompt_kernel_lws_108
L_sequential_preLN__sliding_local_dilated__mixer_s_mlp__prompt_kernel_lwb_107:
    v_add_u32 v27, 0x7800, v25
    ds_read_b64_tr_b16 v[60:61], v27 offset:18432
    ds_read_b64_tr_b16 v[62:63], v27 offset:19200
    ds_read_b64_tr_b16 v[64:65], v27 offset:18496
    ds_read_b64_tr_b16 v[66:67], v27 offset:19264
    ds_read_b64_tr_b16 v[68:69], v27 offset:18560
    ds_read_b64_tr_b16 v[70:71], v27 offset:19328
    ds_read_b64_tr_b16 v[72:73], v27 offset:24576
    ds_read_b64_tr_b16 v[74:75], v27 offset:25344
    ds_read_b64_tr_b16 v[76:77], v27 offset:24640
    ds_read_b64_tr_b16 v[78:79], v27 offset:25408
    ds_read_b64_tr_b16 v[80:81], v27 offset:24704
    ds_read_b64_tr_b16 v[82:83], v27 offset:25472
    v_add_u32 v27, 0x7800, v26
    ds_read_b64_tr_b16 v[84:85], v27 offset:18432
    ds_read_b64_tr_b16 v[86:87], v27 offset:19200
    ds_read_b64_tr_b16 v[88:89], v27 offset:18496
    ds_read_b64_tr_b16 v[90:91], v27 offset:19264
    ds_read_b64_tr_b16 v[92:93], v27 offset:18560
    ds_read_b64_tr_b16 v[94:95], v27 offset:19328
    ds_read_b64_tr_b16 v[96:97], v27 offset:24576
    ds_read_b64_tr_b16 v[98:99], v27 offset:25344
    ds_read_b64_tr_b16 v[100:101], v27 offset:24640
    ds_read_b64_tr_b16 v[102:103], v27 offset:25408
    ds_read_b64_tr_b16 v[104:105], v27 offset:24704
    ds_read_b64_tr_b16 v[106:107], v27 offset:25472
    s_waitcnt lgkmcnt(0)
    v_mov_b32 v12, 2
    s_mov_b64 exec, 1
    ds_max_u32 v5, v12 offset:32
    s_mov_b64 exec, -1
    v_mfma_f32_16x16x32_bf16 v[32:35], v[60:63], v[16:19], v[32:35]
    v_mfma_f32_16x16x32_bf16 v[40:43], v[64:67], v[16:19], v[40:43]
    v_mfma_f32_16x16x32_bf16 v[48:51], v[68:71], v[16:19], v[48:51]
    v_mfma_f32_16x16x32_bf16 v[32:35], v[72:75], v[16:19], v[32:35]
    v_mfma_f32_16x16x32_bf16 v[40:43], v[76:79], v[16:19], v[40:43]
    v_mfma_f32_16x16x32_bf16 v[48:51], v[80:83], v[16:19], v[48:51]
    v_mfma_f32_16x16x32_bf16 v[36:39], v[84:87], v[16:19], v[36:39]
    v_mfma_f32_16x16x32_bf16 v[44:47], v[88:91], v[16:19], v[44:47]
    v_mfma_f32_16x16x32_bf16 v[52:55], v[92:95], v[16:19], v[52:55]
    v_mfma_f32_16x16x32_bf16 v[36:39], v[96:99], v[16:19], v[36:39]
    v_mfma_f32_16x16x32_bf16 v[44:47], v[100:103], v[16:19], v[44:47]
    v_mfma_f32_16x16x32_bf16 v[52:55], v[104:107], v[16:19], v[52:55]
    s_cmp_lt_u32 s52, 3
    s_cbranch_scc1 L_sequential_preLN__sliding_local_dilated__mixer_s_mlp__prompt_kernel_lws_110
L_sequential_preLN__sliding_local_dilated__mixer_s_mlp__prompt_kernel_lwb_109:
    v_add_u32 v27, 0xf000, v25
    ds_read_b64_tr_b16 v[60:61], v27 offset:18432
    ds_read_b64_tr_b16 v[62:63], v27 offset:19200
    ds_read_b64_tr_b16 v[64:65], v27 offset:18496
    ds_read_b64_tr_b16 v[66:67], v27 offset:19264
    ds_read_b64_tr_b16 v[68:69], v27 offset:18560
    ds_read_b64_tr_b16 v[70:71], v27 offset:19328
    ds_read_b64_tr_b16 v[72:73], v27 offset:24576
    ds_read_b64_tr_b16 v[74:75], v27 offset:25344
    ds_read_b64_tr_b16 v[76:77], v27 offset:24640
    ds_read_b64_tr_b16 v[78:79], v27 offset:25408
    ds_read_b64_tr_b16 v[80:81], v27 offset:24704
    ds_read_b64_tr_b16 v[82:83], v27 offset:25472
    v_add_u32 v27, 0xf000, v26
    ds_read_b64_tr_b16 v[84:85], v27 offset:18432
    ds_read_b64_tr_b16 v[86:87], v27 offset:19200
    ds_read_b64_tr_b16 v[88:89], v27 offset:18496
    ds_read_b64_tr_b16 v[90:91], v27 offset:19264
    ds_read_b64_tr_b16 v[92:93], v27 offset:18560
    ds_read_b64_tr_b16 v[94:95], v27 offset:19328
    ds_read_b64_tr_b16 v[96:97], v27 offset:24576
    ds_read_b64_tr_b16 v[98:99], v27 offset:25344
    ds_read_b64_tr_b16 v[100:101], v27 offset:24640
    ds_read_b64_tr_b16 v[102:103], v27 offset:25408
    ds_read_b64_tr_b16 v[104:105], v27 offset:24704
    ds_read_b64_tr_b16 v[106:107], v27 offset:25472
    s_waitcnt lgkmcnt(0)
    v_mov_b32 v12, 3
    s_mov_b64 exec, 1
    ds_max_u32 v5, v12 offset:32
    s_mov_b64 exec, -1
    v_mfma_f32_16x16x32_bf16 v[32:35], v[60:63], v[16:19], v[32:35]
    v_mfma_f32_16x16x32_bf16 v[40:43], v[64:67], v[16:19], v[40:43]
    v_mfma_f32_16x16x32_bf16 v[48:51], v[68:71], v[16:19], v[48:51]
    v_mfma_f32_16x16x32_bf16 v[32:35], v[72:75], v[16:19], v[32:35]
    v_mfma_f32_16x16x32_bf16 v[40:43], v[76:79], v[16:19], v[40:43]
    v_mfma_f32_16x16x32_bf16 v[48:51], v[80:83], v[16:19], v[48:51]
    v_mfma_f32_16x16x32_bf16 v[36:39], v[84:87], v[16:19], v[36:39]
    v_mfma_f32_16x16x32_bf16 v[44:47], v[88:91], v[16:19], v[44:47]
    v_mfma_f32_16x16x32_bf16 v[52:55], v[92:95], v[16:19], v[52:55]
    v_mfma_f32_16x16x32_bf16 v[36:39], v[96:99], v[16:19], v[36:39]
    v_mfma_f32_16x16x32_bf16 v[44:47], v[100:103], v[16:19], v[44:47]
    v_mfma_f32_16x16x32_bf16 v[52:55], v[104:107], v[16:19], v[52:55]
    buffer_load_dwordx4 v[116:119], v24, s[48:51], s55 offen offset:0 sc1
    buffer_load_dwordx4 v[120:123], v24, s[48:51], s55 offen offset:1024 sc1
    s_mov_b64 exec, 0xffff
    buffer_load_dwordx4 v[124:127], v24, s[48:51], s55 offen offset:2048 sc1
    buffer_load_dwordx2 v[128:129], v24, s[48:51], s54 offen sc1
    s_mov_b64 exec, -1
    s_cmp_lt_u32 s52, 4
    s_cbranch_scc1 L_sequential_preLN__sliding_local_dilated__mixer_s_mlp__prompt_kernel_lws_112
L_sequential_preLN__sliding_local_dilated__mixer_s_mlp__prompt_kernel_lwb_111:
    v_add_u32 v27, 0x16800, v25
    ds_read_b64_tr_b16 v[60:61], v27 offset:18432
    ds_read_b64_tr_b16 v[62:63], v27 offset:19200
    ds_read_b64_tr_b16 v[64:65], v27 offset:18496
    ds_read_b64_tr_b16 v[66:67], v27 offset:19264
    ds_read_b64_tr_b16 v[68:69], v27 offset:18560
    ds_read_b64_tr_b16 v[70:71], v27 offset:19328
    ds_read_b64_tr_b16 v[72:73], v27 offset:24576
    ds_read_b64_tr_b16 v[74:75], v27 offset:25344
    ds_read_b64_tr_b16 v[76:77], v27 offset:24640
    ds_read_b64_tr_b16 v[78:79], v27 offset:25408
    ds_read_b64_tr_b16 v[80:81], v27 offset:24704
    ds_read_b64_tr_b16 v[82:83], v27 offset:25472
    v_add_u32 v27, 0x16800, v26
    ds_read_b64_tr_b16 v[84:85], v27 offset:18432
    ds_read_b64_tr_b16 v[86:87], v27 offset:19200
    ds_read_b64_tr_b16 v[88:89], v27 offset:18496
    ds_read_b64_tr_b16 v[90:91], v27 offset:19264
    ds_read_b64_tr_b16 v[92:93], v27 offset:18560
    ds_read_b64_tr_b16 v[94:95], v27 offset:19328
    ds_read_b64_tr_b16 v[96:97], v27 offset:24576
    ds_read_b64_tr_b16 v[98:99], v27 offset:25344
    ds_read_b64_tr_b16 v[100:101], v27 offset:24640
    ds_read_b64_tr_b16 v[102:103], v27 offset:25408
    ds_read_b64_tr_b16 v[104:105], v27 offset:24704
    ds_read_b64_tr_b16 v[106:107], v27 offset:25472
    s_waitcnt lgkmcnt(0)
    v_mov_b32 v12, 4
    s_mov_b64 exec, 1
    ds_max_u32 v5, v12 offset:32
    s_mov_b64 exec, -1
    v_mfma_f32_16x16x32_bf16 v[32:35], v[60:63], v[16:19], v[32:35]
    v_mfma_f32_16x16x32_bf16 v[40:43], v[64:67], v[16:19], v[40:43]
    v_mfma_f32_16x16x32_bf16 v[48:51], v[68:71], v[16:19], v[48:51]
    v_mfma_f32_16x16x32_bf16 v[32:35], v[72:75], v[16:19], v[32:35]
    v_mfma_f32_16x16x32_bf16 v[40:43], v[76:79], v[16:19], v[40:43]
    v_mfma_f32_16x16x32_bf16 v[48:51], v[80:83], v[16:19], v[48:51]
    v_mfma_f32_16x16x32_bf16 v[36:39], v[84:87], v[16:19], v[36:39]
    v_mfma_f32_16x16x32_bf16 v[44:47], v[88:91], v[16:19], v[44:47]
    v_mfma_f32_16x16x32_bf16 v[52:55], v[92:95], v[16:19], v[52:55]
    v_mfma_f32_16x16x32_bf16 v[36:39], v[96:99], v[16:19], v[36:39]
    v_mfma_f32_16x16x32_bf16 v[44:47], v[100:103], v[16:19], v[44:47]
    v_mfma_f32_16x16x32_bf16 v[52:55], v[104:107], v[16:19], v[52:55]
    s_cmp_lt_u32 s52, 5
    s_cbranch_scc1 L_sequential_preLN__sliding_local_dilated__mixer_s_mlp__prompt_kernel_lws_114
L_sequential_preLN__sliding_local_dilated__mixer_s_mlp__prompt_kernel_lwb_113:
    v_add_u32 v27, 0x1e000, v25
    ds_read_b64_tr_b16 v[60:61], v27 offset:18432
    ds_read_b64_tr_b16 v[62:63], v27 offset:19200
    ds_read_b64_tr_b16 v[64:65], v27 offset:18496
    ds_read_b64_tr_b16 v[66:67], v27 offset:19264
    ds_read_b64_tr_b16 v[68:69], v27 offset:18560
    ds_read_b64_tr_b16 v[70:71], v27 offset:19328
    ds_read_b64_tr_b16 v[72:73], v27 offset:24576
    ds_read_b64_tr_b16 v[74:75], v27 offset:25344
    ds_read_b64_tr_b16 v[76:77], v27 offset:24640
    ds_read_b64_tr_b16 v[78:79], v27 offset:25408
    ds_read_b64_tr_b16 v[80:81], v27 offset:24704
    ds_read_b64_tr_b16 v[82:83], v27 offset:25472
    v_add_u32 v27, 0x1e000, v26
    ds_read_b64_tr_b16 v[84:85], v27 offset:18432
    ds_read_b64_tr_b16 v[86:87], v27 offset:19200
    ds_read_b64_tr_b16 v[88:89], v27 offset:18496
    ds_read_b64_tr_b16 v[90:91], v27 offset:19264
    ds_read_b64_tr_b16 v[92:93], v27 offset:18560
    ds_read_b64_tr_b16 v[94:95], v27 offset:19328
    ds_read_b64_tr_b16 v[96:97], v27 offset:24576
    ds_read_b64_tr_b16 v[98:99], v27 offset:25344
    ds_read_b64_tr_b16 v[100:101], v27 offset:24640
    ds_read_b64_tr_b16 v[102:103], v27 offset:25408
    ds_read_b64_tr_b16 v[104:105], v27 offset:24704
    ds_read_b64_tr_b16 v[106:107], v27 offset:25472
    s_waitcnt lgkmcnt(0)
    v_mov_b32 v12, 5
    s_mov_b64 exec, 1
    ds_max_u32 v5, v12 offset:32
    s_mov_b64 exec, -1
    v_mfma_f32_16x16x32_bf16 v[32:35], v[60:63], v[16:19], v[32:35]
    v_mfma_f32_16x16x32_bf16 v[40:43], v[64:67], v[16:19], v[40:43]
    v_mfma_f32_16x16x32_bf16 v[48:51], v[68:71], v[16:19], v[48:51]
    v_mfma_f32_16x16x32_bf16 v[32:35], v[72:75], v[16:19], v[32:35]
    v_mfma_f32_16x16x32_bf16 v[40:43], v[76:79], v[16:19], v[40:43]
    v_mfma_f32_16x16x32_bf16 v[48:51], v[80:83], v[16:19], v[48:51]
    v_mfma_f32_16x16x32_bf16 v[36:39], v[84:87], v[16:19], v[36:39]
    v_mfma_f32_16x16x32_bf16 v[44:47], v[88:91], v[16:19], v[44:47]
    v_mfma_f32_16x16x32_bf16 v[52:55], v[92:95], v[16:19], v[52:55]
    v_mfma_f32_16x16x32_bf16 v[36:39], v[96:99], v[16:19], v[36:39]
    v_mfma_f32_16x16x32_bf16 v[44:47], v[100:103], v[16:19], v[44:47]
    v_mfma_f32_16x16x32_bf16 v[52:55], v[104:107], v[16:19], v[52:55]
    s_waitcnt vmcnt(0)
    s_mov_b32 s27, 0
L_sequential_preLN__sliding_local_dilated__mixer_s_mlp__prompt_kernel_xgpoll_115:
    s_mov_b64 exec, 0xffff
    s_cmp_lg_u32 s29, 0
    s_cbranch_scc1 L_sequential_preLN__sliding_local_dilated__mixer_s_mlp__prompt_kernel_rbnz_118
    v_mov_b32 v116, 0
    v_mov_b32 v118, 0
    v_mov_b32 v117, v6
    v_mov_b32 v119, v6
L_sequential_preLN__sliding_local_dilated__mixer_s_mlp__prompt_kernel_rbnz_118:
    v_cmp_ne_u32 s[40:41], s35, v129
    v_cmp_ne_u32 s[56:57], s53, v128
    v_xor_b32 v125, v125, v6
    v_xor_b32 v127, v127, v6
    v_or_b32 v127, v127, v125
    v_cmp_ne_u32 vcc, 0, v127
    v_mov_b32 v125, v126
    s_or_b64 s[40:41], vcc, s[40:41]
    s_mov_b64 exec, -1
    v_xor_b32 v121, v121, v6
    v_xor_b32 v123, v123, v6
    v_or_b32 v123, v123, v121
    v_cmp_ne_u32 vcc, 0, v123
    v_mov_b32 v121, v122
    s_or_b64 s[40:41], vcc, s[40:41]
    v_xor_b32 v117, v117, v6
    v_xor_b32 v119, v119, v6
    v_or_b32 v119, v119, v117
    v_cmp_ne_u32 vcc, 0, v119
    v_mov_b32 v117, v118
    s_or_b64 s[40:41], vcc, s[40:41]
    s_cbranch_scc1 L_sequential_preLN__sliding_local_dilated__mixer_s_mlp__prompt_kernel_xgslow_116
L_sequential_preLN__sliding_local_dilated__mixer_s_mlp__prompt_kernel_xgok_117:
    v_add_u32 v8, 16, v1
    v_bfe_u32 v9, v8, 1, 4
    v_and_b32 v29, 0xe0, v8
    v_or_b32 v9, v9, v29
    v_and_b32 v8, 1, v8
    v_lshl_or_b32 v9, v8, 4, v9
    v_lshl_add_u32 v29, v9, 3, v4
    v_lshl_add_u32 v27, v9, 2, v4
    ds_write_b64 v29, v[116:117] offset:1280
    ds_write_b32 v27, v116 offset:2560
    ds_write_b32 v27, v117 offset:3200
    ds_write_b64 v29, v[120:121] offset:1792
    ds_write_b32 v27, v120 offset:2816
    ds_write_b32 v27, v121 offset:3456
    s_mov_b64 exec, 0xffff
    ds_write_b64 v29, v[124:125] offset:2304
    ds_write_b32 v27, v124 offset:3072
    ds_write_b32 v27, v125 offset:3712
    s_cmp_eq_u64 s[56:57], 0
    s_cselect_b32 s36, 1, 0
    v_mov_b32 v128, s35
    v_mov_b32 v129, s36
    s_mov_b64 exec, 1
    ds_write_b64 v4, v[128:129] offset:80
    s_mov_b64 exec, -1
    s_cmp_lt_u32 s52, 6
    s_cbranch_scc1 L_sequential_preLN__sliding_local_dilated__mixer_s_mlp__prompt_kernel_lws_120
L_sequential_preLN__sliding_local_dilated__mixer_s_mlp__prompt_kernel_lwb_119:
    v_add_u32 v27, 0x0, v25
    ds_read_b64_tr_b16 v[60:61], v27 offset:18432
    ds_read_b64_tr_b16 v[62:63], v27 offset:19200
    ds_read_b64_tr_b16 v[64:65], v27 offset:18496
    ds_read_b64_tr_b16 v[66:67], v27 offset:19264
    ds_read_b64_tr_b16 v[68:69], v27 offset:18560
    ds_read_b64_tr_b16 v[70:71], v27 offset:19328
    ds_read_b64_tr_b16 v[72:73], v27 offset:24576
    ds_read_b64_tr_b16 v[74:75], v27 offset:25344
    ds_read_b64_tr_b16 v[76:77], v27 offset:24640
    ds_read_b64_tr_b16 v[78:79], v27 offset:25408
    ds_read_b64_tr_b16 v[80:81], v27 offset:24704
    ds_read_b64_tr_b16 v[82:83], v27 offset:25472
    v_add_u32 v27, 0x0, v26
    ds_read_b64_tr_b16 v[84:85], v27 offset:18432
    ds_read_b64_tr_b16 v[86:87], v27 offset:19200
    ds_read_b64_tr_b16 v[88:89], v27 offset:18496
    ds_read_b64_tr_b16 v[90:91], v27 offset:19264
    ds_read_b64_tr_b16 v[92:93], v27 offset:18560
    ds_read_b64_tr_b16 v[94:95], v27 offset:19328
    ds_read_b64_tr_b16 v[96:97], v27 offset:24576
    ds_read_b64_tr_b16 v[98:99], v27 offset:25344
    ds_read_b64_tr_b16 v[100:101], v27 offset:24640
    ds_read_b64_tr_b16 v[102:103], v27 offset:25408
    ds_read_b64_tr_b16 v[104:105], v27 offset:24704
    ds_read_b64_tr_b16 v[106:107], v27 offset:25472
    s_waitcnt lgkmcnt(0)
    v_mov_b32 v12, 6
    s_mov_b64 exec, 1
    ds_max_u32 v5, v12 offset:32
    s_mov_b64 exec, -1
    v_mfma_f32_16x16x32_bf16 v[32:35], v[60:63], v[16:19], v[32:35]
    v_mfma_f32_16x16x32_bf16 v[40:43], v[64:67], v[16:19], v[40:43]
    v_mfma_f32_16x16x32_bf16 v[48:51], v[68:71], v[16:19], v[48:51]
    v_mfma_f32_16x16x32_bf16 v[32:35], v[72:75], v[16:19], v[32:35]
    v_mfma_f32_16x16x32_bf16 v[40:43], v[76:79], v[16:19], v[40:43]
    v_mfma_f32_16x16x32_bf16 v[48:51], v[80:83], v[16:19], v[48:51]
    v_mfma_f32_16x16x32_bf16 v[36:39], v[84:87], v[16:19], v[36:39]
    v_mfma_f32_16x16x32_bf16 v[44:47], v[88:91], v[16:19], v[44:47]
    v_mfma_f32_16x16x32_bf16 v[52:55], v[92:95], v[16:19], v[52:55]
    v_mfma_f32_16x16x32_bf16 v[36:39], v[96:99], v[16:19], v[36:39]
    v_mfma_f32_16x16x32_bf16 v[44:47], v[100:103], v[16:19], v[44:47]
    v_mfma_f32_16x16x32_bf16 v[52:55], v[104:107], v[16:19], v[52:55]
    s_nop 7
    s_mov_b32 exec_lo, 0x00010001
    s_mov_b32 exec_hi, 0x00010001
    ds_write_b128 v28, v[32:35] offset:128
    ds_write_b128 v28, v[36:39] offset:192
    ds_write_b128 v28, v[40:43] offset:256
    ds_write_b128 v28, v[44:47] offset:320
    ds_write_b128 v28, v[48:51] offset:384
    ds_write_b128 v28, v[52:55] offset:448
    s_mov_b64 exec, -1
    v_mov_b32 v12, 1
    s_mov_b64 exec, 1
    ds_max_u32 v5, v12 offset:64
    s_mov_b64 exec, -1
    v_mov_b32 v12, 12
    s_mov_b64 exec, 1
    ds_max_u32 v5, v12 offset:32
    s_mov_b64 exec, -1
    s_setprio 0
    s_branch L_sequential_preLN__sliding_local_dilated__mixer_s_mlp__prompt_kernel_isl_121
L_sequential_preLN__sliding_local_dilated__mixer_s_mlp__prompt_kernel_lws_104:
    s_movk_i32 s42, 1
    s_call_b64 s[44:45], L_wait_a_48_37_0
    s_branch L_sequential_preLN__sliding_local_dilated__mixer_s_mlp__prompt_kernel_lwb_103
L_sequential_preLN__sliding_local_dilated__mixer_s_mlp__prompt_kernel_lws_106:
    s_movk_i32 s42, 1
    s_call_b64 s[44:45], L_wait_a_0_52_0
    s_branch L_sequential_preLN__sliding_local_dilated__mixer_s_mlp__prompt_kernel_lwb_105
L_sequential_preLN__sliding_local_dilated__mixer_s_mlp__prompt_kernel_lws_108:
    s_movk_i32 s42, 2
    s_call_b64 s[44:45], L_wait_a_0_52_0
    s_branch L_sequential_preLN__sliding_local_dilated__mixer_s_mlp__prompt_kernel_lwb_107
L_sequential_preLN__sliding_local_dilated__mixer_s_mlp__prompt_kernel_lws_110:
    s_movk_i32 s42, 3
    s_call_b64 s[44:45], L_wait_a_0_52_0
    s_branch L_sequential_preLN__sliding_local_dilated__mixer_s_mlp__prompt_kernel_lwb_109
L_sequential_preLN__sliding_local_dilated__mixer_s_mlp__prompt_kernel_lws_112:
    s_movk_i32 s42, 4
    s_call_b64 s[44:45], L_wait_a_0_52_0
    s_branch L_sequential_preLN__sliding_local_dilated__mixer_s_mlp__prompt_kernel_lwb_111
L_sequential_preLN__sliding_local_dilated__mixer_s_mlp__prompt_kernel_lws_114:
    s_movk_i32 s42, 5
    s_call_b64 s[44:45], L_wait_a_0_52_0
    s_branch L_sequential_preLN__sliding_local_dilated__mixer_s_mlp__prompt_kernel_lwb_113
L_sequential_preLN__sliding_local_dilated__mixer_s_mlp__prompt_kernel_xgslow_116:
    buffer_load_dwordx4 v[116:119], v24, s[48:51], s55 offen offset:0 sc1
    buffer_load_dwordx4 v[120:123], v24, s[48:51], s55 offen offset:1024 sc1
    s_mov_b64 exec, 0xffff
    buffer_load_dwordx4 v[124:127], v24, s[48:51], s55 offen offset:2048 sc1
    buffer_load_dwordx2 v[128:129], v24, s[48:51], s54 offen sc1
    s_mov_b64 exec, -1
    s_waitcnt vmcnt(0)
    s_sleep 1
    s_add_u32 s27, s27, 1
    s_cmp_lt_u32 s27, 0x40000
    s_cbranch_scc1 L_sequential_preLN__sliding_local_dilated__mixer_s_mlp__prompt_kernel_xgpoll_115
    s_branch L_sequential_preLN__sliding_local_dilated__mixer_s_mlp__prompt_kernel_xgok_117
L_sequential_preLN__sliding_local_dilated__mixer_s_mlp__prompt_kernel_lws_120:
    s_movk_i32 s42, 6
    s_call_b64 s[44:45], L_wait_a_0_52_0
    s_branch L_sequential_preLN__sliding_local_dilated__mixer_s_mlp__prompt_kernel_lwb_119
L_sequential_preLN__sliding_local_dilated__mixer_s_mlp__prompt_kernel_isl_121:
    v_bfe_u32 v8, v1, 2, 2
    v_lshl_add_u32 v9, v3, 2, v8
    v_bfe_u32 v10, v9, 1, 2
    v_lshlrev_b32 v10, 5, v10
    v_lshl_or_b32 v10, v9, 7, v10
    v_and_b32 v8, 3, v1
    v_lshl_or_b32 v130, v8, 3, v10
    v_xor_b32 v131, 32, v130
    v_xor_b32 v132, 64, v130
    v_xor_b32 v133, 96, v130
    s_cmp_lt_u32 s52, 13
    s_cbranch_scc1 L_sequential_preLN__sliding_local_dilated__mixer_s_mlp__prompt_kernel_lws_123
L_sequential_preLN__sliding_local_dilated__mixer_s_mlp__prompt_kernel_lwb_122:
    v_add_u32 v27, 0x0, v130
    ds_read_b64_tr_b16 v[60:61], v27 offset:0
    ds_read_b64_tr_b16 v[62:63], v27 offset:2048
    ds_read_b64_tr_b16 v[64:65], v27 offset:4096
    ds_read_b64_tr_b16 v[66:67], v27 offset:6144
    ds_read_b64_tr_b16 v[68:69], v27 offset:8192
    ds_read_b64_tr_b16 v[70:71], v27 offset:10240
    ds_read_b64_tr_b16 v[72:73], v27 offset:12288
    ds_read_b64_tr_b16 v[74:75], v27 offset:14336
    v_add_u32 v27, 0x0, v131
    ds_read_b64_tr_b16 v[76:77], v27 offset:0
    ds_read_b64_tr_b16 v[78:79], v27 offset:2048
    ds_read_b64_tr_b16 v[80:81], v27 offset:4096
    ds_read_b64_tr_b16 v[82:83], v27 offset:6144
    ds_read_b64_tr_b16 v[84:85], v27 offset:8192
    ds_read_b64_tr_b16 v[86:87], v27 offset:10240
    ds_read_b64_tr_b16 v[88:89], v27 offset:12288
    ds_read_b64_tr_b16 v[90:91], v27 offset:14336
    v_add_u32 v27, 0x0, v132
    ds_read_b64_tr_b16 v[92:93], v27 offset:0
    ds_read_b64_tr_b16 v[94:95], v27 offset:2048
    ds_read_b64_tr_b16 v[96:97], v27 offset:4096
    ds_read_b64_tr_b16 v[98:99], v27 offset:6144
    ds_read_b64_tr_b16 v[100:101], v27 offset:8192
    ds_read_b64_tr_b16 v[102:103], v27 offset:10240
    ds_read_b64_tr_b16 v[104:105], v27 offset:12288
    ds_read_b64_tr_b16 v[106:107], v27 offset:14336
    v_add_u32 v27, 0x0, v133
    ds_read_b64_tr_b16 v[108:109], v27 offset:0
    ds_read_b64_tr_b16 v[110:111], v27 offset:2048
    ds_read_b64_tr_b16 v[112:113], v27 offset:4096
    ds_read_b64_tr_b16 v[114:115], v27 offset:6144
    s_waitcnt lgkmcnt(0)
    v_mfma_f32_16x16x32_bf16 v[32:35], v[60:63], v[16:19], 0
    v_mfma_f32_16x16x32_bf16 v[32:35], v[64:67], v[16:19], v[32:35]
    v_mfma_f32_16x16x32_bf16 v[32:35], v[68:71], v[16:19], v[32:35]
    v_mfma_f32_16x16x32_bf16 v[32:35], v[72:75], v[16:19], v[32:35]
    v_mfma_f32_16x16x32_bf16 v[36:39], v[76:79], v[16:19], 0
    v_mfma_f32_16x16x32_bf16 v[36:39], v[80:83], v[16:19], v[36:39]
    v_mfma_f32_16x16x32_bf16 v[36:39], v[84:87], v[16:19], v[36:39]
    v_mfma_f32_16x16x32_bf16 v[36:39], v[88:91], v[16:19], v[36:39]
    v_mfma_f32_16x16x32_bf16 v[40:43], v[92:95], v[16:19], 0
    v_mfma_f32_16x16x32_bf16 v[40:43], v[96:99], v[16:19], v[40:43]
    v_mfma_f32_16x16x32_bf16 v[40:43], v[100:103], v[16:19], v[40:43]
    v_mfma_f32_16x16x32_bf16 v[40:43], v[104:107], v[16:19], v[40:43]
    v_mfma_f32_16x16x32_bf16 v[44:47], v[108:111], v[16:19], 0
    v_mfma_f32_16x16x32_bf16 v[44:47], v[112:115], v[16:19], v[44:47]
    v_add_u32 v27, 0x0, v133
    ds_read_b64_tr_b16 v[60:61], v27 offset:8192
    ds_read_b64_tr_b16 v[62:63], v27 offset:10240
    ds_read_b64_tr_b16 v[64:65], v27 offset:12288
    ds_read_b64_tr_b16 v[66:67], v27 offset:14336
    s_waitcnt lgkmcnt(0)
    v_mfma_f32_16x16x32_bf16 v[44:47], v[60:63], v[16:19], v[44:47]
    v_mfma_f32_16x16x32_bf16 v[44:47], v[64:67], v[16:19], v[44:47]
    s_cmp_lt_u32 s52, 14
    s_cbranch_scc1 L_sequential_preLN__sliding_local_dilated__mixer_s_mlp__prompt_kernel_lws_125
L_sequential_preLN__sliding_local_dilated__mixer_s_mlp__prompt_kernel_lwb_124:
    v_add_u32 v27, 0x4000, v130
    ds_read_b64_tr_b16 v[60:61], v27 offset:0
    ds_read_b64_tr_b16 v[62:63], v27 offset:2048
    ds_read_b64_tr_b16 v[64:65], v27 offset:4096
    ds_read_b64_tr_b16 v[66:67], v27 offset:6144
    ds_read_b64_tr_b16 v[68:69], v27 offset:8192
    ds_read_b64_tr_b16 v[70:71], v27 offset:10240
    ds_read_b64_tr_b16 v[72:73], v27 offset:12288
    ds_read_b64_tr_b16 v[74:75], v27 offset:14336
    v_add_u32 v27, 0x4000, v131
    ds_read_b64_tr_b16 v[76:77], v27 offset:0
    ds_read_b64_tr_b16 v[78:79], v27 offset:2048
    ds_read_b64_tr_b16 v[80:81], v27 offset:4096
    ds_read_b64_tr_b16 v[82:83], v27 offset:6144
    ds_read_b64_tr_b16 v[84:85], v27 offset:8192
    ds_read_b64_tr_b16 v[86:87], v27 offset:10240
    ds_read_b64_tr_b16 v[88:89], v27 offset:12288
    ds_read_b64_tr_b16 v[90:91], v27 offset:14336
    v_add_u32 v27, 0x4000, v132
    ds_read_b64_tr_b16 v[92:93], v27 offset:0
    ds_read_b64_tr_b16 v[94:95], v27 offset:2048
    ds_read_b64_tr_b16 v[96:97], v27 offset:4096
    ds_read_b64_tr_b16 v[98:99], v27 offset:6144
    ds_read_b64_tr_b16 v[100:101], v27 offset:8192
    ds_read_b64_tr_b16 v[102:103], v27 offset:10240
    ds_read_b64_tr_b16 v[104:105], v27 offset:12288
    ds_read_b64_tr_b16 v[106:107], v27 offset:14336
    v_add_u32 v27, 0x4000, v133
    ds_read_b64_tr_b16 v[108:109], v27 offset:0
    ds_read_b64_tr_b16 v[110:111], v27 offset:2048
    ds_read_b64_tr_b16 v[112:113], v27 offset:4096
    ds_read_b64_tr_b16 v[114:115], v27 offset:6144
    s_waitcnt lgkmcnt(0)
    v_mfma_f32_16x16x32_bf16 v[32:35], v[60:63], v[16:19], v[32:35]
    v_mfma_f32_16x16x32_bf16 v[32:35], v[64:67], v[16:19], v[32:35]
    v_mfma_f32_16x16x32_bf16 v[32:35], v[68:71], v[16:19], v[32:35]
    v_mfma_f32_16x16x32_bf16 v[32:35], v[72:75], v[16:19], v[32:35]
    v_mfma_f32_16x16x32_bf16 v[36:39], v[76:79], v[16:19], v[36:39]
    v_mfma_f32_16x16x32_bf16 v[36:39], v[80:83], v[16:19], v[36:39]
    v_mfma_f32_16x16x32_bf16 v[36:39], v[84:87], v[16:19], v[36:39]
    v_mfma_f32_16x16x32_bf16 v[36:39], v[88:91], v[16:19], v[36:39]
    v_mfma_f32_16x16x32_bf16 v[40:43], v[92:95], v[16:19], v[40:43]
    v_mfma_f32_16x16x32_bf16 v[40:43], v[96:99], v[16:19], v[40:43]
    v_mfma_f32_16x16x32_bf16 v[40:43], v[100:103], v[16:19], v[40:43]
    v_mfma_f32_16x16x32_bf16 v[40:43], v[104:107], v[16:19], v[40:43]
    v_mfma_f32_16x16x32_bf16 v[44:47], v[108:111], v[16:19], v[44:47]
    v_mfma_f32_16x16x32_bf16 v[44:47], v[112:115], v[16:19], v[44:47]
    v_add_u32 v27, 0x4000, v133
    ds_read_b64_tr_b16 v[60:61], v27 offset:8192
    ds_read_b64_tr_b16 v[62:63], v27 offset:10240
    ds_read_b64_tr_b16 v[64:65], v27 offset:12288
    ds_read_b64_tr_b16 v[66:67], v27 offset:14336
    s_waitcnt lgkmcnt(0)
    v_mov_b32 v12, 14
    s_mov_b64 exec, 1
    ds_max_u32 v5, v12 offset:32
    s_mov_b64 exec, -1
    v_mfma_f32_16x16x32_bf16 v[44:47], v[60:63], v[16:19], v[44:47]
    v_mfma_f32_16x16x32_bf16 v[44:47], v[64:67], v[16:19], v[44:47]
    s_cmp_lt_u32 s52, 15
    s_cbranch_scc1 L_sequential_preLN__sliding_local_dilated__mixer_s_mlp__prompt_kernel_lws_127
L_sequential_preLN__sliding_local_dilated__mixer_s_mlp__prompt_kernel_lwb_126:
    v_add_u32 v27, 0x8000, v130
    ds_read_b64_tr_b16 v[60:61], v27 offset:0
    ds_read_b64_tr_b16 v[62:63], v27 offset:2048
    ds_read_b64_tr_b16 v[64:65], v27 offset:4096
    ds_read_b64_tr_b16 v[66:67], v27 offset:6144
    ds_read_b64_tr_b16 v[68:69], v27 offset:8192
    ds_read_b64_tr_b16 v[70:71], v27 offset:10240
    ds_read_b64_tr_b16 v[72:73], v27 offset:12288
    ds_read_b64_tr_b16 v[74:75], v27 offset:14336
    v_add_u32 v27, 0x8000, v131
    ds_read_b64_tr_b16 v[76:77], v27 offset:0
    ds_read_b64_tr_b16 v[78:79], v27 offset:2048
    ds_read_b64_tr_b16 v[80:81], v27 offset:4096
    ds_read_b64_tr_b16 v[82:83], v27 offset:6144
    ds_read_b64_tr_b16 v[84:85], v27 offset:8192
    ds_read_b64_tr_b16 v[86:87], v27 offset:10240
    ds_read_b64_tr_b16 v[88:89], v27 offset:12288
    ds_read_b64_tr_b16 v[90:91], v27 offset:14336
    v_add_u32 v27, 0x8000, v132
    ds_read_b64_tr_b16 v[92:93], v27 offset:0
    ds_read_b64_tr_b16 v[94:95], v27 offset:2048
    ds_read_b64_tr_b16 v[96:97], v27 offset:4096
    ds_read_b64_tr_b16 v[98:99], v27 offset:6144
    ds_read_b64_tr_b16 v[100:101], v27 offset:8192
    ds_read_b64_tr_b16 v[102:103], v27 offset:10240
    ds_read_b64_tr_b16 v[104:105], v27 offset:12288
    ds_read_b64_tr_b16 v[106:107], v27 offset:14336
    v_add_u32 v27, 0x8000, v133
    ds_read_b64_tr_b16 v[108:109], v27 offset:0
    ds_read_b64_tr_b16 v[110:111], v27 offset:2048
    ds_read_b64_tr_b16 v[112:113], v27 offset:4096
    ds_read_b64_tr_b16 v[114:115], v27 offset:6144
    s_waitcnt lgkmcnt(0)
    v_mfma_f32_16x16x32_bf16 v[32:35], v[60:63], v[16:19], v[32:35]
    v_mfma_f32_16x16x32_bf16 v[32:35], v[64:67], v[16:19], v[32:35]
    v_mfma_f32_16x16x32_bf16 v[32:35], v[68:71], v[16:19], v[32:35]
    v_mfma_f32_16x16x32_bf16 v[32:35], v[72:75], v[16:19], v[32:35]
    v_mfma_f32_16x16x32_bf16 v[36:39], v[76:79], v[16:19], v[36:39]
    v_mfma_f32_16x16x32_bf16 v[36:39], v[80:83], v[16:19], v[36:39]
    v_mfma_f32_16x16x32_bf16 v[36:39], v[84:87], v[16:19], v[36:39]
    v_mfma_f32_16x16x32_bf16 v[36:39], v[88:91], v[16:19], v[36:39]
    v_mfma_f32_16x16x32_bf16 v[40:43], v[92:95], v[16:19], v[40:43]
    v_mfma_f32_16x16x32_bf16 v[40:43], v[96:99], v[16:19], v[40:43]
    v_mfma_f32_16x16x32_bf16 v[40:43], v[100:103], v[16:19], v[40:43]
    v_mfma_f32_16x16x32_bf16 v[40:43], v[104:107], v[16:19], v[40:43]
    v_mfma_f32_16x16x32_bf16 v[44:47], v[108:111], v[16:19], v[44:47]
    v_mfma_f32_16x16x32_bf16 v[44:47], v[112:115], v[16:19], v[44:47]
    v_add_u32 v27, 0x8000, v133
    ds_read_b64_tr_b16 v[60:61], v27 offset:8192
    ds_read_b64_tr_b16 v[62:63], v27 offset:10240
    ds_read_b64_tr_b16 v[64:65], v27 offset:12288
    ds_read_b64_tr_b16 v[66:67], v27 offset:14336
    s_waitcnt lgkmcnt(0)
    v_mfma_f32_16x16x32_bf16 v[44:47], v[60:63], v[16:19], v[44:47]
    v_mfma_f32_16x16x32_bf16 v[44:47], v[64:67], v[16:19], v[44:47]
    s_cmp_lt_u32 s52, 16
    s_cbranch_scc1 L_sequential_preLN__sliding_local_dilated__mixer_s_mlp__prompt_kernel_lws_129
L_sequential_preLN__sliding_local_dilated__mixer_s_mlp__prompt_kernel_lwb_128:
    v_add_u32 v27, 0xc000, v130
    ds_read_b64_tr_b16 v[60:61], v27 offset:0
    ds_read_b64_tr_b16 v[62:63], v27 offset:2048
    ds_read_b64_tr_b16 v[64:65], v27 offset:4096
    ds_read_b64_tr_b16 v[66:67], v27 offset:6144
    ds_read_b64_tr_b16 v[68:69], v27 offset:8192
    ds_read_b64_tr_b16 v[70:71], v27 offset:10240
    ds_read_b64_tr_b16 v[72:73], v27 offset:12288
    ds_read_b64_tr_b16 v[74:75], v27 offset:14336
    v_add_u32 v27, 0xc000, v131
    ds_read_b64_tr_b16 v[76:77], v27 offset:0
    ds_read_b64_tr_b16 v[78:79], v27 offset:2048
    ds_read_b64_tr_b16 v[80:81], v27 offset:4096
    ds_read_b64_tr_b16 v[82:83], v27 offset:6144
    ds_read_b64_tr_b16 v[84:85], v27 offset:8192
    ds_read_b64_tr_b16 v[86:87], v27 offset:10240
    ds_read_b64_tr_b16 v[88:89], v27 offset:12288
    ds_read_b64_tr_b16 v[90:91], v27 offset:14336
    v_add_u32 v27, 0xc000, v132
    ds_read_b64_tr_b16 v[92:93], v27 offset:0
    ds_read_b64_tr_b16 v[94:95], v27 offset:2048
    ds_read_b64_tr_b16 v[96:97], v27 offset:4096
    ds_read_b64_tr_b16 v[98:99], v27 offset:6144
    ds_read_b64_tr_b16 v[100:101], v27 offset:8192
    ds_read_b64_tr_b16 v[102:103], v27 offset:10240
    ds_read_b64_tr_b16 v[104:105], v27 offset:12288
    ds_read_b64_tr_b16 v[106:107], v27 offset:14336
    v_add_u32 v27, 0xc000, v133
    ds_read_b64_tr_b16 v[108:109], v27 offset:0
    ds_read_b64_tr_b16 v[110:111], v27 offset:2048
    ds_read_b64_tr_b16 v[112:113], v27 offset:4096
    ds_read_b64_tr_b16 v[114:115], v27 offset:6144
    s_waitcnt lgkmcnt(0)
    v_mfma_f32_16x16x32_bf16 v[32:35], v[60:63], v[16:19], v[32:35]
    v_mfma_f32_16x16x32_bf16 v[32:35], v[64:67], v[16:19], v[32:35]
    v_mfma_f32_16x16x32_bf16 v[32:35], v[68:71], v[16:19], v[32:35]
    v_mfma_f32_16x16x32_bf16 v[32:35], v[72:75], v[16:19], v[32:35]
    v_mfma_f32_16x16x32_bf16 v[36:39], v[76:79], v[16:19], v[36:39]
    v_mfma_f32_16x16x32_bf16 v[36:39], v[80:83], v[16:19], v[36:39]
    v_mfma_f32_16x16x32_bf16 v[36:39], v[84:87], v[16:19], v[36:39]
    v_mfma_f32_16x16x32_bf16 v[36:39], v[88:91], v[16:19], v[36:39]
    v_mfma_f32_16x16x32_bf16 v[40:43], v[92:95], v[16:19], v[40:43]
    v_mfma_f32_16x16x32_bf16 v[40:43], v[96:99], v[16:19], v[40:43]
    v_mfma_f32_16x16x32_bf16 v[40:43], v[100:103], v[16:19], v[40:43]
    v_mfma_f32_16x16x32_bf16 v[40:43], v[104:107], v[16:19], v[40:43]
    v_mfma_f32_16x16x32_bf16 v[44:47], v[108:111], v[16:19], v[44:47]
    v_mfma_f32_16x16x32_bf16 v[44:47], v[112:115], v[16:19], v[44:47]
    v_add_u32 v27, 0xc000, v133
    ds_read_b64_tr_b16 v[60:61], v27 offset:8192
    ds_read_b64_tr_b16 v[62:63], v27 offset:10240
    ds_read_b64_tr_b16 v[64:65], v27 offset:12288
    ds_read_b64_tr_b16 v[66:67], v27 offset:14336
    s_waitcnt lgkmcnt(0)
    v_mov_b32 v12, 16
    s_mov_b64 exec, 1
    ds_max_u32 v5, v12 offset:32
    s_mov_b64 exec, -1
    v_mfma_f32_16x16x32_bf16 v[44:47], v[60:63], v[16:19], v[44:47]
    v_mfma_f32_16x16x32_bf16 v[44:47], v[64:67], v[16:19], v[44:47]
    v_mov_b32 v12, 20
    s_mov_b64 exec, 1
    ds_max_u32 v5, v12 offset:32
    s_mov_b64 exec, -1
    s_nop 7
    s_mov_b32 exec_lo, 0x00010001
    s_mov_b32 exec_hi, 0x00010001
    ds_write_b128 v28, v[32:35] offset:512
    ds_write_b128 v28, v[36:39] offset:576
    ds_write_b128 v28, v[40:43] offset:640
    ds_write_b128 v28, v[44:47] offset:704
    s_mov_b64 exec, -1
    v_mov_b32 v12, 2
    s_mov_b64 exec, 1
    ds_max_u32 v5, v12 offset:64
    s_mov_b64 exec, -1
    v_bfe_u32 v8, v1, 2, 2
    v_lshl_add_u32 v8, v3, 2, v8
    v_mul_u32_u24 v8, 224, v8
    v_and_b32 v9, 3, v1
    v_lshl_add_u32 v25, v9, 3, v8
    s_cmp_lt_u32 s52, 22
    s_cbranch_scc1 L_sequential_preLN__sliding_local_dilated__mixer_s_mlp__prompt_kernel_lws_131
L_sequential_preLN__sliding_local_dilated__mixer_s_mlp__prompt_kernel_lwb_130:
    s_cmp_lt_u32 s52, 21
    s_cbranch_scc1 L_sequential_preLN__sliding_local_dilated__mixer_s_mlp__prompt_kernel_lws_133
L_sequential_preLN__sliding_local_dilated__mixer_s_mlp__prompt_kernel_lwb_132:
    v_add_u32 v27, 0x0, v25
    ds_read_b64_tr_b16 v[60:61], v27 offset:0
    ds_read_b64_tr_b16 v[62:63], v27 offset:3584
    ds_read_b64_tr_b16 v[64:65], v27 offset:32
    ds_read_b64_tr_b16 v[66:67], v27 offset:3616
    ds_read_b64_tr_b16 v[68:69], v27 offset:64
    ds_read_b64_tr_b16 v[70:71], v27 offset:3648
    ds_read_b64_tr_b16 v[72:73], v27 offset:96
    ds_read_b64_tr_b16 v[74:75], v27 offset:3680
    ds_read_b64_tr_b16 v[76:77], v27 offset:128
    ds_read_b64_tr_b16 v[78:79], v27 offset:3712
    ds_read_b64_tr_b16 v[80:81], v27 offset:160
    ds_read_b64_tr_b16 v[82:83], v27 offset:3744
    ds_read_b64_tr_b16 v[84:85], v27 offset:192
    ds_read_b64_tr_b16 v[86:87], v27 offset:3776
    ds_read_b64_tr_b16 v[88:89], v27 offset:7168
    ds_read_b64_tr_b16 v[90:91], v27 offset:10752
    ds_read_b64_tr_b16 v[92:93], v27 offset:7200
    ds_read_b64_tr_b16 v[94:95], v27 offset:10784
    ds_read_b64_tr_b16 v[96:97], v27 offset:7232
    ds_read_b64_tr_b16 v[98:99], v27 offset:10816
    ds_read_b64_tr_b16 v[100:101], v27 offset:7264
    ds_read_b64_tr_b16 v[102:103], v27 offset:10848
    ds_read_b64_tr_b16 v[104:105], v27 offset:7296
    ds_read_b64_tr_b16 v[106:107], v27 offset:10880
    ds_read_b64_tr_b16 v[108:109], v27 offset:7328
    ds_read_b64_tr_b16 v[110:111], v27 offset:10912
    ds_read_b64_tr_b16 v[112:113], v27 offset:7360
    ds_read_b64_tr_b16 v[114:115], v27 offset:10944
    s_waitcnt lgkmcnt(0)
    v_mfma_f32_16x16x32_bf16 v[32:35], v[60:63], v[16:19], 0
    v_mfma_f32_16x16x32_bf16 v[36:39], v[64:67], v[16:19], 0
    v_mfma_f32_16x16x32_bf16 v[40:43], v[68:71], v[16:19], 0
    v_mfma_f32_16x16x32_bf16 v[44:47], v[72:75], v[16:19], 0
    v_mfma_f32_16x16x32_bf16 v[48:51], v[76:79], v[16:19], 0
    v_mfma_f32_16x16x32_bf16 v[52:55], v[80:83], v[16:19], 0
    v_mfma_f32_16x16x32_bf16 v[56:59], v[84:87], v[16:19], 0
    v_mfma_f32_16x16x32_bf16 v[32:35], v[88:91], v[16:19], v[32:35]
    v_mfma_f32_16x16x32_bf16 v[36:39], v[92:95], v[16:19], v[36:39]
    v_mfma_f32_16x16x32_bf16 v[40:43], v[96:99], v[16:19], v[40:43]
    v_mfma_f32_16x16x32_bf16 v[44:47], v[100:103], v[16:19], v[44:47]
    v_mfma_f32_16x16x32_bf16 v[48:51], v[104:107], v[16:19], v[48:51]
    v_mfma_f32_16x16x32_bf16 v[52:55], v[108:111], v[16:19], v[52:55]
    v_mfma_f32_16x16x32_bf16 v[56:59], v[112:115], v[16:19], v[56:59]
    v_add_u32 v27, 0x0, v25
    ds_read_b64_tr_b16 v[60:61], v27 offset:14336
    ds_read_b64_tr_b16 v[62:63], v27 offset:17920
    ds_read_b64_tr_b16 v[64:65], v27 offset:14368
    ds_read_b64_tr_b16 v[66:67], v27 offset:17952
    ds_read_b64_tr_b16 v[68:69], v27 offset:14400
    ds_read_b64_tr_b16 v[70:71], v27 offset:17984
    ds_read_b64_tr_b16 v[72:73], v27 offset:14432
    ds_read_b64_tr_b16 v[74:75], v27 offset:18016
    ds_read_b64_tr_b16 v[76:77], v27 offset:14464
    ds_read_b64_tr_b16 v[78:79], v27 offset:18048
    ds_read_b64_tr_b16 v[80:81], v27 offset:14496
    ds_read_b64_tr_b16 v[82:83], v27 offset:18080
    ds_read_b64_tr_b16 v[84:85], v27 offset:14528
    ds_read_b64_tr_b16 v[86:87], v27 offset:18112
    ds_read_b64_tr_b16 v[88:89], v27 offset:21504
    ds_read_b64_tr_b16 v[90:91], v27 offset:25088
    ds_read_b64_tr_b16 v[92:93], v27 offset:21536
    ds_read_b64_tr_b16 v[94:95], v27 offset:25120
    ds_read_b64_tr_b16 v[96:97], v27 offset:21568
    ds_read_b64_tr_b16 v[98:99], v27 offset:25152
    ds_read_b64_tr_b16 v[100:101], v27 offset:21600
    ds_read_b64_tr_b16 v[102:103], v27 offset:25184
    ds_read_b64_tr_b16 v[104:105], v27 offset:21632
    ds_read_b64_tr_b16 v[106:107], v27 offset:25216
    ds_read_b64_tr_b16 v[108:109], v27 offset:21664
    ds_read_b64_tr_b16 v[110:111], v27 offset:25248
    ds_read_b64_tr_b16 v[112:113], v27 offset:21696
    ds_read_b64_tr_b16 v[114:115], v27 offset:25280
    s_waitcnt lgkmcnt(0)
    v_mov_b32 v12, 21
    s_mov_b64 exec, 1
    ds_max_u32 v5, v12 offset:32
    s_mov_b64 exec, -1
    v_mfma_f32_16x16x32_bf16 v[32:35], v[60:63], v[16:19], v[32:35]
    v_mfma_f32_16x16x32_bf16 v[36:39], v[64:67], v[16:19], v[36:39]
    v_mfma_f32_16x16x32_bf16 v[40:43], v[68:71], v[16:19], v[40:43]
    v_mfma_f32_16x16x32_bf16 v[44:47], v[72:75], v[16:19], v[44:47]
    v_mfma_f32_16x16x32_bf16 v[48:51], v[76:79], v[16:19], v[48:51]
    v_mfma_f32_16x16x32_bf16 v[52:55], v[80:83], v[16:19], v[52:55]
    v_mfma_f32_16x16x32_bf16 v[56:59], v[84:87], v[16:19], v[56:59]
    v_mfma_f32_16x16x32_bf16 v[32:35], v[88:91], v[16:19], v[32:35]
    v_mfma_f32_16x16x32_bf16 v[36:39], v[92:95], v[16:19], v[36:39]
    v_mfma_f32_16x16x32_bf16 v[40:43], v[96:99], v[16:19], v[40:43]
    v_mfma_f32_16x16x32_bf16 v[44:47], v[100:103], v[16:19], v[44:47]
    v_mfma_f32_16x16x32_bf16 v[48:51], v[104:107], v[16:19], v[48:51]
    v_mfma_f32_16x16x32_bf16 v[52:55], v[108:111], v[16:19], v[52:55]
    v_mfma_f32_16x16x32_bf16 v[56:59], v[112:115], v[16:19], v[56:59]
    s_cmp_lt_u32 s52, 22
    s_cbranch_scc1 L_sequential_preLN__sliding_local_dilated__mixer_s_mlp__prompt_kernel_lws_135
L_sequential_preLN__sliding_local_dilated__mixer_s_mlp__prompt_kernel_lwb_134:
    v_add_u32 v27, 0x7000, v25
    ds_read_b64_tr_b16 v[60:61], v27 offset:0
    ds_read_b64_tr_b16 v[62:63], v27 offset:3584
    ds_read_b64_tr_b16 v[64:65], v27 offset:32
    ds_read_b64_tr_b16 v[66:67], v27 offset:3616
    ds_read_b64_tr_b16 v[68:69], v27 offset:64
    ds_read_b64_tr_b16 v[70:71], v27 offset:3648
    ds_read_b64_tr_b16 v[72:73], v27 offset:96
    ds_read_b64_tr_b16 v[74:75], v27 offset:3680
    ds_read_b64_tr_b16 v[76:77], v27 offset:128
    ds_read_b64_tr_b16 v[78:79], v27 offset:3712
    ds_read_b64_tr_b16 v[80:81], v27 offset:160
    ds_read_b64_tr_b16 v[82:83], v27 offset:3744
    ds_read_b64_tr_b16 v[84:85], v27 offset:192
    ds_read_b64_tr_b16 v[86:87], v27 offset:3776
    ds_read_b64_tr_b16 v[88:89], v27 offset:7168
    ds_read_b64_tr_b16 v[90:91], v27 offset:10752
    ds_read_b64_tr_b16 v[92:93], v27 offset:7200
    ds_read_b64_tr_b16 v[94:95], v27 offset:10784
    ds_read_b64_tr_b16 v[96:97], v27 offset:7232
    ds_read_b64_tr_b16 v[98:99], v27 offset:10816
    ds_read_b64_tr_b16 v[100:101], v27 offset:7264
    ds_read_b64_tr_b16 v[102:103], v27 offset:10848
    ds_read_b64_tr_b16 v[104:105], v27 offset:7296
    ds_read_b64_tr_b16 v[106:107], v27 offset:10880
    ds_read_b64_tr_b16 v[108:109], v27 offset:7328
    ds_read_b64_tr_b16 v[110:111], v27 offset:10912
    ds_read_b64_tr_b16 v[112:113], v27 offset:7360
    ds_read_b64_tr_b16 v[114:115], v27 offset:10944
    s_waitcnt lgkmcnt(0)
    v_mfma_f32_16x16x32_bf16 v[32:35], v[60:63], v[16:19], v[32:35]
    v_mfma_f32_16x16x32_bf16 v[36:39], v[64:67], v[16:19], v[36:39]
    v_mfma_f32_16x16x32_bf16 v[40:43], v[68:71], v[16:19], v[40:43]
    v_mfma_f32_16x16x32_bf16 v[44:47], v[72:75], v[16:19], v[44:47]
    v_mfma_f32_16x16x32_bf16 v[48:51], v[76:79], v[16:19], v[48:51]
    v_mfma_f32_16x16x32_bf16 v[52:55], v[80:83], v[16:19], v[52:55]
    v_mfma_f32_16x16x32_bf16 v[56:59], v[84:87], v[16:19], v[56:59]
    v_mfma_f32_16x16x32_bf16 v[32:35], v[88:91], v[16:19], v[32:35]
    v_mfma_f32_16x16x32_bf16 v[36:39], v[92:95], v[16:19], v[36:39]
    v_mfma_f32_16x16x32_bf16 v[40:43], v[96:99], v[16:19], v[40:43]
    v_mfma_f32_16x16x32_bf16 v[44:47], v[100:103], v[16:19], v[44:47]
    v_mfma_f32_16x16x32_bf16 v[48:51], v[104:107], v[16:19], v[48:51]
    v_mfma_f32_16x16x32_bf16 v[52:55], v[108:111], v[16:19], v[52:55]
    v_mfma_f32_16x16x32_bf16 v[56:59], v[112:115], v[16:19], v[56:59]
    v_add_u32 v27, 0x7000, v25
    ds_read_b64_tr_b16 v[60:61], v27 offset:14336
    ds_read_b64_tr_b16 v[62:63], v27 offset:17920
    ds_read_b64_tr_b16 v[64:65], v27 offset:14368
    ds_read_b64_tr_b16 v[66:67], v27 offset:17952
    ds_read_b64_tr_b16 v[68:69], v27 offset:14400
    ds_read_b64_tr_b16 v[70:71], v27 offset:17984
    ds_read_b64_tr_b16 v[72:73], v27 offset:14432
    ds_read_b64_tr_b16 v[74:75], v27 offset:18016
    ds_read_b64_tr_b16 v[76:77], v27 offset:14464
    ds_read_b64_tr_b16 v[78:79], v27 offset:18048
    ds_read_b64_tr_b16 v[80:81], v27 offset:14496
    ds_read_b64_tr_b16 v[82:83], v27 offset:18080
    ds_read_b64_tr_b16 v[84:85], v27 offset:14528
    ds_read_b64_tr_b16 v[86:87], v27 offset:18112
    ds_read_b64_tr_b16 v[88:89], v27 offset:21504
    ds_read_b64_tr_b16 v[90:91], v27 offset:25088
    ds_read_b64_tr_b16 v[92:93], v27 offset:21536
    ds_read_b64_tr_b16 v[94:95], v27 offset:25120
    ds_read_b64_tr_b16 v[96:97], v27 offset:21568
    ds_read_b64_tr_b16 v[98:99], v27 offset:25152
    ds_read_b64_tr_b16 v[100:101], v27 offset:21600
    ds_read_b64_tr_b16 v[102:103], v27 offset:25184
    ds_read_b64_tr_b16 v[104:105], v27 offset:21632
    ds_read_b64_tr_b16 v[106:107], v27 offset:25216
    ds_read_b64_tr_b16 v[108:109], v27 offset:21664
    ds_read_b64_tr_b16 v[110:111], v27 offset:25248
    ds_read_b64_tr_b16 v[112:113], v27 offset:21696
    ds_read_b64_tr_b16 v[114:115], v27 offset:25280
    s_waitcnt lgkmcnt(0)
    v_mov_b32 v12, 22
    s_mov_b64 exec, 1
    ds_max_u32 v5, v12 offset:32
    s_mov_b64 exec, -1
    v_mfma_f32_16x16x32_bf16 v[32:35], v[60:63], v[16:19], v[32:35]
    v_mfma_f32_16x16x32_bf16 v[36:39], v[64:67], v[16:19], v[36:39]
    v_mfma_f32_16x16x32_bf16 v[40:43], v[68:71], v[16:19], v[40:43]
    v_mfma_f32_16x16x32_bf16 v[44:47], v[72:75], v[16:19], v[44:47]
    v_mfma_f32_16x16x32_bf16 v[48:51], v[76:79], v[16:19], v[48:51]
    v_mfma_f32_16x16x32_bf16 v[52:55], v[80:83], v[16:19], v[52:55]
    v_mfma_f32_16x16x32_bf16 v[56:59], v[84:87], v[16:19], v[56:59]
    v_mfma_f32_16x16x32_bf16 v[32:35], v[88:91], v[16:19], v[32:35]
    v_mfma_f32_16x16x32_bf16 v[36:39], v[92:95], v[16:19], v[36:39]
    v_mfma_f32_16x16x32_bf16 v[40:43], v[96:99], v[16:19], v[40:43]
    v_mfma_f32_16x16x32_bf16 v[44:47], v[100:103], v[16:19], v[44:47]
    v_mfma_f32_16x16x32_bf16 v[48:51], v[104:107], v[16:19], v[48:51]
    v_mfma_f32_16x16x32_bf16 v[52:55], v[108:111], v[16:19], v[52:55]
    v_mfma_f32_16x16x32_bf16 v[56:59], v[112:115], v[16:19], v[56:59]
    s_cmp_lt_u32 s52, 23
    s_cbranch_scc1 L_sequential_preLN__sliding_local_dilated__mixer_s_mlp__prompt_kernel_lws_137
L_sequential_preLN__sliding_local_dilated__mixer_s_mlp__prompt_kernel_lwb_136:
    v_add_u32 v27, 0xe000, v25
    ds_read_b64_tr_b16 v[60:61], v27 offset:0
    ds_read_b64_tr_b16 v[62:63], v27 offset:3584
    ds_read_b64_tr_b16 v[64:65], v27 offset:32
    ds_read_b64_tr_b16 v[66:67], v27 offset:3616
    ds_read_b64_tr_b16 v[68:69], v27 offset:64
    ds_read_b64_tr_b16 v[70:71], v27 offset:3648
    ds_read_b64_tr_b16 v[72:73], v27 offset:96
    ds_read_b64_tr_b16 v[74:75], v27 offset:3680
    ds_read_b64_tr_b16 v[76:77], v27 offset:128
    ds_read_b64_tr_b16 v[78:79], v27 offset:3712
    ds_read_b64_tr_b16 v[80:81], v27 offset:160
    ds_read_b64_tr_b16 v[82:83], v27 offset:3744
    ds_read_b64_tr_b16 v[84:85], v27 offset:192
    ds_read_b64_tr_b16 v[86:87], v27 offset:3776
    ds_read_b64_tr_b16 v[88:89], v27 offset:7168
    ds_read_b64_tr_b16 v[90:91], v27 offset:10752
    ds_read_b64_tr_b16 v[92:93], v27 offset:7200
    ds_read_b64_tr_b16 v[94:95], v27 offset:10784
    ds_read_b64_tr_b16 v[96:97], v27 offset:7232
    ds_read_b64_tr_b16 v[98:99], v27 offset:10816
    ds_read_b64_tr_b16 v[100:101], v27 offset:7264
    ds_read_b64_tr_b16 v[102:103], v27 offset:10848
    ds_read_b64_tr_b16 v[104:105], v27 offset:7296
    ds_read_b64_tr_b16 v[106:107], v27 offset:10880
    ds_read_b64_tr_b16 v[108:109], v27 offset:7328
    ds_read_b64_tr_b16 v[110:111], v27 offset:10912
    ds_read_b64_tr_b16 v[112:113], v27 offset:7360
    ds_read_b64_tr_b16 v[114:115], v27 offset:10944
    s_waitcnt lgkmcnt(0)
    v_mfma_f32_16x16x32_bf16 v[32:35], v[60:63], v[16:19], v[32:35]
    v_mfma_f32_16x16x32_bf16 v[36:39], v[64:67], v[16:19], v[36:39]
    v_mfma_f32_16x16x32_bf16 v[40:43], v[68:71], v[16:19], v[40:43]
    v_mfma_f32_16x16x32_bf16 v[44:47], v[72:75], v[16:19], v[44:47]
    v_mfma_f32_16x16x32_bf16 v[48:51], v[76:79], v[16:19], v[48:51]
    v_mfma_f32_16x16x32_bf16 v[52:55], v[80:83], v[16:19], v[52:55]
    v_mfma_f32_16x16x32_bf16 v[56:59], v[84:87], v[16:19], v[56:59]
    v_mfma_f32_16x16x32_bf16 v[32:35], v[88:91], v[16:19], v[32:35]
    v_mfma_f32_16x16x32_bf16 v[36:39], v[92:95], v[16:19], v[36:39]
    v_mfma_f32_16x16x32_bf16 v[40:43], v[96:99], v[16:19], v[40:43]
    v_mfma_f32_16x16x32_bf16 v[44:47], v[100:103], v[16:19], v[44:47]
    v_mfma_f32_16x16x32_bf16 v[48:51], v[104:107], v[16:19], v[48:51]
    v_mfma_f32_16x16x32_bf16 v[52:55], v[108:111], v[16:19], v[52:55]
    v_mfma_f32_16x16x32_bf16 v[56:59], v[112:115], v[16:19], v[56:59]
    v_add_u32 v27, 0xe000, v25
    ds_read_b64_tr_b16 v[60:61], v27 offset:14336
    ds_read_b64_tr_b16 v[62:63], v27 offset:17920
    ds_read_b64_tr_b16 v[64:65], v27 offset:14368
    ds_read_b64_tr_b16 v[66:67], v27 offset:17952
    ds_read_b64_tr_b16 v[68:69], v27 offset:14400
    ds_read_b64_tr_b16 v[70:71], v27 offset:17984
    ds_read_b64_tr_b16 v[72:73], v27 offset:14432
    ds_read_b64_tr_b16 v[74:75], v27 offset:18016
    ds_read_b64_tr_b16 v[76:77], v27 offset:14464
    ds_read_b64_tr_b16 v[78:79], v27 offset:18048
    ds_read_b64_tr_b16 v[80:81], v27 offset:14496
    ds_read_b64_tr_b16 v[82:83], v27 offset:18080
    ds_read_b64_tr_b16 v[84:85], v27 offset:14528
    ds_read_b64_tr_b16 v[86:87], v27 offset:18112
    ds_read_b64_tr_b16 v[88:89], v27 offset:21504
    ds_read_b64_tr_b16 v[90:91], v27 offset:25088
    ds_read_b64_tr_b16 v[92:93], v27 offset:21536
    ds_read_b64_tr_b16 v[94:95], v27 offset:25120
    ds_read_b64_tr_b16 v[96:97], v27 offset:21568
    ds_read_b64_tr_b16 v[98:99], v27 offset:25152
    ds_read_b64_tr_b16 v[100:101], v27 offset:21600
    ds_read_b64_tr_b16 v[102:103], v27 offset:25184
    ds_read_b64_tr_b16 v[104:105], v27 offset:21632
    ds_read_b64_tr_b16 v[106:107], v27 offset:25216
    ds_read_b64_tr_b16 v[108:109], v27 offset:21664
    ds_read_b64_tr_b16 v[110:111], v27 offset:25248
    ds_read_b64_tr_b16 v[112:113], v27 offset:21696
    ds_read_b64_tr_b16 v[114:115], v27 offset:25280
    s_waitcnt lgkmcnt(0)
    v_mov_b32 v12, 23
    s_mov_b64 exec, 1
    ds_max_u32 v5, v12 offset:32
    s_mov_b64 exec, -1
    v_mfma_f32_16x16x32_bf16 v[32:35], v[60:63], v[16:19], v[32:35]
    v_mfma_f32_16x16x32_bf16 v[36:39], v[64:67], v[16:19], v[36:39]
    v_mfma_f32_16x16x32_bf16 v[40:43], v[68:71], v[16:19], v[40:43]
    v_mfma_f32_16x16x32_bf16 v[44:47], v[72:75], v[16:19], v[44:47]
    v_mfma_f32_16x16x32_bf16 v[48:51], v[76:79], v[16:19], v[48:51]
    v_mfma_f32_16x16x32_bf16 v[52:55], v[80:83], v[16:19], v[52:55]
    v_mfma_f32_16x16x32_bf16 v[56:59], v[84:87], v[16:19], v[56:59]
    v_mfma_f32_16x16x32_bf16 v[32:35], v[88:91], v[16:19], v[32:35]
    v_mfma_f32_16x16x32_bf16 v[36:39], v[92:95], v[16:19], v[36:39]
    v_mfma_f32_16x16x32_bf16 v[40:43], v[96:99], v[16:19], v[40:43]
    v_mfma_f32_16x16x32_bf16 v[44:47], v[100:103], v[16:19], v[44:47]
    v_mfma_f32_16x16x32_bf16 v[48:51], v[104:107], v[16:19], v[48:51]
    v_mfma_f32_16x16x32_bf16 v[52:55], v[108:111], v[16:19], v[52:55]
    v_mfma_f32_16x16x32_bf16 v[56:59], v[112:115], v[16:19], v[56:59]
    s_cmp_lt_u32 s52, 24
    s_cbranch_scc1 L_sequential_preLN__sliding_local_dilated__mixer_s_mlp__prompt_kernel_lws_139
L_sequential_preLN__sliding_local_dilated__mixer_s_mlp__prompt_kernel_lwb_138:
    v_add_u32 v27, 0x15000, v25
    ds_read_b64_tr_b16 v[60:61], v27 offset:0
    ds_read_b64_tr_b16 v[62:63], v27 offset:3584
    ds_read_b64_tr_b16 v[64:65], v27 offset:32
    ds_read_b64_tr_b16 v[66:67], v27 offset:3616
    ds_read_b64_tr_b16 v[68:69], v27 offset:64
    ds_read_b64_tr_b16 v[70:71], v27 offset:3648
    ds_read_b64_tr_b16 v[72:73], v27 offset:96
    ds_read_b64_tr_b16 v[74:75], v27 offset:3680
    ds_read_b64_tr_b16 v[76:77], v27 offset:128
    ds_read_b64_tr_b16 v[78:79], v27 offset:3712
    ds_read_b64_tr_b16 v[80:81], v27 offset:160
    ds_read_b64_tr_b16 v[82:83], v27 offset:3744
    ds_read_b64_tr_b16 v[84:85], v27 offset:192
    ds_read_b64_tr_b16 v[86:87], v27 offset:3776
    ds_read_b64_tr_b16 v[88:89], v27 offset:7168
    ds_read_b64_tr_b16 v[90:91], v27 offset:10752
    ds_read_b64_tr_b16 v[92:93], v27 offset:7200
    ds_read_b64_tr_b16 v[94:95], v27 offset:10784
    ds_read_b64_tr_b16 v[96:97], v27 offset:7232
    ds_read_b64_tr_b16 v[98:99], v27 offset:10816
    ds_read_b64_tr_b16 v[100:101], v27 offset:7264
    ds_read_b64_tr_b16 v[102:103], v27 offset:10848
    ds_read_b64_tr_b16 v[104:105], v27 offset:7296
    ds_read_b64_tr_b16 v[106:107], v27 offset:10880
    ds_read_b64_tr_b16 v[108:109], v27 offset:7328
    ds_read_b64_tr_b16 v[110:111], v27 offset:10912
    ds_read_b64_tr_b16 v[112:113], v27 offset:7360
    ds_read_b64_tr_b16 v[114:115], v27 offset:10944
    s_waitcnt lgkmcnt(0)
    v_mfma_f32_16x16x32_bf16 v[32:35], v[60:63], v[16:19], v[32:35]
    v_mfma_f32_16x16x32_bf16 v[36:39], v[64:67], v[16:19], v[36:39]
    v_mfma_f32_16x16x32_bf16 v[40:43], v[68:71], v[16:19], v[40:43]
    v_mfma_f32_16x16x32_bf16 v[44:47], v[72:75], v[16:19], v[44:47]
    v_mfma_f32_16x16x32_bf16 v[48:51], v[76:79], v[16:19], v[48:51]
    v_mfma_f32_16x16x32_bf16 v[52:55], v[80:83], v[16:19], v[52:55]
    v_mfma_f32_16x16x32_bf16 v[56:59], v[84:87], v[16:19], v[56:59]
    v_mfma_f32_16x16x32_bf16 v[32:35], v[88:91], v[16:19], v[32:35]
    v_mfma_f32_16x16x32_bf16 v[36:39], v[92:95], v[16:19], v[36:39]
    v_mfma_f32_16x16x32_bf16 v[40:43], v[96:99], v[16:19], v[40:43]
    v_mfma_f32_16x16x32_bf16 v[44:47], v[100:103], v[16:19], v[44:47]
    v_mfma_f32_16x16x32_bf16 v[48:51], v[104:107], v[16:19], v[48:51]
    v_mfma_f32_16x16x32_bf16 v[52:55], v[108:111], v[16:19], v[52:55]
    v_mfma_f32_16x16x32_bf16 v[56:59], v[112:115], v[16:19], v[56:59]
    v_add_u32 v27, 0x15000, v25
    ds_read_b64_tr_b16 v[60:61], v27 offset:14336
    ds_read_b64_tr_b16 v[62:63], v27 offset:17920
    ds_read_b64_tr_b16 v[64:65], v27 offset:14368
    ds_read_b64_tr_b16 v[66:67], v27 offset:17952
    ds_read_b64_tr_b16 v[68:69], v27 offset:14400
    ds_read_b64_tr_b16 v[70:71], v27 offset:17984
    ds_read_b64_tr_b16 v[72:73], v27 offset:14432
    ds_read_b64_tr_b16 v[74:75], v27 offset:18016
    ds_read_b64_tr_b16 v[76:77], v27 offset:14464
    ds_read_b64_tr_b16 v[78:79], v27 offset:18048
    ds_read_b64_tr_b16 v[80:81], v27 offset:14496
    ds_read_b64_tr_b16 v[82:83], v27 offset:18080
    ds_read_b64_tr_b16 v[84:85], v27 offset:14528
    ds_read_b64_tr_b16 v[86:87], v27 offset:18112
    ds_read_b64_tr_b16 v[88:89], v27 offset:21504
    ds_read_b64_tr_b16 v[90:91], v27 offset:25088
    ds_read_b64_tr_b16 v[92:93], v27 offset:21536
    ds_read_b64_tr_b16 v[94:95], v27 offset:25120
    ds_read_b64_tr_b16 v[96:97], v27 offset:21568
    ds_read_b64_tr_b16 v[98:99], v27 offset:25152
    ds_read_b64_tr_b16 v[100:101], v27 offset:21600
    ds_read_b64_tr_b16 v[102:103], v27 offset:25184
    ds_read_b64_tr_b16 v[104:105], v27 offset:21632
    ds_read_b64_tr_b16 v[106:107], v27 offset:25216
    ds_read_b64_tr_b16 v[108:109], v27 offset:21664
    ds_read_b64_tr_b16 v[110:111], v27 offset:25248
    ds_read_b64_tr_b16 v[112:113], v27 offset:21696
    ds_read_b64_tr_b16 v[114:115], v27 offset:25280
    s_waitcnt lgkmcnt(0)
    v_mov_b32 v12, 24
    s_mov_b64 exec, 1
    ds_max_u32 v5, v12 offset:32
    s_mov_b64 exec, -1
    v_mfma_f32_16x16x32_bf16 v[32:35], v[60:63], v[16:19], v[32:35]
    v_mfma_f32_16x16x32_bf16 v[36:39], v[64:67], v[16:19], v[36:39]
    v_mfma_f32_16x16x32_bf16 v[40:43], v[68:71], v[16:19], v[40:43]
    v_mfma_f32_16x16x32_bf16 v[44:47], v[72:75], v[16:19], v[44:47]
    v_mfma_f32_16x16x32_bf16 v[48:51], v[76:79], v[16:19], v[48:51]
    v_mfma_f32_16x16x32_bf16 v[52:55], v[80:83], v[16:19], v[52:55]
    v_mfma_f32_16x16x32_bf16 v[56:59], v[84:87], v[16:19], v[56:59]
    v_mfma_f32_16x16x32_bf16 v[32:35], v[88:91], v[16:19], v[32:35]
    v_mfma_f32_16x16x32_bf16 v[36:39], v[92:95], v[16:19], v[36:39]
    v_mfma_f32_16x16x32_bf16 v[40:43], v[96:99], v[16:19], v[40:43]
    v_mfma_f32_16x16x32_bf16 v[44:47], v[100:103], v[16:19], v[44:47]
    v_mfma_f32_16x16x32_bf16 v[48:51], v[104:107], v[16:19], v[48:51]
    v_mfma_f32_16x16x32_bf16 v[52:55], v[108:111], v[16:19], v[52:55]
    v_mfma_f32_16x16x32_bf16 v[56:59], v[112:115], v[16:19], v[56:59]
    v_mov_b32 v12, 32767
    s_mov_b64 exec, 1
    ds_max_u32 v5, v12 offset:32
    s_mov_b64 exec, -1
    s_nop 7
    s_mov_b32 exec_lo, 0x00010001
    s_mov_b32 exec_hi, 0x00010001
    ds_write_b128 v28, v[32:35] offset:768
    ds_write_b128 v28, v[36:39] offset:832
    ds_write_b128 v28, v[40:43] offset:896
    ds_write_b128 v28, v[44:47] offset:960
    ds_write_b128 v28, v[48:51] offset:1024
    ds_write_b128 v28, v[52:55] offset:1088
    ds_write_b128 v28, v[56:59] offset:1152
    s_mov_b64 exec, -1
    v_mov_b32 v12, 3
    s_mov_b64 exec, 1
    ds_max_u32 v5, v12 offset:64
    s_mov_b64 exec, -1
L_sequential_preLN__sliding_local_dilated__mixer_s_mlp__prompt_kernel_pfrest_140:
    s_cmp_ge_u32 s58, 8
    s_cbranch_scc1 L_sequential_preLN__sliding_local_dilated__mixer_s_mlp__prompt_kernel_pfdone_141
    s_load_dword s79, s[4:5], 0
    s_load_dword s79, s[4:5], 64
    s_load_dword s79, s[4:5], 128
    s_load_dword s79, s[4:5], 192
    s_load_dword s79, s[4:5], 256
    s_load_dword s79, s[4:5], 320
    s_load_dword s79, s[4:5], 384
    s_load_dword s79, s[4:5], 448
    s_load_dword s79, s[4:5], 512
    s_load_dword s79, s[4:5], 576
    s_load_dword s79, s[4:5], 640
    s_load_dword s79, s[4:5], 704
    s_load_dword s79, s[4:5], 768
    s_load_dword s79, s[4:5], 832
    s_load_dword s79, s[4:5], 896
    s_load_dword s79, s[4:5], 960
    s_add_u32 s4, s4, 0xe000
    s_addc_u32 s5, s5, 0
    s_add_u32 s58, s58, 1
    s_branch L_sequential_preLN__sliding_local_dilated__mixer_s_mlp__prompt_kernel_pfrest_140
L_sequential_preLN__sliding_local_dilated__mixer_s_mlp__prompt_kernel_pfdone_141:
    s_waitcnt lgkmcnt(0)
    s_endpgm
L_sequential_preLN__sliding_local_dilated__mixer_s_mlp__prompt_kernel_lws_123:
    s_movk_i32 s42, 13
    s_call_b64 s[44:45], L_wait_a_0_52_0
    s_branch L_sequential_preLN__sliding_local_dilated__mixer_s_mlp__prompt_kernel_lwb_122
L_sequential_preLN__sliding_local_dilated__mixer_s_mlp__prompt_kernel_lws_125:
    s_movk_i32 s42, 14
    s_call_b64 s[44:45], L_wait_a_0_52_0
    s_branch L_sequential_preLN__sliding_local_dilated__mixer_s_mlp__prompt_kernel_lwb_124
L_sequential_preLN__sliding_local_dilated__mixer_s_mlp__prompt_kernel_lws_127:
    s_movk_i32 s42, 15
    s_call_b64 s[44:45], L_wait_a_0_52_0
    s_branch L_sequential_preLN__sliding_local_dilated__mixer_s_mlp__prompt_kernel_lwb_126
L_sequential_preLN__sliding_local_dilated__mixer_s_mlp__prompt_kernel_lws_129:
    s_movk_i32 s42, 16
    s_call_b64 s[44:45], L_wait_a_0_52_0
    s_branch L_sequential_preLN__sliding_local_dilated__mixer_s_mlp__prompt_kernel_lwb_128
L_sequential_preLN__sliding_local_dilated__mixer_s_mlp__prompt_kernel_lws_131:
    s_movk_i32 s42, 22
    s_call_b64 s[44:45], L_wait_a_0_52_1
    s_branch L_sequential_preLN__sliding_local_dilated__mixer_s_mlp__prompt_kernel_lwb_130
L_sequential_preLN__sliding_local_dilated__mixer_s_mlp__prompt_kernel_lws_133:
    s_movk_i32 s42, 21
    s_call_b64 s[44:45], L_wait_a_0_52_0
    s_branch L_sequential_preLN__sliding_local_dilated__mixer_s_mlp__prompt_kernel_lwb_132
L_sequential_preLN__sliding_local_dilated__mixer_s_mlp__prompt_kernel_lws_135:
    s_movk_i32 s42, 22
    s_call_b64 s[44:45], L_wait_a_0_52_0
    s_branch L_sequential_preLN__sliding_local_dilated__mixer_s_mlp__prompt_kernel_lwb_134
L_sequential_preLN__sliding_local_dilated__mixer_s_mlp__prompt_kernel_lws_137:
    s_movk_i32 s42, 23
    s_call_b64 s[44:45], L_wait_a_0_52_0
    s_branch L_sequential_preLN__sliding_local_dilated__mixer_s_mlp__prompt_kernel_lwb_136
L_sequential_preLN__sliding_local_dilated__mixer_s_mlp__prompt_kernel_lws_139:
    s_movk_i32 s42, 24
    s_call_b64 s[44:45], L_wait_a_0_52_0
    s_branch L_sequential_preLN__sliding_local_dilated__mixer_s_mlp__prompt_kernel_lwb_138
L_wait_a_48_37_0:
    s_mov_b32 s27, 0
    s_mov_b64 exec, 1
L_wait_a_48_37_0_t:
    ds_read_b128 v[8:11], v4 offset:48
    s_waitcnt lgkmcnt(0)
    v_min3_u32 v8, v8, v9, v10
    v_min_u32 v8, v8, v11
    s_nop 0
    v_readfirstlane_b32 s37, v8
    s_cmp_ge_u32 s37, s42
    s_cbranch_scc1 L_wait_a_48_37_0_o
    s_sleep 1
    s_add_u32 s27, s27, 1
    s_cmp_lt_u32 s27, 0x40000
    s_cbranch_scc1 L_wait_a_48_37_0_t
L_wait_a_48_37_0_o:
    s_mov_b64 exec, -1
    s_setpc_b64 s[44:45]
L_wait_a_0_52_0:
    s_mov_b32 s27, 0
    s_mov_b64 exec, 1
L_wait_a_0_52_0_t:
    ds_read_b128 v[8:11], v4 offset:0
    s_waitcnt lgkmcnt(0)
    v_min3_u32 v8, v8, v9, v10
    v_min_u32 v8, v8, v11
    s_nop 0
    v_readfirstlane_b32 s52, v8
    s_cmp_ge_u32 s52, s42
    s_cbranch_scc1 L_wait_a_0_52_0_o
    s_sleep 1
    s_add_u32 s27, s27, 1
    s_cmp_lt_u32 s27, 0x40000
    s_cbranch_scc1 L_wait_a_0_52_0_t
L_wait_a_0_52_0_o:
    s_mov_b64 exec, -1
    s_setpc_b64 s[44:45]
L_wait_a_0_52_1:
    s_mov_b32 s27, 0
    s_mov_b64 exec, 1
L_wait_a_0_52_1_t:
    ds_read_b128 v[8:11], v4 offset:0
    s_waitcnt lgkmcnt(0)
    v_min3_u32 v8, v8, v9, v10
    v_min_u32 v8, v8, v11
    s_nop 0
    v_readfirstlane_b32 s52, v8
    s_cmp_ge_u32 s52, s42
    s_cbranch_scc1 L_wait_a_0_52_1_o
    s_cmp_ge_u32 s58, 8
    s_cbranch_scc1 L_wait_a_0_52_1_n
    s_load_dword s79, s[4:5], 0
    s_load_dword s79, s[4:5], 64
    s_load_dword s79, s[4:5], 128
    s_load_dword s79, s[4:5], 192
    s_load_dword s79, s[4:5], 256
    s_load_dword s79, s[4:5], 320
    s_load_dword s79, s[4:5], 384
    s_load_dword s79, s[4:5], 448
    s_load_dword s79, s[4:5], 512
    s_load_dword s79, s[4:5], 576
    s_load_dword s79, s[4:5], 640
    s_load_dword s79, s[4:5], 704
    s_load_dword s79, s[4:5], 768
    s_load_dword s79, s[4:5], 832
    s_load_dword s79, s[4:5], 896
    s_load_dword s79, s[4:5], 960
    s_add_u32 s4, s4, 0xe000
    s_addc_u32 s5, s5, 0
    s_add_u32 s58, s58, 1
L_wait_a_0_52_1_n:
    s_sleep 1
    s_add_u32 s27, s27, 1
    s_cmp_lt_u32 s27, 0x40000
    s_cbranch_scc1 L_wait_a_0_52_1_t
L_wait_a_0_52_1_o:
    s_mov_b64 exec, -1
    s_setpc_b64 s[44:45]
L_pf:
    s_mov_b32 s39, 3
    v_mov_b32 v4, 0x26c00
    s_lshl_b32 s3, s26, 2
    v_add_u32 v5, s3, v4
    v_mov_b32 v16, 0x3f803f80
    v_mov_b32 v17, 0x3f803f80
    v_mov_b32 v18, 0x3f803f80
    v_mov_b32 v19, 0x3f803f80
    v_mov_b32 v7, 0
    s_mov_b32 s37, 0
    s_mov_b32 s52, 0
    s_waitcnt lgkmcnt(0)
    s_barrier
    v_mov_b32 v12, 32767
    s_mov_b64 exec, 1
    ds_max_u32 v5, v12 offset:0
    s_mov_b64 exec, -1
    v_mov_b32 v12, 32767
    s_mov_b64 exec, 1
    ds_max_u32 v5, v12 offset:32
    s_mov_b64 exec, -1
    v_mov_b32 v12, 32767
    s_mov_b64 exec, 1
    ds_max_u32 v5, v12 offset:64
    s_mov_b64 exec, -1
    s_mul_i32 s33, s2, 7168
    s_add_u32 s54, s16, s33
    s_addc_u32 s55, s17, 0
    s_add_u32 s56, s18, s33
    s_addc_u32 s57, s19, 0
    s_mov_b32 s27, 0
    s_lshl_b32 s33, s29, 3
    s_add_u32 s33, s33, s27
    s_mul_i32 s33, s33, 56
    s_lshr_b32 s34, s30, 1
    s_mul_i32 s34, s34, 7
    s_add_u32 s33, s33, s34
    s_and_b32 s34, s30, 1
    s_mul_i32 s34, s34, 3
    s_add_u32 s33, s33, s34
    s_lshl_b32 s33, s33, 10
    s_add_u32 s33, s33, 0x800000
    s_add_u32 s58, s24, s33
    s_addc_u32 s59, s25, 0
    s_add_u32 s33, s33, 0xe000
    s_add_u32 s60, s24, s33
    s_addc_u32 s61, s25, 0
    s_add_u32 s33, s33, 0xe000
    s_add_u32 s62, s24, s33
    s_addc_u32 s63, s25, 0
    s_add_u32 s33, s33, 0xe000
    s_add_u32 s64, s24, s33
    s_addc_u32 s65, s25, 0
    s_add_u32 s33, s33, 0xe000
    s_add_u32 s66, s24, s33
    s_addc_u32 s67, s25, 0
    s_mov_b32 s68, 0
    s_cmp_lt_u32 s52, 1
    s_cbranch_scc1 L_sequential_preLN__sliding_local_dilated__mixer_s_mlp__prompt_kernel_lws_143
L_sequential_preLN__sliding_local_dilated__mixer_s_mlp__prompt_kernel_lwb_142:
    s_lshl_b32 s33, s31, 16
    s_lshl_b32 s34, s32, 11
    s_add_u32 s33, s33, 0x200000
    s_add_u32 s33, s33, s34
    s_add_u32 s70, s24, s33
    s_addc_u32 s71, s25, 0
    s_mov_b32 s33, 0
L_sequential_preLN__sliding_local_dilated__mixer_s_mlp__prompt_kernel_po_144:
    s_load_dword s79, s[70:71], 0
    s_load_dword s79, s[70:71], 64
    s_load_dword s79, s[70:71], 128
    s_load_dword s79, s[70:71], 192
    s_load_dword s79, s[70:71], 256
    s_load_dword s79, s[70:71], 320
    s_load_dword s79, s[70:71], 384
    s_load_dword s79, s[70:71], 448
    s_load_dword s79, s[70:71], 512
    s_load_dword s79, s[70:71], 576
    s_load_dword s79, s[70:71], 640
    s_load_dword s79, s[70:71], 704
    s_load_dword s79, s[70:71], 768
    s_load_dword s79, s[70:71], 832
    s_load_dword s79, s[70:71], 896
    s_load_dword s79, s[70:71], 960
    s_load_dword s79, s[70:71], 1024
    s_load_dword s79, s[70:71], 1088
    s_load_dword s79, s[70:71], 1152
    s_load_dword s79, s[70:71], 1216
    s_load_dword s79, s[70:71], 1280
    s_load_dword s79, s[70:71], 1344
    s_load_dword s79, s[70:71], 1408
    s_load_dword s79, s[70:71], 1472
    s_load_dword s79, s[70:71], 1536
    s_load_dword s79, s[70:71], 1600
    s_load_dword s79, s[70:71], 1664
    s_load_dword s79, s[70:71], 1728
    s_load_dword s79, s[70:71], 1792
    s_load_dword s79, s[70:71], 1856
    s_load_dword s79, s[70:71], 1920
    s_load_dword s79, s[70:71], 1984
    s_add_u32 s70, s70, 0x4000
    s_addc_u32 s71, s71, 0
    s_add_u32 s33, s33, 1
    s_cmp_lt_u32 s33, 4
    s_cbranch_scc1 L_sequential_preLN__sliding_local_dilated__mixer_s_mlp__prompt_kernel_po_144
L_sequential_preLN__sliding_local_dilated__mixer_s_mlp__prompt_kernel_pfrest_145:
    s_cmp_ge_u32 s68, 16
    s_cbranch_scc1 L_sequential_preLN__sliding_local_dilated__mixer_s_mlp__prompt_kernel_pfdone_146
    s_load_dword s79, s[54:55], 0
    s_load_dword s79, s[54:55], 64
    s_load_dword s79, s[54:55], 128
    s_load_dword s79, s[54:55], 192
    s_load_dword s79, s[54:55], 256
    s_load_dword s79, s[54:55], 320
    s_load_dword s79, s[54:55], 384
    s_load_dword s79, s[54:55], 448
    s_load_dword s79, s[54:55], 512
    s_load_dword s79, s[54:55], 576
    s_load_dword s79, s[54:55], 640
    s_load_dword s79, s[54:55], 704
    s_load_dword s79, s[54:55], 768
    s_load_dword s79, s[54:55], 832
    s_add_u32 s54, s54, 896
    s_addc_u32 s55, s55, 0
    s_add_u32 s68, s68, 1
    s_cmp_eq_u32 s68, 8
    s_cselect_b64 s[54:55], s[56:57], s[54:55]
    s_cmp_eq_u32 s68, 16
    s_cselect_b64 s[54:55], s[58:59], s[54:55]
    s_cmp_eq_u32 s68, 21
    s_cselect_b64 s[54:55], s[60:61], s[54:55]
    s_cmp_eq_u32 s68, 26
    s_cselect_b64 s[54:55], s[62:63], s[54:55]
    s_cmp_eq_u32 s68, 31
    s_cselect_b64 s[54:55], s[64:65], s[54:55]
    s_cmp_eq_u32 s68, 36
    s_cselect_b64 s[54:55], s[66:67], s[54:55]
    s_branch L_sequential_preLN__sliding_local_dilated__mixer_s_mlp__prompt_kernel_pfrest_145
L_sequential_preLN__sliding_local_dilated__mixer_s_mlp__prompt_kernel_pfdone_146:
    s_mul_i32 s33, s29, 448
    s_lshr_b32 s34, s30, 1
    s_mul_i32 s34, s34, 7
    s_add_u32 s33, s33, s34
    s_and_b32 s34, s30, 1
    s_lshl_b32 s34, s34, 2
    s_add_u32 s33, s33, s34
    s_lshl_b32 s33, s33, 10
    s_add_u32 s33, s33, 0x800800
    s_add_u32 s70, s24, s33
    s_addc_u32 s71, s25, 0
    s_mov_b32 s68, 0
L_sequential_preLN__sliding_local_dilated__mixer_s_mlp__prompt_kernel_pfg_147:
    s_cmp_ge_u32 s68, 8
    s_cbranch_scc1 L_sequential_preLN__sliding_local_dilated__mixer_s_mlp__prompt_kernel_pfgd_148
    s_load_dword s79, s[70:71], 0
    s_load_dword s79, s[70:71], 64
    s_load_dword s79, s[70:71], 128
    s_load_dword s79, s[70:71], 192
    s_load_dword s79, s[70:71], 256
    s_load_dword s79, s[70:71], 320
    s_load_dword s79, s[70:71], 384
    s_load_dword s79, s[70:71], 448
    s_load_dword s79, s[70:71], 512
    s_load_dword s79, s[70:71], 576
    s_load_dword s79, s[70:71], 640
    s_load_dword s79, s[70:71], 704
    s_load_dword s79, s[70:71], 768
    s_load_dword s79, s[70:71], 832
    s_load_dword s79, s[70:71], 896
    s_load_dword s79, s[70:71], 960
    s_add_u32 s70, s70, 0xe000
    s_addc_u32 s71, s71, 0
    s_add_u32 s68, s68, 1
    s_branch L_sequential_preLN__sliding_local_dilated__mixer_s_mlp__prompt_kernel_pfg_147
L_sequential_preLN__sliding_local_dilated__mixer_s_mlp__prompt_kernel_pfgd_148:
    s_waitcnt lgkmcnt(0)
    s_endpgm
L_sequential_preLN__sliding_local_dilated__mixer_s_mlp__prompt_kernel_lws_143:
    s_movk_i32 s42, 1
    s_call_b64 s[44:45], L_wait_p_0_52_0
    s_branch L_sequential_preLN__sliding_local_dilated__mixer_s_mlp__prompt_kernel_lwb_142
L_wait_p_0_52_0:
    s_mov_b32 s27, 0
    s_mov_b64 exec, 1
L_wait_p_0_52_0_t:
    ds_read_b128 v[8:11], v4 offset:0
    s_waitcnt lgkmcnt(0)
    v_min3_u32 v8, v8, v9, v10
    v_min_u32 v8, v8, v11
    s_nop 0
    v_readfirstlane_b32 s52, v8
    s_cmp_ge_u32 s52, s42
    s_cbranch_scc1 L_wait_p_0_52_0_o
    s_sleep 1
    s_add_u32 s27, s27, 1
    s_cmp_lt_u32 s27, 0x40000
    s_cbranch_scc1 L_wait_p_0_52_0_t
L_wait_p_0_52_0_o:
    s_mov_b64 exec, -1
    s_setpc_b64 s[44:45]
L_compute:
    v_mov_b32 v4, 0x26c00
    s_lshl_b32 s3, s26, 2
    v_add_u32 v5, s3, v4
    v_mov_b32 v16, 0x3f803f80
    v_mov_b32 v17, 0x3f803f80
    v_mov_b32 v18, 0x3f803f80
    v_mov_b32 v19, 0x3f803f80
    v_mov_b32 v7, 0
    s_mov_b32 s37, 0
    s_mov_b32 s39, 0
    s_mov_b32 s52, 0
    s_mov_b32 s53, 0
    v_lshlrev_b32 v24, 4, v1
    v_mov_b32 v8, 0
    v_mov_b32 v9, 0
    v_mov_b32 v10, 0
    v_mov_b32 v11, 0
    s_lshl_b32 s33, s26, 10
    v_add3_u32 v12, v4, v24, s33
    ds_write_b128 v12, v[8:11]
    s_waitcnt lgkmcnt(0)
    s_mov_b32 s48, s24
    s_mov_b32 s49, s25
    s_mov_b32 s50, 0xfe8000
    s_mov_b32 s51, 0x20000
    s_mov_b32 s56, s4
    s_mov_b32 s57, s5
    s_mov_b32 s58, 0x200000
    s_mov_b32 s59, 0x20000
    s_mov_b32 s60, s22
    s_mov_b32 s61, s23
    s_mov_b32 s62, 0x100
    s_mov_b32 s63, 0x20000
    s_or_b32 s33, s2, s26
    s_cmp_lg_u32 s33, 0
    s_cbranch_scc1 L_sequential_preLN__sliding_local_dilated__mixer_s_mlp__prompt_kernel_notzero_149
    s_memrealtime s[44:45]
    s_waitcnt lgkmcnt(0)
    s_or_b32 s33, s44, 1
    v_mov_b32 v8, s33
    s_mov_b64 exec, 1
    buffer_store_dword v8, v7, s[60:63], 0 offen sc1
    s_mov_b64 exec, -1
L_sequential_preLN__sliding_local_dilated__mixer_s_mlp__prompt_kernel_notzero_149:
    s_lshl_b32 s64, s29, 7
    s_lshl_b32 s33, s30, 3
    s_add_u32 s64, s64, s33
    s_lshl_b32 s33, s26, 1
    s_add_u32 s64, s64, s33
    s_lshl_b32 s33, s64, 10
    buffer_load_dwordx4 v[28:31], v24, s[56:59], s33 offen
    buffer_load_dwordx4 v[32:35], v24, s[56:59], s33 offen offset:1024
    s_barrier
    s_lshr_b32 s65, s26, 1
    s_and_b32 s66, s26, 1
    v_lshrrev_b32 v8, 1, v2
    v_xor_b32 v8, v8, v3
    v_lshlrev_b32 v8, 4, v8
    v_lshl_or_b32 v8, v2, 7, v8
    s_lshl_b32 s33, s65, 13
    s_add_u32 s33, s33, 2048
    v_add_u32 v124, s33, v8
    v_and_b32 v9, 7, v2
    v_lshrrev_b32 v10, 1, v9
    v_xor_b32 v10, v10, v3
    v_lshlrev_b32 v10, 4, v10
    v_lshl_or_b32 v9, v9, 7, v10
    s_cmp_eq_u32 s65, 1
    s_cselect_b64 vcc, -1, 0
    v_add_u32 v10, 6144, v8
    v_cndmask_b32 v126, v9, v10, vcc
    v_xor_b32 v9, 1088, v9
    v_add_u32 v10, 8192, v8
    v_cndmask_b32 v128, v9, v10, vcc
    v_xor_b32 v125, 64, v124
    v_xor_b32 v127, 64, v126
    v_xor_b32 v129, 64, v128
    v_bfe_u32 v8, v1, 2, 2
    v_lshl_add_u32 v8, v3, 3, v8
    v_mul_u32_u24 v8, 192, v8
    v_and_b32 v9, 1, v3
    v_xor_b32 v9, s66, v9
    v_lshl_add_u32 v8, v9, 5, v8
    v_and_b32 v9, 3, v1
    v_lshl_add_u32 v130, v9, 3, v8
    v_add_u32 v131, 0xf000, v124
    v_add_u32 v132, 0xf000, v125
    v_add_u32 v133, 0xf000, v126
    v_add_u32 v134, 0xf000, v127
    v_add_u32 v135, 0xf000, v128
    v_add_u32 v136, 0xf000, v129
    v_add_u32 v137, 0xf000, v130
    v_add_u32 v138, 0x1e000, v124
    v_add_u32 v139, 0x1e000, v125
    v_add_u32 v140, 0x1e000, v126
    v_add_u32 v141, 0x1e000, v127
    v_add_u32 v142, 0x1e000, v128
    v_add_u32 v143, 0x1e000, v129
    v_add_u32 v144, 0x1e000, v130
    s_lshl_b32 s33, s65, 9
    v_lshl_add_u32 v148, v2, 3, v4
    v_add_u32 v148, s33, v148
    s_lshl_b32 s33, s65, 8
    v_lshl_add_u32 v150, v3, 4, v4
    v_add_u32 v149, s33, v150
    s_lshl_b32 s33, s66, 6
    v_add_u32 v150, s33, v150
    v_lshl_add_u32 v151, v2, 2, v4
    v_add_u32 v151, s33, v151
    v_lshl_add_u32 v158, v1, 3, v4
    s_or_b32 s33, s29, s65
    s_cmp_eq_u32 s33, 0
    s_cselect_b64 s[44:45], 0, -1
    v_mov_b32 v153, 0xcf6e6b28
    v_lshl_add_u32 v8, v3, 2, 0
    v_sub_u32 v8, v2, v8
    v_cmp_le_i32 s[4:5], 0, v8
    v_and_b32 v9, 15, v8
    v_cmp_ge_u32 s[12:13], 7, v9
    v_mov_b32 v10, 0xffff
    s_or_b64 s[68:69], s[4:5], s[44:45]
    v_cndmask_b32 v9, 0, v10, s[4:5]
    s_and_b64 s[68:69], s[68:69], s[12:13]
    v_mov_b32 v154, v9
    v_lshl_add_u32 v8, v3, 2, 1
    v_sub_u32 v8, v2, v8
    v_cmp_le_i32 s[6:7], 0, v8
    v_and_b32 v9, 15, v8
    v_cmp_ge_u32 s[14:15], 7, v9
    v_mov_b32 v10, 0xffff0000
    s_or_b64 s[70:71], s[6:7], s[44:45]
    v_cndmask_b32 v9, 0, v10, s[6:7]
    s_and_b64 s[70:71], s[70:71], s[14:15]
    v_or_b32 v154, v154, v9
    v_not_b32 v156, v154
    v_lshl_add_u32 v8, v3, 2, 2
    v_sub_u32 v8, v2, v8
    v_cmp_le_i32 s[8:9], 0, v8
    v_and_b32 v9, 15, v8
    v_cmp_ge_u32 s[16:17], 7, v9
    v_mov_b32 v10, 0xffff
    s_or_b64 s[72:73], s[8:9], s[44:45]
    v_cndmask_b32 v9, 0, v10, s[8:9]
    s_and_b64 s[72:73], s[72:73], s[16:17]
    v_mov_b32 v155, v9
    v_lshl_add_u32 v8, v3, 2, 3
    v_sub_u32 v8, v2, v8
    v_cmp_le_i32 s[10:11], 0, v8
    v_and_b32 v9, 15, v8
    v_cmp_ge_u32 s[18:19], 7, v9
    v_mov_b32 v10, 0xffff0000
    s_or_b64 s[74:75], s[10:11], s[44:45]
    v_cndmask_b32 v9, 0, v10, s[10:11]
    s_and_b64 s[74:75], s[74:75], s[18:19]
    v_or_b32 v155, v155, v9
    v_not_b32 v157, v155
    v_and_b32 v8, 1, v3
    v_lshl_add_u32 v8, v2, 1, v8
    v_lshrrev_b32 v9, 4, v8
    v_and_b32 v8, 15, v8
    v_lshlrev_b32 v8, 4, v8
    v_lshl_add_u32 v8, v9, 14, v8
    v_lshrrev_b32 v9, 1, v3
    v_lshl_add_u32 v152, v9, 8, v8
    s_lshl_b32 s41, s29, 1
    s_add_u32 s41, s41, s65
    s_lshl_b32 s40, s41, 16
    s_lshl_b32 s41, s41, 9
    s_lshl_b32 s33, s30, 1
    s_add_u32 s33, s33, s66
    s_lshl_b32 s34, s33, 9
    s_add_u32 s40, s40, s34
    s_add_u32 s76, s40, 0x8000
    s_lshl_b32 s33, s33, 2
    s_add_u32 s41, s41, s33
    s_add_u32 s41, s41, 0xfd0000
    s_mov_b32 s77, 0x3eb8aa3b
    s_waitcnt vmcnt(0)
    v_mov_b32 v36, 0
    v_mov_b32 v37, 0
    v_mov_b32 v38, 0
    v_mov_b32 v39, 0
    v_dot2c_f32_bf16 v36, v28, v16
    v_dot2c_f32_bf16 v38, v28, v28
    v_dot2c_f32_bf16 v37, v32, v16
    v_dot2c_f32_bf16 v39, v32, v32
    v_dot2c_f32_bf16 v36, v29, v16
    v_dot2c_f32_bf16 v38, v29, v29
    v_dot2c_f32_bf16 v37, v33, v16
    v_dot2c_f32_bf16 v39, v33, v33
    v_dot2c_f32_bf16 v36, v30, v16
    v_dot2c_f32_bf16 v38, v30, v30
    v_dot2c_f32_bf16 v37, v34, v16
    v_dot2c_f32_bf16 v39, v34, v34
    v_dot2c_f32_bf16 v36, v31, v16
    v_dot2c_f32_bf16 v38, v31, v31
    v_dot2c_f32_bf16 v37, v35, v16
    v_dot2c_f32_bf16 v39, v35, v35
    s_nop 2
    v_permlane32_swap_b32 v36, v37
    v_permlane32_swap_b32 v38, v39
    s_nop 1
    v_add_f32 v36, v36, v37
    v_add_f32 v38, v38, v39
    s_nop 1
    v_permlane16_swap_b32 v36, v38
    s_nop 1
    v_add_f32 v36, v36, v38
    s_nop 1
    v_add_f32_dpp v36, v36, v36 row_ror:8 row_mask:0xf bank_mask:0xf
    s_nop 1
    v_add_f32_dpp v36, v36, v36 row_ror:4 row_mask:0xf bank_mask:0xf
    s_nop 1
    v_add_f32_dpp v36, v36, v36 row_ror:2 row_mask:0xf bank_mask:0xf
    s_nop 1
    v_add_f32_dpp v36, v36, v36 row_ror:1 row_mask:0xf bank_mask:0xf
    v_mov_b32 v38, v36
    s_nop 1
    v_permlane16_swap_b32 v36, v38
    s_nop 1
    v_mul_f32 v29, 0xbb000000, v36
    v_mul_f32 v37, 0x3b000000, v38
    v_fma_f32 v37, -v29, v29, v37
    v_max_f32 v37, 0, v37
    v_add_f32 v28, 0x3727c5ac, v37
    v_rsq_f32 v28, v28
    s_nop 0
    v_mul_f32 v29, v29, v28
    v_lshrrev_b32 v36, 5, v1
    v_lshl_add_u32 v36, v36, 3, v4
    s_lshl_b32 s33, s26, 4
    v_add_u32 v36, s33, v36
    s_mov_b32 exec_lo, 1
    s_mov_b32 exec_hi, 1
    ds_write_b64 v36, v[28:29] offset:1216
    s_mov_b64 exec, -1
    v_mov_b32 v12, 1
    s_mov_b64 exec, 1
    ds_max_u32 v5, v12 offset:48
    s_mov_b64 exec, -1
    s_lshl_b32 s33, s31, 2
    s_add_u32 s33, s33, s26
    s_lshl_b32 s33, s33, 14
    s_lshl_b32 s34, s32, 7
    s_add_u32 s33, s33, s34
    v_lshlrev_b32 v8, 10, v2
    v_lshl_add_u32 v8, v3, 3, v8
    buffer_load_dwordx2 a[72:73], v8, s[56:59], s33 offen offset:0
    buffer_load_dwordx2 a[74:75], v8, s[56:59], s33 offen offset:32
    buffer_load_dwordx2 a[76:77], v8, s[56:59], s33 offen offset:64
    buffer_load_dwordx2 a[78:79], v8, s[56:59], s33 offen offset:96
    s_cmp_lt_u32 s52, 1
    s_cbranch_scc1 L_sequential_preLN__sliding_local_dilated__mixer_s_mlp__prompt_kernel_lws_151
L_sequential_preLN__sliding_local_dilated__mixer_s_mlp__prompt_kernel_lwb_150:
    ds_read_b64_tr_b16 a[0:1], v130 offset:18432
    ds_read_b64_tr_b16 a[2:3], v130 offset:19200
    ds_read_b64_tr_b16 a[4:5], v130 offset:18496
    ds_read_b64_tr_b16 a[6:7], v130 offset:19264
    ds_read_b64_tr_b16 a[8:9], v130 offset:18560
    ds_read_b64_tr_b16 a[10:11], v130 offset:19328
    ds_read_b128 a[32:35], v124 offset:0
    ds_read_b128 a[36:39], v124 offset:2048
    ds_read_b128 a[40:43], v124 offset:4096
    ds_read_b128 a[44:47], v124 offset:6144
    ds_read_b128 a[24:27], v126 offset:0
    ds_read_b128 a[28:31], v128 offset:0
    s_waitcnt lgkmcnt(5)
    v_mfma_f32_16x16x32_bf16 v[48:51], a[0:3], a[32:35], 0
    ds_read_b64_tr_b16 a[12:13], v130 offset:24576
    v_mfma_f32_16x16x32_bf16 v[72:75], a[4:7], a[32:35], 0
    ds_read_b64_tr_b16 a[14:15], v130 offset:25344
    v_mfma_f32_16x16x32_bf16 v[96:99], a[32:35], a[8:11], 0
    ds_read_b64_tr_b16 a[16:17], v130 offset:24640
    s_waitcnt lgkmcnt(7)
    v_mfma_f32_16x16x32_bf16 v[52:55], a[0:3], a[36:39], 0
    ds_read_b64_tr_b16 a[18:19], v130 offset:25408
    v_mfma_f32_16x16x32_bf16 v[76:79], a[4:7], a[36:39], 0
    ds_read_b64_tr_b16 a[20:21], v130 offset:24704
    v_mfma_f32_16x16x32_bf16 v[100:103], a[36:39], a[8:11], 0
    ds_read_b64_tr_b16 a[22:23], v130 offset:25472
    s_waitcnt lgkmcnt(9)
    v_mfma_f32_16x16x32_bf16 v[56:59], a[0:3], a[40:43], 0
    ds_read_b128 a[56:59], v125 offset:0
    s_mov_b64 exec, 1
    ds_read_b128 v[20:23], v4 offset:0
    s_mov_b64 exec, -1
    v_mfma_f32_16x16x32_bf16 v[80:83], a[4:7], a[40:43], 0
    ds_read_b128 a[60:63], v125 offset:2048
    v_mfma_f32_16x16x32_bf16 v[104:107], a[40:43], a[8:11], 0
    ds_read_b128 a[64:67], v125 offset:4096
    s_waitcnt lgkmcnt(12)
    v_mfma_f32_16x16x32_bf16 v[60:63], a[0:3], a[44:47], 0
    ds_read_b128 a[68:71], v125 offset:6144
    v_mfma_f32_16x16x32_bf16 v[84:87], a[4:7], a[44:47], 0
    ds_read_b128 a[48:51], v127 offset:0
    v_mfma_f32_16x16x32_bf16 v[108:111], a[44:47], a[8:11], 0
    ds_read_b128 a[52:55], v129 offset:0
    s_waitcnt lgkmcnt(14)
    v_mfma_f32_16x16x32_bf16 v[64:67], a[4:7], a[24:27], 0
    v_mfma_f32_16x16x32_bf16 v[88:91], a[24:27], a[8:11], 0
    s_waitcnt lgkmcnt(13)
    v_mfma_f32_16x16x32_bf16 v[68:71], a[4:7], a[28:31], 0
    v_mfma_f32_16x16x32_bf16 v[92:95], a[28:31], a[8:11], 0
    s_waitcnt lgkmcnt(5)
    v_min3_u32 v20, v20, v21, v22
    v_min_u32 v20, v20, v23
    s_nop 0
    v_readfirstlane_b32 s52, v20
    s_cmp_lt_u32 s52, 2
    s_cbranch_scc1 L_sequential_preLN__sliding_local_dilated__mixer_s_mlp__prompt_kernel_lws_153
L_sequential_preLN__sliding_local_dilated__mixer_s_mlp__prompt_kernel_lwb_152:
    s_waitcnt lgkmcnt(6)
    v_mfma_f32_16x16x32_bf16 v[48:51], a[12:15], a[56:59], v[48:51]
    ds_read_b64_tr_b16 a[0:1], v130 offset:49152
    v_mfma_f32_16x16x32_bf16 v[72:75], a[16:19], a[56:59], v[72:75]
    ds_read_b64_tr_b16 a[2:3], v130 offset:49920
    v_mfma_f32_16x16x32_bf16 v[96:99], a[56:59], a[20:23], v[96:99]
    ds_read_b64_tr_b16 a[4:5], v130 offset:49216
    s_waitcnt lgkmcnt(7)
    v_mfma_f32_16x16x32_bf16 v[52:55], a[12:15], a[60:63], v[52:55]
    ds_read_b64_tr_b16 a[6:7], v130 offset:49984
    v_mfma_f32_16x16x32_bf16 v[76:79], a[16:19], a[60:63], v[76:79]
    ds_read_b64_tr_b16 a[8:9], v130 offset:49280
    v_mfma_f32_16x16x32_bf16 v[100:103], a[60:63], a[20:23], v[100:103]
    ds_read_b64_tr_b16 a[10:11], v130 offset:50048
    s_waitcnt lgkmcnt(9)
    v_mfma_f32_16x16x32_bf16 v[56:59], a[12:15], a[64:67], v[56:59]
    ds_read_b128 a[32:35], v124 offset:30720
    v_mfma_f32_16x16x32_bf16 v[80:83], a[16:19], a[64:67], v[80:83]
    ds_read_b128 a[36:39], v124 offset:32768
    v_mfma_f32_16x16x32_bf16 v[104:107], a[64:67], a[20:23], v[104:107]
    ds_read_b128 a[40:43], v124 offset:34816
    s_waitcnt lgkmcnt(11)
    v_mfma_f32_16x16x32_bf16 v[60:63], a[12:15], a[68:71], v[60:63]
    ds_read_b128 a[44:47], v124 offset:36864
    v_mfma_f32_16x16x32_bf16 v[84:87], a[16:19], a[68:71], v[84:87]
    ds_read_b128 a[24:27], v126 offset:30720
    v_mfma_f32_16x16x32_bf16 v[108:111], a[68:71], a[20:23], v[108:111]
    ds_read_b128 a[28:31], v128 offset:30720
    s_waitcnt lgkmcnt(13)
    v_mfma_f32_16x16x32_bf16 v[64:67], a[16:19], a[48:51], v[64:67]
    v_mfma_f32_16x16x32_bf16 v[88:91], a[48:51], a[20:23], v[88:91]
    s_waitcnt lgkmcnt(12)
    v_mfma_f32_16x16x32_bf16 v[68:71], a[16:19], a[52:55], v[68:71]
    v_mfma_f32_16x16x32_bf16 v[92:95], a[52:55], a[20:23], v[92:95]
    v_mov_b32 v12, 1
    s_mov_b64 exec, 1
    ds_max_u32 v5, v12 offset:16
    s_mov_b64 exec, -1
    s_waitcnt lgkmcnt(6)
    v_mfma_f32_16x16x32_bf16 v[48:51], a[0:3], a[32:35], v[48:51]
    ds_read_b64_tr_b16 a[12:13], v130 offset:55296
    v_mfma_f32_16x16x32_bf16 v[72:75], a[4:7], a[32:35], v[72:75]
    ds_read_b64_tr_b16 a[14:15], v130 offset:56064
    v_mfma_f32_16x16x32_bf16 v[96:99], a[32:35], a[8:11], v[96:99]
    ds_read_b64_tr_b16 a[16:17], v130 offset:55360
    s_waitcnt lgkmcnt(8)
    v_mfma_f32_16x16x32_bf16 v[52:55], a[0:3], a[36:39], v[52:55]
    ds_read_b64_tr_b16 a[18:19], v130 offset:56128
    v_mfma_f32_16x16x32_bf16 v[76:79], a[4:7], a[36:39], v[76:79]
    ds_read_b64_tr_b16 a[20:21], v130 offset:55424
    v_mfma_f32_16x16x32_bf16 v[100:103], a[36:39], a[8:11], v[100:103]
    ds_read_b64_tr_b16 a[22:23], v130 offset:56192
    s_waitcnt lgkmcnt(10)
    v_mfma_f32_16x16x32_bf16 v[56:59], a[0:3], a[40:43], v[56:59]
    ds_read_b128 a[56:59], v125 offset:30720
    s_mov_b64 exec, 1
    ds_read_b128 v[20:23], v4 offset:0
    s_mov_b64 exec, -1
    v_mfma_f32_16x16x32_bf16 v[80:83], a[4:7], a[40:43], v[80:83]
    ds_read_b128 a[60:63], v125 offset:32768
    v_mfma_f32_16x16x32_bf16 v[104:107], a[40:43], a[8:11], v[104:107]
    ds_read_b128 a[64:67], v125 offset:34816
    s_waitcnt lgkmcnt(13)
    v_mfma_f32_16x16x32_bf16 v[60:63], a[0:3], a[44:47], v[60:63]
    ds_read_b128 a[68:71], v125 offset:36864
    v_mfma_f32_16x16x32_bf16 v[84:87], a[4:7], a[44:47], v[84:87]
    ds_read_b128 a[48:51], v127 offset:30720
    v_mfma_f32_16x16x32_bf16 v[108:111], a[44:47], a[8:11], v[108:111]
    ds_read_b128 a[52:55], v129 offset:30720
    s_waitcnt lgkmcnt(15)
    v_mfma_f32_16x16x32_bf16 v[64:67], a[4:7], a[24:27], v[64:67]
    v_mfma_f32_16x16x32_bf16 v[88:91], a[24:27], a[8:11], v[88:91]
    s_waitcnt lgkmcnt(14)
    v_mfma_f32_16x16x32_bf16 v[68:71], a[4:7], a[28:31], v[68:71]
    v_mfma_f32_16x16x32_bf16 v[92:95], a[28:31], a[8:11], v[92:95]
    s_waitcnt lgkmcnt(5)
    v_min3_u32 v20, v20, v21, v22
    v_min_u32 v20, v20, v23
    s_nop 0
    v_readfirstlane_b32 s52, v20
    s_cmp_lt_u32 s52, 3
    s_cbranch_scc1 L_sequential_preLN__sliding_local_dilated__mixer_s_mlp__prompt_kernel_lws_155
L_sequential_preLN__sliding_local_dilated__mixer_s_mlp__prompt_kernel_lwb_154:
    s_waitcnt lgkmcnt(6)
    v_mfma_f32_16x16x32_bf16 v[48:51], a[12:15], a[56:59], v[48:51]
    ds_read_b64_tr_b16 a[0:1], v137 offset:18432
    v_mfma_f32_16x16x32_bf16 v[72:75], a[16:19], a[56:59], v[72:75]
    ds_read_b64_tr_b16 a[2:3], v137 offset:19200
    v_mfma_f32_16x16x32_bf16 v[96:99], a[56:59], a[20:23], v[96:99]
    ds_read_b64_tr_b16 a[4:5], v137 offset:18496
    s_waitcnt lgkmcnt(7)
    v_mfma_f32_16x16x32_bf16 v[52:55], a[12:15], a[60:63], v[52:55]
    ds_read_b64_tr_b16 a[6:7], v137 offset:19264
    v_mfma_f32_16x16x32_bf16 v[76:79], a[16:19], a[60:63], v[76:79]
    ds_read_b64_tr_b16 a[8:9], v137 offset:18560
    v_mfma_f32_16x16x32_bf16 v[100:103], a[60:63], a[20:23], v[100:103]
    ds_read_b64_tr_b16 a[10:11], v137 offset:19328
    s_waitcnt lgkmcnt(9)
    v_mfma_f32_16x16x32_bf16 v[56:59], a[12:15], a[64:67], v[56:59]
    ds_read_b128 a[32:35], v131 offset:0
    v_mfma_f32_16x16x32_bf16 v[80:83], a[16:19], a[64:67], v[80:83]
    ds_read_b128 a[36:39], v131 offset:2048
    v_mfma_f32_16x16x32_bf16 v[104:107], a[64:67], a[20:23], v[104:107]
    ds_read_b128 a[40:43], v131 offset:4096
    s_waitcnt lgkmcnt(11)
    v_mfma_f32_16x16x32_bf16 v[60:63], a[12:15], a[68:71], v[60:63]
    ds_read_b128 a[44:47], v131 offset:6144
    v_mfma_f32_16x16x32_bf16 v[84:87], a[16:19], a[68:71], v[84:87]
    ds_read_b128 a[24:27], v133 offset:0
    v_mfma_f32_16x16x32_bf16 v[108:111], a[68:71], a[20:23], v[108:111]
    ds_read_b128 a[28:31], v135 offset:0
    s_waitcnt lgkmcnt(13)
    v_mfma_f32_16x16x32_bf16 v[64:67], a[16:19], a[48:51], v[64:67]
    v_mfma_f32_16x16x32_bf16 v[88:91], a[48:51], a[20:23], v[88:91]
    s_waitcnt lgkmcnt(12)
    v_mfma_f32_16x16x32_bf16 v[68:71], a[16:19], a[52:55], v[68:71]
    v_mfma_f32_16x16x32_bf16 v[92:95], a[52:55], a[20:23], v[92:95]
    v_mov_b32 v12, 2
    s_mov_b64 exec, 1
    ds_max_u32 v5, v12 offset:16
    s_mov_b64 exec, -1
    s_waitcnt lgkmcnt(6)
    v_mfma_f32_16x16x32_bf16 v[48:51], a[0:3], a[32:35], v[48:51]
    ds_read_b64_tr_b16 a[12:13], v137 offset:24576
    v_mfma_f32_16x16x32_bf16 v[72:75], a[4:7], a[32:35], v[72:75]
    ds_read_b64_tr_b16 a[14:15], v137 offset:25344
    v_mfma_f32_16x16x32_bf16 v[96:99], a[32:35], a[8:11], v[96:99]
    ds_read_b64_tr_b16 a[16:17], v137 offset:24640
    s_waitcnt lgkmcnt(8)
    v_mfma_f32_16x16x32_bf16 v[52:55], a[0:3], a[36:39], v[52:55]
    ds_read_b64_tr_b16 a[18:19], v137 offset:25408
    v_mfma_f32_16x16x32_bf16 v[76:79], a[4:7], a[36:39], v[76:79]
    ds_read_b64_tr_b16 a[20:21], v137 offset:24704
    v_mfma_f32_16x16x32_bf16 v[100:103], a[36:39], a[8:11], v[100:103]
    ds_read_b64_tr_b16 a[22:23], v137 offset:25472
    s_waitcnt lgkmcnt(10)
    v_mfma_f32_16x16x32_bf16 v[56:59], a[0:3], a[40:43], v[56:59]
    ds_read_b128 a[56:59], v132 offset:0
    s_mov_b64 exec, 1
    ds_read_b128 v[20:23], v4 offset:0
    s_mov_b64 exec, -1
    v_mfma_f32_16x16x32_bf16 v[80:83], a[4:7], a[40:43], v[80:83]
    ds_read_b128 a[60:63], v132 offset:2048
    v_mfma_f32_16x16x32_bf16 v[104:107], a[40:43], a[8:11], v[104:107]
    ds_read_b128 a[64:67], v132 offset:4096
    s_waitcnt lgkmcnt(13)
    v_mfma_f32_16x16x32_bf16 v[60:63], a[0:3], a[44:47], v[60:63]
    ds_read_b128 a[68:71], v132 offset:6144
    v_mfma_f32_16x16x32_bf16 v[84:87], a[4:7], a[44:47], v[84:87]
    ds_read_b128 a[48:51], v134 offset:0
    v_mfma_f32_16x16x32_bf16 v[108:111], a[44:47], a[8:11], v[108:111]
    ds_read_b128 a[52:55], v136 offset:0
    s_waitcnt lgkmcnt(15)
    v_mfma_f32_16x16x32_bf16 v[64:67], a[4:7], a[24:27], v[64:67]
    v_mfma_f32_16x16x32_bf16 v[88:91], a[24:27], a[8:11], v[88:91]
    s_waitcnt lgkmcnt(14)
    v_mfma_f32_16x16x32_bf16 v[68:71], a[4:7], a[28:31], v[68:71]
    v_mfma_f32_16x16x32_bf16 v[92:95], a[28:31], a[8:11], v[92:95]
    s_waitcnt lgkmcnt(5)
    v_min3_u32 v20, v20, v21, v22
    v_min_u32 v20, v20, v23
    s_nop 0
    v_readfirstlane_b32 s52, v20
    s_cmp_lt_u32 s52, 4
    s_cbranch_scc1 L_sequential_preLN__sliding_local_dilated__mixer_s_mlp__prompt_kernel_lws_157
L_sequential_preLN__sliding_local_dilated__mixer_s_mlp__prompt_kernel_lwb_156:
    s_waitcnt lgkmcnt(6)
    v_mfma_f32_16x16x32_bf16 v[48:51], a[12:15], a[56:59], v[48:51]
    ds_read_b64_tr_b16 a[0:1], v137 offset:49152
    v_mfma_f32_16x16x32_bf16 v[72:75], a[16:19], a[56:59], v[72:75]
    ds_read_b64_tr_b16 a[2:3], v137 offset:49920
    v_mfma_f32_16x16x32_bf16 v[96:99], a[56:59], a[20:23], v[96:99]
    ds_read_b64_tr_b16 a[4:5], v137 offset:49216
    s_waitcnt lgkmcnt(7)
    v_mfma_f32_16x16x32_bf16 v[52:55], a[12:15], a[60:63], v[52:55]
    ds_read_b64_tr_b16 a[6:7], v137 offset:49984
    v_mfma_f32_16x16x32_bf16 v[76:79], a[16:19], a[60:63], v[76:79]
    ds_read_b64_tr_b16 a[8:9], v137 offset:49280
    v_mfma_f32_16x16x32_bf16 v[100:103], a[60:63], a[20:23], v[100:103]
    ds_read_b64_tr_b16 a[10:11], v137 offset:50048
    s_waitcnt lgkmcnt(9)
    v_mfma_f32_16x16x32_bf16 v[56:59], a[12:15], a[64:67], v[56:59]
    ds_read_b128 a[32:35], v131 offset:30720
    v_mfma_f32_16x16x32_bf16 v[80:83], a[16:19], a[64:67], v[80:83]
    ds_read_b128 a[36:39], v131 offset:32768
    v_mfma_f32_16x16x32_bf16 v[104:107], a[64:67], a[20:23], v[104:107]
    ds_read_b128 a[40:43], v131 offset:34816
    s_waitcnt lgkmcnt(11)
    v_mfma_f32_16x16x32_bf16 v[60:63], a[12:15], a[68:71], v[60:63]
    ds_read_b128 a[44:47], v131 offset:36864
    v_mfma_f32_16x16x32_bf16 v[84:87], a[16:19], a[68:71], v[84:87]
    ds_read_b128 a[24:27], v133 offset:30720
    v_mfma_f32_16x16x32_bf16 v[108:111], a[68:71], a[20:23], v[108:111]
    ds_read_b128 a[28:31], v135 offset:30720
    s_waitcnt lgkmcnt(13)
    v_mfma_f32_16x16x32_bf16 v[64:67], a[16:19], a[48:51], v[64:67]
    v_mfma_f32_16x16x32_bf16 v[88:91], a[48:51], a[20:23], v[88:91]
    s_waitcnt lgkmcnt(12)
    v_mfma_f32_16x16x32_bf16 v[68:71], a[16:19], a[52:55], v[68:71]
    v_mfma_f32_16x16x32_bf16 v[92:95], a[52:55], a[20:23], v[92:95]
    v_mov_b32 v12, 3
    s_mov_b64 exec, 1
    ds_max_u32 v5, v12 offset:16
    s_mov_b64 exec, -1
    s_waitcnt lgkmcnt(6)
    v_mfma_f32_16x16x32_bf16 v[48:51], a[0:3], a[32:35], v[48:51]
    ds_read_b64_tr_b16 a[12:13], v137 offset:55296
    v_mfma_f32_16x16x32_bf16 v[72:75], a[4:7], a[32:35], v[72:75]
    ds_read_b64_tr_b16 a[14:15], v137 offset:56064
    v_mfma_f32_16x16x32_bf16 v[96:99], a[32:35], a[8:11], v[96:99]
    ds_read_b64_tr_b16 a[16:17], v137 offset:55360
    s_waitcnt lgkmcnt(8)
    v_mfma_f32_16x16x32_bf16 v[52:55], a[0:3], a[36:39], v[52:55]
    ds_read_b64_tr_b16 a[18:19], v137 offset:56128
    v_mfma_f32_16x16x32_bf16 v[76:79], a[4:7], a[36:39], v[76:79]
    ds_read_b64_tr_b16 a[20:21], v137 offset:55424
    v_mfma_f32_16x16x32_bf16 v[100:103], a[36:39], a[8:11], v[100:103]
    ds_read_b64_tr_b16 a[22:23], v137 offset:56192
    s_waitcnt lgkmcnt(10)
    v_mfma_f32_16x16x32_bf16 v[56:59], a[0:3], a[40:43], v[56:59]
    ds_read_b128 a[56:59], v132 offset:30720
    s_mov_b64 exec, 1
    ds_read_b128 v[20:23], v4 offset:0
    s_mov_b64 exec, -1
    v_mfma_f32_16x16x32_bf16 v[80:83], a[4:7], a[40:43], v[80:83]
    ds_read_b128 a[60:63], v132 offset:32768
    v_mfma_f32_16x16x32_bf16 v[104:107], a[40:43], a[8:11], v[104:107]
    ds_read_b128 a[64:67], v132 offset:34816
    s_waitcnt lgkmcnt(13)
    v_mfma_f32_16x16x32_bf16 v[60:63], a[0:3], a[44:47], v[60:63]
    ds_read_b128 a[68:71], v132 offset:36864
    v_mfma_f32_16x16x32_bf16 v[84:87], a[4:7], a[44:47], v[84:87]
    ds_read_b128 a[48:51], v134 offset:30720
    v_mfma_f32_16x16x32_bf16 v[108:111], a[44:47], a[8:11], v[108:111]
    ds_read_b128 a[52:55], v136 offset:30720
    s_waitcnt lgkmcnt(15)
    v_mfma_f32_16x16x32_bf16 v[64:67], a[4:7], a[24:27], v[64:67]
    v_mfma_f32_16x16x32_bf16 v[88:91], a[24:27], a[8:11], v[88:91]
    s_waitcnt lgkmcnt(14)
    v_mfma_f32_16x16x32_bf16 v[68:71], a[4:7], a[28:31], v[68:71]
    v_mfma_f32_16x16x32_bf16 v[92:95], a[28:31], a[8:11], v[92:95]
    s_waitcnt lgkmcnt(5)
    v_min3_u32 v20, v20, v21, v22
    v_min_u32 v20, v20, v23
    s_nop 0
    v_readfirstlane_b32 s52, v20
    s_cmp_lt_u32 s52, 5
    s_cbranch_scc1 L_sequential_preLN__sliding_local_dilated__mixer_s_mlp__prompt_kernel_lws_159
L_sequential_preLN__sliding_local_dilated__mixer_s_mlp__prompt_kernel_lwb_158:
    s_waitcnt lgkmcnt(6)
    v_mfma_f32_16x16x32_bf16 v[48:51], a[12:15], a[56:59], v[48:51]
    ds_read_b64_tr_b16 a[0:1], v144 offset:18432
    v_mfma_f32_16x16x32_bf16 v[72:75], a[16:19], a[56:59], v[72:75]
    ds_read_b64_tr_b16 a[2:3], v144 offset:19200
    v_mfma_f32_16x16x32_bf16 v[96:99], a[56:59], a[20:23], v[96:99]
    ds_read_b64_tr_b16 a[4:5], v144 offset:18496
    s_waitcnt lgkmcnt(7)
    v_mfma_f32_16x16x32_bf16 v[52:55], a[12:15], a[60:63], v[52:55]
    ds_read_b64_tr_b16 a[6:7], v144 offset:19264
    v_mfma_f32_16x16x32_bf16 v[76:79], a[16:19], a[60:63], v[76:79]
    ds_read_b64_tr_b16 a[8:9], v144 offset:18560
    v_mfma_f32_16x16x32_bf16 v[100:103], a[60:63], a[20:23], v[100:103]
    ds_read_b64_tr_b16 a[10:11], v144 offset:19328
    s_waitcnt lgkmcnt(9)
    v_mfma_f32_16x16x32_bf16 v[56:59], a[12:15], a[64:67], v[56:59]
    ds_read_b128 a[32:35], v138 offset:0
    v_mfma_f32_16x16x32_bf16 v[80:83], a[16:19], a[64:67], v[80:83]
    ds_read_b128 a[36:39], v138 offset:2048
    v_mfma_f32_16x16x32_bf16 v[104:107], a[64:67], a[20:23], v[104:107]
    ds_read_b128 a[40:43], v138 offset:4096
    s_waitcnt lgkmcnt(11)
    v_mfma_f32_16x16x32_bf16 v[60:63], a[12:15], a[68:71], v[60:63]
    ds_read_b128 a[44:47], v138 offset:6144
    v_mfma_f32_16x16x32_bf16 v[84:87], a[16:19], a[68:71], v[84:87]
    ds_read_b128 a[24:27], v140 offset:0
    v_mfma_f32_16x16x32_bf16 v[108:111], a[68:71], a[20:23], v[108:111]
    ds_read_b128 a[28:31], v142 offset:0
    s_waitcnt lgkmcnt(13)
    v_mfma_f32_16x16x32_bf16 v[64:67], a[16:19], a[48:51], v[64:67]
    v_mfma_f32_16x16x32_bf16 v[88:91], a[48:51], a[20:23], v[88:91]
    s_waitcnt lgkmcnt(12)
    v_mfma_f32_16x16x32_bf16 v[68:71], a[16:19], a[52:55], v[68:71]
    v_mfma_f32_16x16x32_bf16 v[92:95], a[52:55], a[20:23], v[92:95]
    v_mov_b32 v12, 4
    s_mov_b64 exec, 1
    ds_max_u32 v5, v12 offset:16
    s_mov_b64 exec, -1
    s_waitcnt lgkmcnt(6)
    v_mfma_f32_16x16x32_bf16 v[48:51], a[0:3], a[32:35], v[48:51]
    ds_read_b64_tr_b16 a[12:13], v144 offset:24576
    v_mfma_f32_16x16x32_bf16 v[72:75], a[4:7], a[32:35], v[72:75]
    ds_read_b64_tr_b16 a[14:15], v144 offset:25344
    v_mfma_f32_16x16x32_bf16 v[96:99], a[32:35], a[8:11], v[96:99]
    ds_read_b64_tr_b16 a[16:17], v144 offset:24640
    s_waitcnt lgkmcnt(8)
    v_mfma_f32_16x16x32_bf16 v[52:55], a[0:3], a[36:39], v[52:55]
    ds_read_b64_tr_b16 a[18:19], v144 offset:25408
    v_mfma_f32_16x16x32_bf16 v[76:79], a[4:7], a[36:39], v[76:79]
    ds_read_b64_tr_b16 a[20:21], v144 offset:24704
    v_mfma_f32_16x16x32_bf16 v[100:103], a[36:39], a[8:11], v[100:103]
    ds_read_b64_tr_b16 a[22:23], v144 offset:25472
    s_waitcnt lgkmcnt(10)
    v_mfma_f32_16x16x32_bf16 v[56:59], a[0:3], a[40:43], v[56:59]
    ds_read_b128 a[56:59], v139 offset:0
    s_mov_b64 exec, 1
    ds_read_b128 v[20:23], v4 offset:0
    s_mov_b64 exec, -1
    v_mfma_f32_16x16x32_bf16 v[80:83], a[4:7], a[40:43], v[80:83]
    ds_read_b128 a[60:63], v139 offset:2048
    v_mfma_f32_16x16x32_bf16 v[104:107], a[40:43], a[8:11], v[104:107]
    ds_read_b128 a[64:67], v139 offset:4096
    s_waitcnt lgkmcnt(13)
    v_mfma_f32_16x16x32_bf16 v[60:63], a[0:3], a[44:47], v[60:63]
    ds_read_b128 a[68:71], v139 offset:6144
    v_mfma_f32_16x16x32_bf16 v[84:87], a[4:7], a[44:47], v[84:87]
    ds_read_b128 a[48:51], v141 offset:0
    v_mfma_f32_16x16x32_bf16 v[108:111], a[44:47], a[8:11], v[108:111]
    ds_read_b128 a[52:55], v143 offset:0
    s_waitcnt lgkmcnt(15)
    v_mfma_f32_16x16x32_bf16 v[64:67], a[4:7], a[24:27], v[64:67]
    v_mfma_f32_16x16x32_bf16 v[88:91], a[24:27], a[8:11], v[88:91]
    s_waitcnt lgkmcnt(14)
    v_mfma_f32_16x16x32_bf16 v[68:71], a[4:7], a[28:31], v[68:71]
    v_mfma_f32_16x16x32_bf16 v[92:95], a[28:31], a[8:11], v[92:95]
    s_waitcnt lgkmcnt(5)
    v_min3_u32 v20, v20, v21, v22
    v_min_u32 v20, v20, v23
    s_nop 0
    v_readfirstlane_b32 s52, v20
    s_cmp_lt_u32 s52, 6
    s_cbranch_scc1 L_sequential_preLN__sliding_local_dilated__mixer_s_mlp__prompt_kernel_lws_161
L_sequential_preLN__sliding_local_dilated__mixer_s_mlp__prompt_kernel_lwb_160:
    s_waitcnt lgkmcnt(6)
    v_mfma_f32_16x16x32_bf16 v[48:51], a[12:15], a[56:59], v[48:51]
    ds_read_b64_tr_b16 a[0:1], v130 offset:18432
    v_mfma_f32_16x16x32_bf16 v[72:75], a[16:19], a[56:59], v[72:75]
    ds_read_b64_tr_b16 a[2:3], v130 offset:19200
    v_mfma_f32_16x16x32_bf16 v[96:99], a[56:59], a[20:23], v[96:99]
    ds_read_b64_tr_b16 a[4:5], v130 offset:18496
    s_waitcnt lgkmcnt(7)
    v_mfma_f32_16x16x32_bf16 v[52:55], a[12:15], a[60:63], v[52:55]
    ds_read_b64_tr_b16 a[6:7], v130 offset:19264
    v_mfma_f32_16x16x32_bf16 v[76:79], a[16:19], a[60:63], v[76:79]
    ds_read_b64_tr_b16 a[8:9], v130 offset:18560
    v_mfma_f32_16x16x32_bf16 v[100:103], a[60:63], a[20:23], v[100:103]
    ds_read_b64_tr_b16 a[10:11], v130 offset:19328
    s_waitcnt lgkmcnt(9)
    v_mfma_f32_16x16x32_bf16 v[56:59], a[12:15], a[64:67], v[56:59]
    ds_read_b128 a[32:35], v124 offset:0
    v_mfma_f32_16x16x32_bf16 v[80:83], a[16:19], a[64:67], v[80:83]
    ds_read_b128 a[36:39], v124 offset:2048
    v_mfma_f32_16x16x32_bf16 v[104:107], a[64:67], a[20:23], v[104:107]
    ds_read_b128 a[40:43], v124 offset:4096
    s_waitcnt lgkmcnt(11)
    v_mfma_f32_16x16x32_bf16 v[60:63], a[12:15], a[68:71], v[60:63]
    ds_read_b128 a[44:47], v124 offset:6144
    v_mfma_f32_16x16x32_bf16 v[84:87], a[16:19], a[68:71], v[84:87]
    ds_read_b128 a[24:27], v126 offset:0
    v_mfma_f32_16x16x32_bf16 v[108:111], a[68:71], a[20:23], v[108:111]
    ds_read_b128 a[28:31], v128 offset:0
    s_waitcnt lgkmcnt(13)
    v_mfma_f32_16x16x32_bf16 v[64:67], a[16:19], a[48:51], v[64:67]
    v_mfma_f32_16x16x32_bf16 v[88:91], a[48:51], a[20:23], v[88:91]
    s_waitcnt lgkmcnt(12)
    v_mfma_f32_16x16x32_bf16 v[68:71], a[16:19], a[52:55], v[68:71]
    v_mfma_f32_16x16x32_bf16 v[92:95], a[52:55], a[20:23], v[92:95]
    v_mov_b32 v12, 5
    s_mov_b64 exec, 1
    ds_max_u32 v5, v12 offset:16
    s_mov_b64 exec, -1
    s_waitcnt lgkmcnt(6)
    v_mfma_f32_16x16x32_bf16 v[48:51], a[0:3], a[32:35], v[48:51]
    ds_read_b64_tr_b16 a[12:13], v130 offset:24576
    v_mfma_f32_16x16x32_bf16 v[72:75], a[4:7], a[32:35], v[72:75]
    ds_read_b64_tr_b16 a[14:15], v130 offset:25344
    v_mfma_f32_16x16x32_bf16 v[96:99], a[32:35], a[8:11], v[96:99]
    ds_read_b64_tr_b16 a[16:17], v130 offset:24640
    s_waitcnt lgkmcnt(8)
    v_mfma_f32_16x16x32_bf16 v[52:55], a[0:3], a[36:39], v[52:55]
    ds_read_b64_tr_b16 a[18:19], v130 offset:25408
    v_mfma_f32_16x16x32_bf16 v[76:79], a[4:7], a[36:39], v[76:79]
    ds_read_b64_tr_b16 a[20:21], v130 offset:24704
    v_mfma_f32_16x16x32_bf16 v[100:103], a[36:39], a[8:11], v[100:103]
    ds_read_b64_tr_b16 a[22:23], v130 offset:25472
    s_waitcnt lgkmcnt(10)
    v_mfma_f32_16x16x32_bf16 v[56:59], a[0:3], a[40:43], v[56:59]
    ds_read_b128 a[56:59], v125 offset:0
    s_mov_b64 exec, 1
    ds_read_b128 v[20:23], v4 offset:0
    s_mov_b64 exec, -1
    v_mfma_f32_16x16x32_bf16 v[80:83], a[4:7], a[40:43], v[80:83]
    ds_read_b128 a[60:63], v125 offset:2048
    v_mfma_f32_16x16x32_bf16 v[104:107], a[40:43], a[8:11], v[104:107]
    ds_read_b128 a[64:67], v125 offset:4096
    s_waitcnt lgkmcnt(13)
    v_mfma_f32_16x16x32_bf16 v[60:63], a[0:3], a[44:47], v[60:63]
    ds_read_b128 a[68:71], v125 offset:6144
    v_mfma_f32_16x16x32_bf16 v[84:87], a[4:7], a[44:47], v[84:87]
    ds_read_b128 a[48:51], v127 offset:0
    v_mfma_f32_16x16x32_bf16 v[108:111], a[44:47], a[8:11], v[108:111]
    ds_read_b128 a[52:55], v129 offset:0
    s_waitcnt lgkmcnt(15)
    v_mfma_f32_16x16x32_bf16 v[64:67], a[4:7], a[24:27], v[64:67]
    v_mfma_f32_16x16x32_bf16 v[88:91], a[24:27], a[8:11], v[88:91]
    s_waitcnt lgkmcnt(14)
    v_mfma_f32_16x16x32_bf16 v[68:71], a[4:7], a[28:31], v[68:71]
    v_mfma_f32_16x16x32_bf16 v[92:95], a[28:31], a[8:11], v[92:95]
    s_waitcnt lgkmcnt(5)
    v_min3_u32 v20, v20, v21, v22
    v_min_u32 v20, v20, v23
    s_nop 0
    v_readfirstlane_b32 s52, v20
    s_cmp_lt_u32 s52, 7
    s_cbranch_scc1 L_sequential_preLN__sliding_local_dilated__mixer_s_mlp__prompt_kernel_lws_163
L_sequential_preLN__sliding_local_dilated__mixer_s_mlp__prompt_kernel_lwb_162:
    s_waitcnt lgkmcnt(6)
    v_mfma_f32_16x16x32_bf16 v[48:51], a[12:15], a[56:59], v[48:51]
    ds_read_b64_tr_b16 a[0:1], v130 offset:49152
    v_mfma_f32_16x16x32_bf16 v[72:75], a[16:19], a[56:59], v[72:75]
    ds_read_b64_tr_b16 a[2:3], v130 offset:49920
    v_mfma_f32_16x16x32_bf16 v[96:99], a[56:59], a[20:23], v[96:99]
    ds_read_b64_tr_b16 a[4:5], v130 offset:49216
    s_waitcnt lgkmcnt(7)
    v_mfma_f32_16x16x32_bf16 v[52:55], a[12:15], a[60:63], v[52:55]
    ds_read_b64_tr_b16 a[6:7], v130 offset:49984
    v_mfma_f32_16x16x32_bf16 v[76:79], a[16:19], a[60:63], v[76:79]
    ds_read_b64_tr_b16 a[8:9], v130 offset:49280
    v_mfma_f32_16x16x32_bf16 v[100:103], a[60:63], a[20:23], v[100:103]
    ds_read_b64_tr_b16 a[10:11], v130 offset:50048
    s_waitcnt lgkmcnt(9)
    v_mfma_f32_16x16x32_bf16 v[56:59], a[12:15], a[64:67], v[56:59]
    ds_read_b128 a[32:35], v124 offset:30720
    v_mfma_f32_16x16x32_bf16 v[80:83], a[16:19], a[64:67], v[80:83]
    ds_read_b128 a[36:39], v124 offset:32768
    v_mfma_f32_16x16x32_bf16 v[104:107], a[64:67], a[20:23], v[104:107]
    ds_read_b128 a[40:43], v124 offset:34816
    s_waitcnt lgkmcnt(11)
    v_mfma_f32_16x16x32_bf16 v[60:63], a[12:15], a[68:71], v[60:63]
    ds_read_b128 a[44:47], v124 offset:36864
    v_mfma_f32_16x16x32_bf16 v[84:87], a[16:19], a[68:71], v[84:87]
    ds_read_b128 a[24:27], v126 offset:30720
    v_mfma_f32_16x16x32_bf16 v[108:111], a[68:71], a[20:23], v[108:111]
    ds_read_b128 a[28:31], v128 offset:30720
    s_waitcnt lgkmcnt(13)
    v_mfma_f32_16x16x32_bf16 v[64:67], a[16:19], a[48:51], v[64:67]
    v_mfma_f32_16x16x32_bf16 v[88:91], a[48:51], a[20:23], v[88:91]
    s_waitcnt lgkmcnt(12)
    v_mfma_f32_16x16x32_bf16 v[68:71], a[16:19], a[52:55], v[68:71]
    v_mfma_f32_16x16x32_bf16 v[92:95], a[52:55], a[20:23], v[92:95]
    v_mov_b32 v12, 6
    s_mov_b64 exec, 1
    ds_max_u32 v5, v12 offset:16
    s_mov_b64 exec, -1
    s_waitcnt lgkmcnt(6)
    v_mfma_f32_16x16x32_bf16 v[48:51], a[0:3], a[32:35], v[48:51]
    ds_read_b64_tr_b16 a[12:13], v130 offset:55296
    v_mfma_f32_16x16x32_bf16 v[72:75], a[4:7], a[32:35], v[72:75]
    ds_read_b64_tr_b16 a[14:15], v130 offset:56064
    v_mfma_f32_16x16x32_bf16 v[96:99], a[32:35], a[8:11], v[96:99]
    ds_read_b64_tr_b16 a[16:17], v130 offset:55360
    s_waitcnt lgkmcnt(8)
    v_mfma_f32_16x16x32_bf16 v[52:55], a[0:3], a[36:39], v[52:55]
    ds_read_b64_tr_b16 a[18:19], v130 offset:56128
    v_mfma_f32_16x16x32_bf16 v[76:79], a[4:7], a[36:39], v[76:79]
    ds_read_b64_tr_b16 a[20:21], v130 offset:55424
    v_mfma_f32_16x16x32_bf16 v[100:103], a[36:39], a[8:11], v[100:103]
    ds_read_b64_tr_b16 a[22:23], v130 offset:56192
    s_waitcnt lgkmcnt(10)
    v_mfma_f32_16x16x32_bf16 v[56:59], a[0:3], a[40:43], v[56:59]
    ds_read_b128 a[56:59], v125 offset:30720
    s_mov_b64 exec, 1
    ds_read_b128 v[20:23], v4 offset:0
    s_mov_b64 exec, -1
    v_mfma_f32_16x16x32_bf16 v[80:83], a[4:7], a[40:43], v[80:83]
    ds_read_b128 a[60:63], v125 offset:32768
    v_mfma_f32_16x16x32_bf16 v[104:107], a[40:43], a[8:11], v[104:107]
    ds_read_b128 a[64:67], v125 offset:34816
    s_waitcnt lgkmcnt(13)
    v_mfma_f32_16x16x32_bf16 v[60:63], a[0:3], a[44:47], v[60:63]
    ds_read_b128 a[68:71], v125 offset:36864
    v_mfma_f32_16x16x32_bf16 v[84:87], a[4:7], a[44:47], v[84:87]
    ds_read_b128 a[48:51], v127 offset:30720
    v_mfma_f32_16x16x32_bf16 v[108:111], a[44:47], a[8:11], v[108:111]
    ds_read_b128 a[52:55], v129 offset:30720
    s_waitcnt lgkmcnt(15)
    v_mfma_f32_16x16x32_bf16 v[64:67], a[4:7], a[24:27], v[64:67]
    v_mfma_f32_16x16x32_bf16 v[88:91], a[24:27], a[8:11], v[88:91]
    s_waitcnt lgkmcnt(14)
    v_mfma_f32_16x16x32_bf16 v[68:71], a[4:7], a[28:31], v[68:71]
    v_mfma_f32_16x16x32_bf16 v[92:95], a[28:31], a[8:11], v[92:95]
    v_mfma_f32_16x16x32_bf16 v[112:115], a[0:3], v[16:19], 0
    v_mfma_f32_16x16x32_bf16 v[116:119], a[4:7], v[16:19], 0
    v_mfma_f32_16x16x32_bf16 v[120:123], v[16:19], a[8:11], 0
    s_waitcnt lgkmcnt(5)
    v_min3_u32 v20, v20, v21, v22
    v_min_u32 v20, v20, v23
    s_nop 0
    v_readfirstlane_b32 s52, v20
    s_cmp_lt_u32 s52, 8
    s_cbranch_scc1 L_sequential_preLN__sliding_local_dilated__mixer_s_mlp__prompt_kernel_lws_165
L_sequential_preLN__sliding_local_dilated__mixer_s_mlp__prompt_kernel_lwb_164:
    s_waitcnt lgkmcnt(6)
    v_mfma_f32_16x16x32_bf16 v[48:51], a[12:15], a[56:59], v[48:51]
    ds_read_b64_tr_b16 a[0:1], v137 offset:18432
    v_mfma_f32_16x16x32_bf16 v[72:75], a[16:19], a[56:59], v[72:75]
    ds_read_b64_tr_b16 a[2:3], v137 offset:19200
    v_mfma_f32_16x16x32_bf16 v[96:99], a[56:59], a[20:23], v[96:99]
    ds_read_b64_tr_b16 a[4:5], v137 offset:18496
    s_waitcnt lgkmcnt(7)
    v_mfma_f32_16x16x32_bf16 v[52:55], a[12:15], a[60:63], v[52:55]
    ds_read_b64_tr_b16 a[6:7], v137 offset:19264
    v_mfma_f32_16x16x32_bf16 v[76:79], a[16:19], a[60:63], v[76:79]
    ds_read_b64_tr_b16 a[8:9], v137 offset:18560
    v_mfma_f32_16x16x32_bf16 v[100:103], a[60:63], a[20:23], v[100:103]
    ds_read_b64_tr_b16 a[10:11], v137 offset:19328
    s_waitcnt lgkmcnt(9)
    v_mfma_f32_16x16x32_bf16 v[56:59], a[12:15], a[64:67], v[56:59]
    ds_read_b128 a[32:35], v131 offset:0
    v_mfma_f32_16x16x32_bf16 v[80:83], a[16:19], a[64:67], v[80:83]
    ds_read_b128 a[36:39], v131 offset:2048
    v_mfma_f32_16x16x32_bf16 v[104:107], a[64:67], a[20:23], v[104:107]
    ds_read_b128 a[40:43], v131 offset:4096
    s_waitcnt lgkmcnt(11)
    v_mfma_f32_16x16x32_bf16 v[60:63], a[12:15], a[68:71], v[60:63]
    ds_read_b128 a[44:47], v131 offset:6144
    v_mfma_f32_16x16x32_bf16 v[84:87], a[16:19], a[68:71], v[84:87]
    ds_read_b128 a[24:27], v133 offset:0
    v_mfma_f32_16x16x32_bf16 v[108:111], a[68:71], a[20:23], v[108:111]
    ds_read_b128 a[28:31], v135 offset:0
    s_waitcnt lgkmcnt(13)
    v_mfma_f32_16x16x32_bf16 v[64:67], a[16:19], a[48:51], v[64:67]
    v_mfma_f32_16x16x32_bf16 v[88:91], a[48:51], a[20:23], v[88:91]
    s_waitcnt lgkmcnt(12)
    v_mfma_f32_16x16x32_bf16 v[68:71], a[16:19], a[52:55], v[68:71]
    v_mfma_f32_16x16x32_bf16 v[92:95], a[52:55], a[20:23], v[92:95]
    v_mfma_f32_16x16x32_bf16 v[112:115], a[12:15], v[16:19], v[112:115]
    v_mfma_f32_16x16x32_bf16 v[116:119], a[16:19], v[16:19], v[116:119]
    v_mfma_f32_16x16x32_bf16 v[120:123], v[16:19], a[20:23], v[120:123]
    v_mov_b32 v12, 7
    s_mov_b64 exec, 1
    ds_max_u32 v5, v12 offset:16
    s_mov_b64 exec, -1
    s_waitcnt lgkmcnt(6)
    v_mfma_f32_16x16x32_bf16 v[48:51], a[0:3], a[32:35], v[48:51]
    ds_read_b64_tr_b16 a[12:13], v137 offset:24576
    v_mfma_f32_16x16x32_bf16 v[72:75], a[4:7], a[32:35], v[72:75]
    ds_read_b64_tr_b16 a[14:15], v137 offset:25344
    v_mfma_f32_16x16x32_bf16 v[96:99], a[32:35], a[8:11], v[96:99]
    ds_read_b64_tr_b16 a[16:17], v137 offset:24640
    s_waitcnt lgkmcnt(8)
    v_mfma_f32_16x16x32_bf16 v[52:55], a[0:3], a[36:39], v[52:55]
    ds_read_b64_tr_b16 a[18:19], v137 offset:25408
    v_mfma_f32_16x16x32_bf16 v[76:79], a[4:7], a[36:39], v[76:79]
    ds_read_b64_tr_b16 a[20:21], v137 offset:24704
    v_mfma_f32_16x16x32_bf16 v[100:103], a[36:39], a[8:11], v[100:103]
    ds_read_b64_tr_b16 a[22:23], v137 offset:25472
    s_waitcnt lgkmcnt(10)
    v_mfma_f32_16x16x32_bf16 v[56:59], a[0:3], a[40:43], v[56:59]
    ds_read_b128 a[56:59], v132 offset:0
    s_mov_b64 exec, 1
    ds_read_b128 v[8:11], v4 offset:64
    s_mov_b64 exec, -1
    v_mfma_f32_16x16x32_bf16 v[80:83], a[4:7], a[40:43], v[80:83]
    ds_read_b128 a[60:63], v132 offset:2048
    v_mfma_f32_16x16x32_bf16 v[104:107], a[40:43], a[8:11], v[104:107]
    ds_read_b128 a[64:67], v132 offset:4096
    s_waitcnt lgkmcnt(13)
    v_mfma_f32_16x16x32_bf16 v[60:63], a[0:3], a[44:47], v[60:63]
    ds_read_b128 a[68:71], v132 offset:6144
    v_mfma_f32_16x16x32_bf16 v[84:87], a[4:7], a[44:47], v[84:87]
    ds_read_b128 a[48:51], v134 offset:0
    v_mfma_f32_16x16x32_bf16 v[108:111], a[44:47], a[8:11], v[108:111]
    ds_read_b128 a[52:55], v136 offset:0
    s_waitcnt lgkmcnt(15)
    v_mfma_f32_16x16x32_bf16 v[64:67], a[4:7], a[24:27], v[64:67]
    v_mfma_f32_16x16x32_bf16 v[88:91], a[24:27], a[8:11], v[88:91]
    s_waitcnt lgkmcnt(14)
    v_mfma_f32_16x16x32_bf16 v[68:71], a[4:7], a[28:31], v[68:71]
    v_mfma_f32_16x16x32_bf16 v[92:95], a[28:31], a[8:11], v[92:95]
    v_mfma_f32_16x16x32_bf16 v[112:115], a[0:3], v[16:19], v[112:115]
    v_mfma_f32_16x16x32_bf16 v[116:119], a[4:7], v[16:19], v[116:119]
    v_mfma_f32_16x16x32_bf16 v[120:123], v[16:19], a[8:11], v[120:123]
    s_waitcnt lgkmcnt(5)
    v_min3_u32 v8, v8, v9, v10
    v_min_u32 v8, v8, v11
    s_nop 0
    v_readfirstlane_b32 s53, v8
    s_cmp_lt_u32 s53, 1
    s_cbranch_scc1 L_sequential_preLN__sliding_local_dilated__mixer_s_mlp__prompt_kernel_lws_167
L_sequential_preLN__sliding_local_dilated__mixer_s_mlp__prompt_kernel_lwb_166:
    s_waitcnt lgkmcnt(6)
    v_mfma_f32_16x16x32_bf16 v[48:51], a[12:15], a[56:59], v[48:51]
    ds_read_b128 v[124:127], v149 offset:2560
    v_mfma_f32_16x16x32_bf16 v[72:75], a[16:19], a[56:59], v[72:75]
    ds_read_b128 v[128:131], v149 offset:3200
    v_mfma_f32_16x16x32_bf16 v[96:99], a[56:59], a[20:23], v[96:99]
    ds_read_b128 v[132:135], v149 offset:2624
    s_waitcnt lgkmcnt(7)
    v_mfma_f32_16x16x32_bf16 v[52:55], a[12:15], a[60:63], v[52:55]
    ds_read_b128 v[136:139], v149 offset:3264
    v_mfma_f32_16x16x32_bf16 v[76:79], a[16:19], a[60:63], v[76:79]
    ds_read_b128 v[140:143], v149 offset:2688
    v_mfma_f32_16x16x32_bf16 v[100:103], a[60:63], a[20:23], v[100:103]
    ds_read_b128 v[144:147], v149 offset:3328
    s_waitcnt lgkmcnt(9)
    v_mfma_f32_16x16x32_bf16 v[56:59], a[12:15], a[64:67], v[56:59]
    ds_read_b32 v20, v151 offset:384
    v_mfma_f32_16x16x32_bf16 v[80:83], a[16:19], a[64:67], v[80:83]
    ds_read_b128 v[40:43], v150 offset:128
    v_mfma_f32_16x16x32_bf16 v[104:107], a[64:67], a[20:23], v[104:107]
    ds_read_b128 v[44:47], v150 offset:256
    s_waitcnt lgkmcnt(11)
    v_mfma_f32_16x16x32_bf16 v[60:63], a[12:15], a[68:71], v[60:63]
    ds_read_b64 v[22:23], v158 offset:80
    v_mfma_f32_16x16x32_bf16 v[84:87], a[16:19], a[68:71], v[84:87]
    ds_read_b64 v[28:29], v148 offset:1280
    v_mfma_f32_16x16x32_bf16 v[108:111], a[68:71], a[20:23], v[108:111]
    ds_read_b64 v[30:31], v148 offset:1408
    s_waitcnt lgkmcnt(13)
    v_mfma_f32_16x16x32_bf16 v[64:67], a[16:19], a[48:51], v[64:67]
    ds_read_b64 v[32:33], v148 offset:1536
    v_mfma_f32_16x16x32_bf16 v[88:91], a[48:51], a[20:23], v[88:91]
    ds_read_b64 v[34:35], v148 offset:1664
    s_waitcnt lgkmcnt(14)
    v_mfma_f32_16x16x32_bf16 v[68:71], a[16:19], a[52:55], v[68:71]
    ds_read_b64 v[36:37], v148 offset:1792
    v_mfma_f32_16x16x32_bf16 v[92:95], a[52:55], a[20:23], v[92:95]
    ds_read_b64 v[38:39], v148 offset:1920
    v_mfma_f32_16x16x32_bf16 v[112:115], a[12:15], v[16:19], v[112:115]
    v_mfma_f32_16x16x32_bf16 v[116:119], a[16:19], v[16:19], v[116:119]
    v_mfma_f32_16x16x32_bf16 v[120:123], v[16:19], a[20:23], v[120:123]
    v_mov_b32 v12, 8
    s_mov_b64 exec, 1
    ds_max_u32 v5, v12 offset:16
    s_mov_b64 exec, -1
    s_waitcnt lgkmcnt(0)
    v_readfirstlane_b32 s35, v22
    v_readfirstlane_b32 s36, v23
    s_nop 1
    v_pk_add_f32 v[40:41], v[40:41], v[112:113]
    v_pk_add_f32 v[42:43], v[42:43], v[114:115]
    v_pk_add_f32 v[44:45], v[44:45], v[116:117]
    v_pk_add_f32 v[46:47], v[46:47], v[118:119]
    v_add_f32 v20, v20, v120
    v_mov_b32 v6, s35
    v_pk_mul_f32 v[88:89], v[88:89], v[124:125]
    v_pk_mul_f32 v[90:91], v[90:91], v[126:127]
    v_pk_mul_f32 v[92:93], v[92:93], v[132:133]
    v_pk_mul_f32 v[94:95], v[94:95], v[134:135]
    v_pk_mul_f32 v[96:97], v[96:97], v[140:141]
    v_pk_mul_f32 v[98:99], v[98:99], v[142:143]
    v_pk_fma_f32 v[88:89], v[128:129], v[20:21], v[88:89] op_sel_hi:[1,0,1]
    v_pk_fma_f32 v[90:91], v[130:131], v[20:21], v[90:91] op_sel_hi:[1,0,1]
    v_pk_fma_f32 v[92:93], v[136:137], v[20:21], v[92:93] op_sel_hi:[1,0,1]
    v_pk_fma_f32 v[94:95], v[138:139], v[20:21], v[94:95] op_sel_hi:[1,0,1]
    v_pk_fma_f32 v[96:97], v[144:145], v[20:21], v[96:97] op_sel_hi:[1,0,1]
    v_pk_fma_f32 v[98:99], v[146:147], v[20:21], v[98:99] op_sel_hi:[1,0,1]
    v_cvt_pk_bf16_f32 v88, v88, v89
    v_cvt_pk_bf16_f32 v89, v90, v91
    v_cvt_pk_bf16_f32 v90, v92, v93
    v_cvt_pk_bf16_f32 v91, v94, v95
    v_cvt_pk_bf16_f32 v92, v96, v97
    v_cvt_pk_bf16_f32 v93, v98, v99
    ds_read_b128 v[124:127], v149 offset:2752
    ds_read_b128 v[128:131], v149 offset:3392
    ds_read_b128 v[132:135], v149 offset:2816
    ds_read_b128 v[136:139], v149 offset:3456
    ds_read_b128 v[140:143], v149 offset:2880
    ds_read_b128 v[144:147], v149 offset:3520
    v_pk_mul_f32 v[48:49], v[48:49], v[32:33] op_sel_hi:[1,0]
    v_pk_mul_f32 v[50:51], v[50:51], v[32:33] op_sel_hi:[1,0]
    v_pk_mul_f32 v[52:53], v[52:53], v[34:35] op_sel_hi:[1,0]
    v_pk_mul_f32 v[54:55], v[54:55], v[34:35] op_sel_hi:[1,0]
    v_pk_mul_f32 v[56:57], v[56:57], v[36:37] op_sel_hi:[1,0]
    v_pk_mul_f32 v[58:59], v[58:59], v[36:37] op_sel_hi:[1,0]
    v_pk_mul_f32 v[60:61], v[60:61], v[38:39] op_sel_hi:[1,0]
    v_pk_mul_f32 v[62:63], v[62:63], v[38:39] op_sel_hi:[1,0]
    v_pk_fma_f32 v[48:49], v[40:41], v[32:33], v[48:49] op_sel:[0,1,0] op_sel_hi:[1,1,1]
    v_pk_fma_f32 v[50:51], v[42:43], v[32:33], v[50:51] op_sel:[0,1,0] op_sel_hi:[1,1,1]
    v_pk_fma_f32 v[52:53], v[40:41], v[34:35], v[52:53] op_sel:[0,1,0] op_sel_hi:[1,1,1]
    v_pk_fma_f32 v[54:55], v[42:43], v[34:35], v[54:55] op_sel:[0,1,0] op_sel_hi:[1,1,1]
    v_pk_fma_f32 v[56:57], v[40:41], v[36:37], v[56:57] op_sel:[0,1,0] op_sel_hi:[1,1,1]
    v_pk_fma_f32 v[58:59], v[42:43], v[36:37], v[58:59] op_sel:[0,1,0] op_sel_hi:[1,1,1]
    v_pk_fma_f32 v[60:61], v[40:41], v[38:39], v[60:61] op_sel:[0,1,0] op_sel_hi:[1,1,1]
    v_pk_fma_f32 v[62:63], v[42:43], v[38:39], v[62:63] op_sel:[0,1,0] op_sel_hi:[1,1,1]
    v_cvt_pk_bf16_f32 v48, v48, v49
    v_cvt_pk_bf16_f32 v49, v50, v51
    v_cvt_pk_bf16_f32 v50, v52, v53
    v_cvt_pk_bf16_f32 v51, v54, v55
    v_cvt_pk_bf16_f32 v52, v56, v57
    v_cvt_pk_bf16_f32 v53, v58, v59
    v_cvt_pk_bf16_f32 v54, v60, v61
    v_cvt_pk_bf16_f32 v55, v62, v63
    v_pk_mul_f32 v[64:65], v[64:65], v[28:29] op_sel_hi:[1,0]
    v_pk_mul_f32 v[66:67], v[66:67], v[28:29] op_sel_hi:[1,0]
    v_pk_mul_f32 v[68:69], v[68:69], v[30:31] op_sel_hi:[1,0]
    v_pk_mul_f32 v[70:71], v[70:71], v[30:31] op_sel_hi:[1,0]
    v_pk_mul_f32 v[72:73], v[72:73], v[32:33] op_sel_hi:[1,0]
    v_pk_mul_f32 v[74:75], v[74:75], v[32:33] op_sel_hi:[1,0]
    v_pk_mul_f32 v[76:77], v[76:77], v[34:35] op_sel_hi:[1,0]
    v_pk_mul_f32 v[78:79], v[78:79], v[34:35] op_sel_hi:[1,0]
    v_pk_mul_f32 v[80:81], v[80:81], v[36:37] op_sel_hi:[1,0]
    v_pk_mul_f32 v[82:83], v[82:83], v[36:37] op_sel_hi:[1,0]
    v_pk_mul_f32 v[84:85], v[84:85], v[38:39] op_sel_hi:[1,0]
    v_pk_mul_f32 v[86:87], v[86:87], v[38:39] op_sel_hi:[1,0]
    v_pk_fma_f32 v[64:65], v[44:45], v[28:29], v[64:65] op_sel:[0,1,0] op_sel_hi:[1,1,1]
    v_pk_fma_f32 v[66:67], v[46:47], v[28:29], v[66:67] op_sel:[0,1,0] op_sel_hi:[1,1,1]
    v_pk_fma_f32 v[68:69], v[44:45], v[30:31], v[68:69] op_sel:[0,1,0] op_sel_hi:[1,1,1]
    v_pk_fma_f32 v[70:71], v[46:47], v[30:31], v[70:71] op_sel:[0,1,0] op_sel_hi:[1,1,1]
    v_pk_fma_f32 v[72:73], v[44:45], v[32:33], v[72:73] op_sel:[0,1,0] op_sel_hi:[1,1,1]
    v_pk_fma_f32 v[74:75], v[46:47], v[32:33], v[74:75] op_sel:[0,1,0] op_sel_hi:[1,1,1]
    v_pk_fma_f32 v[76:77], v[44:45], v[34:35], v[76:77] op_sel:[0,1,0] op_sel_hi:[1,1,1]
    v_pk_fma_f32 v[78:79], v[46:47], v[34:35], v[78:79] op_sel:[0,1,0] op_sel_hi:[1,1,1]
    v_pk_fma_f32 v[80:81], v[44:45], v[36:37], v[80:81] op_sel:[0,1,0] op_sel_hi:[1,1,1]
    v_pk_fma_f32 v[82:83], v[46:47], v[36:37], v[82:83] op_sel:[0,1,0] op_sel_hi:[1,1,1]
    v_pk_fma_f32 v[84:85], v[44:45], v[38:39], v[84:85] op_sel:[0,1,0] op_sel_hi:[1,1,1]
    v_pk_fma_f32 v[86:87], v[46:47], v[38:39], v[86:87] op_sel:[0,1,0] op_sel_hi:[1,1,1]
    v_cvt_pk_bf16_f32 v64, v64, v65
    v_cvt_pk_bf16_f32 v65, v66, v67
    v_cvt_pk_bf16_f32 v66, v68, v69
    v_cvt_pk_bf16_f32 v67, v70, v71
    v_cvt_pk_bf16_f32 v68, v72, v73
    v_cvt_pk_bf16_f32 v69, v74, v75
    v_cvt_pk_bf16_f32 v70, v76, v77
    v_cvt_pk_bf16_f32 v71, v78, v79
    v_cvt_pk_bf16_f32 v72, v80, v81
    v_cvt_pk_bf16_f32 v73, v82, v83
    v_cvt_pk_bf16_f32 v74, v84, v85
    v_cvt_pk_bf16_f32 v75, v86, v87
    s_nop 0
    v_mfma_f32_16x16x16_bf16 v[56:59], v[68:69], v[48:49], 0
    v_mfma_f32_16x16x16_bf16 v[84:87], v[64:65], v[48:49], 0
    v_mfma_f32_16x16x16_bf16 v[60:63], v[70:71], v[50:51], 0
    v_mfma_f32_16x16x16_bf16 v[112:115], v[66:67], v[50:51], 0
    v_mfma_f32_16x16x16_bf16 v[76:79], v[72:73], v[52:53], 0
    v_mfma_f32_16x16x16_bf16 v[116:119], v[68:69], v[52:53], 0
    v_mfma_f32_16x16x16_bf16 v[80:83], v[74:75], v[54:55], 0
    v_mfma_f32_16x16x16_bf16 v[120:123], v[70:71], v[54:55], 0
    s_waitcnt lgkmcnt(0)
    v_pk_mul_f32 v[100:101], v[100:101], v[124:125]
    v_pk_mul_f32 v[102:103], v[102:103], v[126:127]
    v_pk_mul_f32 v[104:105], v[104:105], v[132:133]
    v_pk_mul_f32 v[106:107], v[106:107], v[134:135]
    v_pk_mul_f32 v[108:109], v[108:109], v[140:141]
    v_pk_mul_f32 v[110:111], v[110:111], v[142:143]
    v_pk_fma_f32 v[100:101], v[128:129], v[20:21], v[100:101] op_sel_hi:[1,0,1]
    v_pk_fma_f32 v[102:103], v[130:131], v[20:21], v[102:103] op_sel_hi:[1,0,1]
    v_pk_fma_f32 v[104:105], v[136:137], v[20:21], v[104:105] op_sel_hi:[1,0,1]
    v_pk_fma_f32 v[106:107], v[138:139], v[20:21], v[106:107] op_sel_hi:[1,0,1]
    v_pk_fma_f32 v[108:109], v[144:145], v[20:21], v[108:109] op_sel_hi:[1,0,1]
    v_pk_fma_f32 v[110:111], v[146:147], v[20:21], v[110:111] op_sel_hi:[1,0,1]
    v_cvt_pk_bf16_f32 v94, v100, v101
    v_cvt_pk_bf16_f32 v95, v102, v103
    v_cvt_pk_bf16_f32 v96, v104, v105
    v_cvt_pk_bf16_f32 v97, v106, v107
    v_cvt_pk_bf16_f32 v98, v108, v109
    v_cvt_pk_bf16_f32 v99, v110, v111
    v_cndmask_b32 v56, v84, v56, s[4:5]
    v_cndmask_b32 v60, v112, v60, s[4:5]
    v_cndmask_b32 v76, v116, v76, s[4:5]
    v_cndmask_b32 v80, v120, v80, s[4:5]
    v_cndmask_b32 v57, v85, v57, s[6:7]
    v_cndmask_b32 v61, v113, v61, s[6:7]
    v_cndmask_b32 v77, v117, v77, s[6:7]
    v_cndmask_b32 v81, v121, v81, s[6:7]
    v_cndmask_b32 v58, v86, v58, s[8:9]
    v_cndmask_b32 v62, v114, v62, s[8:9]
    v_cndmask_b32 v78, v118, v78, s[8:9]
    v_cndmask_b32 v82, v122, v82, s[8:9]
    v_cndmask_b32 v59, v87, v59, s[10:11]
    v_cndmask_b32 v63, v115, v63, s[10:11]
    v_cndmask_b32 v79, v119, v79, s[10:11]
    v_cndmask_b32 v83, v123, v83, s[10:11]
    v_cndmask_b32 v56, v153, v56, s[68:69]
    v_cndmask_b32 v60, v153, v60, s[68:69]
    v_cndmask_b32 v76, v153, v76, s[12:13]
    v_cndmask_b32 v80, v153, v80, s[12:13]
    v_cndmask_b32 v57, v153, v57, s[70:71]
    v_cndmask_b32 v61, v153, v61, s[70:71]
    v_cndmask_b32 v77, v153, v77, s[14:15]
    v_cndmask_b32 v81, v153, v81, s[14:15]
    v_cndmask_b32 v58, v153, v58, s[72:73]
    v_cndmask_b32 v62, v153, v62, s[72:73]
    v_cndmask_b32 v78, v153, v78, s[16:17]
    v_cndmask_b32 v82, v153, v82, s[16:17]
    v_cndmask_b32 v59, v153, v59, s[74:75]
    v_cndmask_b32 v63, v153, v63, s[74:75]
    v_cndmask_b32 v79, v153, v79, s[18:19]
    v_cndmask_b32 v83, v153, v83, s[18:19]
    v_max3_f32 v28, v56, v57, v58
    v_max3_f32 v30, v60, v61, v62
    v_max3_f32 v32, v76, v77, v78
    v_max3_f32 v34, v80, v81, v82
    v_max_f32 v28, v28, v59
    v_max_f32 v30, v30, v63
    v_max_f32 v32, v32, v79
    v_max_f32 v34, v34, v83
    v_mov_b32 v29, v28
    v_mov_b32 v31, v30
    v_mov_b32 v33, v32
    v_mov_b32 v35, v34
    v_permlane32_swap_b32 v28, v29
    v_permlane32_swap_b32 v30, v31
    v_permlane32_swap_b32 v32, v33
    v_permlane32_swap_b32 v34, v35
    v_max_f32 v28, v28, v29
    v_max_f32 v30, v30, v31
    v_max_f32 v32, v32, v33
    v_max_f32 v34, v34, v35
    v_mov_b32 v29, v28
    v_mov_b32 v31, v30
    v_mov_b32 v33, v32
    v_mov_b32 v35, v34
    v_permlane16_swap_b32 v28, v29
    v_permlane16_swap_b32 v30, v31
    v_permlane16_swap_b32 v32, v33
    v_permlane16_swap_b32 v34, v35
    v_max_f32 v28, v28, v29
    v_max_f32 v30, v30, v31
    v_max_f32 v32, v32, v33
    v_max_f32 v34, v34, v35
    v_sub_f32 v56, v56, v28
    v_sub_f32 v57, v57, v28
    v_sub_f32 v58, v58, v28
    v_sub_f32 v59, v59, v28
    v_sub_f32 v60, v60, v30
    v_sub_f32 v61, v61, v30
    v_sub_f32 v62, v62, v30
    v_sub_f32 v63, v63, v30
    v_sub_f32 v76, v76, v32
    v_sub_f32 v77, v77, v32
    v_sub_f32 v78, v78, v32
    v_sub_f32 v79, v79, v32
    v_sub_f32 v80, v80, v34
    v_sub_f32 v81, v81, v34
    v_sub_f32 v82, v82, v34
    v_sub_f32 v83, v83, v34
    v_mul_f32 v56, s77, v56
    v_mul_f32 v57, s77, v57
    v_mul_f32 v58, s77, v58
    v_mul_f32 v59, s77, v59
    v_mul_f32 v60, s77, v60
    v_mul_f32 v61, s77, v61
    v_mul_f32 v62, s77, v62
    v_mul_f32 v63, s77, v63
    v_mul_f32 v76, s77, v76
    v_mul_f32 v77, s77, v77
    v_mul_f32 v78, s77, v78
    v_mul_f32 v79, s77, v79
    v_mul_f32 v80, s77, v80
    v_mul_f32 v81, s77, v81
    v_mul_f32 v82, s77, v82
    v_mul_f32 v83, s77, v83
    v_exp_f32 v56, v56
    v_exp_f32 v57, v57
    v_exp_f32 v58, v58
    v_exp_f32 v59, v59
    v_exp_f32 v60, v60
    v_exp_f32 v61, v61
    v_exp_f32 v62, v62
    v_exp_f32 v63, v63
    v_exp_f32 v76, v76
    v_exp_f32 v77, v77
    v_exp_f32 v78, v78
    v_exp_f32 v79, v79
    v_exp_f32 v80, v80
    v_exp_f32 v81, v81
    v_exp_f32 v82, v82
    v_exp_f32 v83, v83
    v_add_f32 v28, v56, v57
    v_add_f32 v29, v58, v59
    v_add_f32 v30, v60, v61
    v_add_f32 v31, v62, v63
    v_add_f32 v32, v76, v77
    v_add_f32 v33, v78, v79
    v_add_f32 v34, v80, v81
    v_add_f32 v35, v82, v83
    v_add_f32 v28, v28, v29
    v_add_f32 v30, v30, v31
    v_add_f32 v32, v32, v33
    v_add_f32 v34, v34, v35
    v_mov_b32 v29, v28
    v_mov_b32 v31, v30
    v_mov_b32 v33, v32
    v_mov_b32 v35, v34
    v_permlane32_swap_b32 v28, v29
    v_permlane32_swap_b32 v30, v31
    v_permlane32_swap_b32 v32, v33
    v_permlane32_swap_b32 v34, v35
    v_add_f32 v28, v28, v29
    v_add_f32 v30, v30, v31
    v_add_f32 v32, v32, v33
    v_add_f32 v34, v34, v35
    v_mov_b32 v29, v28
    v_mov_b32 v31, v30
    v_mov_b32 v33, v32
    v_mov_b32 v35, v34
    v_permlane16_swap_b32 v28, v29
    v_permlane16_swap_b32 v30, v31
    v_permlane16_swap_b32 v32, v33
    v_permlane16_swap_b32 v34, v35
    v_add_f32 v28, v28, v29
    v_add_f32 v30, v30, v31
    v_add_f32 v32, v32, v33
    v_add_f32 v34, v34, v35
    v_rcp_f32 v28, v28
    v_rcp_f32 v30, v30
    v_rcp_f32 v32, v32
    v_rcp_f32 v34, v34
    v_pk_mul_f32 v[56:57], v[56:57], v[28:29] op_sel_hi:[1,0]
    v_pk_mul_f32 v[58:59], v[58:59], v[28:29] op_sel_hi:[1,0]
    v_pk_mul_f32 v[60:61], v[60:61], v[30:31] op_sel_hi:[1,0]
    v_pk_mul_f32 v[62:63], v[62:63], v[30:31] op_sel_hi:[1,0]
    v_pk_mul_f32 v[76:77], v[76:77], v[32:33] op_sel_hi:[1,0]
    v_pk_mul_f32 v[78:79], v[78:79], v[32:33] op_sel_hi:[1,0]
    v_pk_mul_f32 v[80:81], v[80:81], v[34:35] op_sel_hi:[1,0]
    v_pk_mul_f32 v[82:83], v[82:83], v[34:35] op_sel_hi:[1,0]
    v_cvt_pk_bf16_f32 v56, v56, v57
    v_cvt_pk_bf16_f32 v57, v58, v59
    v_cvt_pk_bf16_f32 v60, v60, v61
    v_cvt_pk_bf16_f32 v61, v62, v63
    v_cvt_pk_bf16_f32 v76, v76, v77
    v_cvt_pk_bf16_f32 v77, v78, v79
    v_cvt_pk_bf16_f32 v80, v80, v81
    v_cvt_pk_bf16_f32 v81, v82, v83
    v_and_b32 v58, v56, v156
    v_and_b32 v59, v57, v157
    v_and_b32 v62, v60, v156
    v_and_b32 v63, v61, v157
    v_and_b32 v78, v76, v156
    v_and_b32 v79, v77, v157
    v_and_b32 v82, v80, v156
    v_and_b32 v83, v81, v157
    v_and_b32 v56, v56, v154
    v_and_b32 v57, v57, v155
    v_and_b32 v60, v60, v154
    v_and_b32 v61, v61, v155
    v_and_b32 v76, v76, v154
    v_and_b32 v77, v77, v155
    v_and_b32 v80, v80, v154
    v_and_b32 v81, v81, v155
    v_mfma_f32_16x16x16_bf16 v[84:87], v[88:89], v[58:59], 0
    v_mfma_f32_16x16x16_bf16 v[112:115], v[90:91], v[62:63], 0
    v_mfma_f32_16x16x16_bf16 v[116:119], v[92:93], v[78:79], 0
    v_mfma_f32_16x16x16_bf16 v[120:123], v[94:95], v[82:83], 0
    v_mfma_f32_16x16x16_bf16 v[84:87], v[92:93], v[56:57], v[84:87]
    v_mfma_f32_16x16x16_bf16 v[112:115], v[94:95], v[60:61], v[112:115]
    v_mfma_f32_16x16x16_bf16 v[116:119], v[96:97], v[76:77], v[116:119]
    v_mfma_f32_16x16x16_bf16 v[120:123], v[98:99], v[80:81], v[120:123]
    v_lshlrev_b32 v20, 7, v1
    s_nop 3
    v_cvt_pk_bf16_f32 v48, v84, v85
    v_cvt_pk_bf16_f32 v49, v86, v87
    v_cvt_pk_bf16_f32 v50, v112, v113
    v_cvt_pk_bf16_f32 v51, v114, v115
    v_cvt_pk_bf16_f32 v52, v116, v117
    v_cvt_pk_bf16_f32 v53, v118, v119
    v_cvt_pk_bf16_f32 v54, v120, v121
    v_cvt_pk_bf16_f32 v55, v122, v123
    s_nop 0
    v_permlane16_swap_b32 v48, v50
    v_permlane16_swap_b32 v49, v51
    v_permlane16_swap_b32 v52, v54
    v_permlane16_swap_b32 v53, v55
    buffer_store_dwordx4 v[48:51], v152, s[48:51], s40 offen sc1
    buffer_store_dwordx4 v[52:55], v152, s[48:51], s76 offen sc1
    s_cmp_eq_u32 s36, 0
    s_cselect_b32 s67, 0x400000, 0
    s_add_u32 s68, s67, 0x200000
    s_lshl_b32 s64, s31, 2
    s_add_u32 s64, s64, s26
    s_lshl_b32 s33, s64, 4
    v_add_u32 v84, s33, v2
    s_lshl_b32 s34, s32, 1
    s_add_u32 s33, s33, s34
    s_lshl_b32 s33, s33, 10
    v_add_u32 v85, s33, v24
    s_lshl_b32 s65, s64, 7
    s_lshl_b32 s33, s32, 2
    s_add_u32 s65, s65, s33
    s_mov_b32 s5, 0
    v_bfe_u32 v8, v1, 2, 2
    v_lshl_add_u32 v9, v3, 3, v8
    v_lshrrev_b32 v10, 1, v8
    v_and_b32 v8, 1, v3
    v_lshl_or_b32 v10, v8, 1, v10
    v_lshlrev_b32 v10, 5, v10
    v_lshl_or_b32 v10, v9, 7, v10
    v_and_b32 v8, 3, v1
    v_lshl_or_b32 v65, v8, 3, v10
    v_xor_b32 v66, 32, v65
    v_xor_b32 v67, 64, v65
    v_xor_b32 v68, 96, v65
    v_add_u32 v69, 0xc000, v65
    v_add_u32 v70, 0xc000, v66
    v_add_u32 v71, 0xc000, v67
    v_add_u32 v72, 0xc000, v68
    v_add_u32 v73, 0x18000, v65
    v_add_u32 v74, 0x18000, v66
    v_add_u32 v75, 0x18000, v67
    v_add_u32 v76, 0x18000, v68
    s_mul_i32 s33, s64, 16384
    s_add_u32 s33, s33, 0x0
    v_add_u32 v77, s33, v24
    s_lshl_b32 s33, s64, 7
    s_add_u32 s33, s33, 0xfd0000
    v_lshl_add_u32 v64, v1, 2, s33
    s_mov_b32 s4, 0xffffffff
    s_waitcnt vmcnt(2)
    v_accvgpr_read_b32 v40, a72
    v_accvgpr_read_b32 v41, a73
    v_accvgpr_read_b32 v42, a74
    v_accvgpr_read_b32 v43, a75
    v_accvgpr_read_b32 v44, a76
    v_accvgpr_read_b32 v45, a77
    v_accvgpr_read_b32 v46, a78
    v_accvgpr_read_b32 v47, a79
    v_lshlrev_b32 v88, 16, v40
    v_and_b32 v89, 0xffff0000, v40
    v_lshlrev_b32 v90, 16, v41
    v_and_b32 v91, 0xffff0000, v41
    v_lshlrev_b32 v92, 16, v42
    v_and_b32 v93, 0xffff0000, v42
    v_lshlrev_b32 v94, 16, v43
    v_and_b32 v95, 0xffff0000, v43
    v_lshlrev_b32 v96, 16, v44
    v_and_b32 v97, 0xffff0000, v44
    v_lshlrev_b32 v98, 16, v45
    v_and_b32 v99, 0xffff0000, v45
    v_lshlrev_b32 v100, 16, v46
    v_and_b32 v101, 0xffff0000, v46
    v_lshlrev_b32 v102, 16, v47
    v_and_b32 v103, 0xffff0000, v47
    s_waitcnt vmcnt(0)
    s_cmp_eq_u32 s36, 0
    s_cbranch_scc1 L_sequential_preLN__sliding_local_dilated__mixer_s_mlp__prompt_kernel_alt_168
    s_mov_b64 exec, 15
    buffer_store_dword v6, v20, s[48:51], s41 offen
    s_mov_b64 exec, -1
L_sequential_preLN__sliding_local_dilated__mixer_s_mlp__prompt_kernel_altb_169:
    s_cmp_lt_u32 s52, 9
    s_cbranch_scc1 L_sequential_preLN__sliding_local_dilated__mixer_s_mlp__prompt_kernel_lws_171
L_sequential_preLN__sliding_local_dilated__mixer_s_mlp__prompt_kernel_lwb_170:
    ds_read_b64_tr_b16 a[48:49], v69 offset:43008
    ds_read_b64_tr_b16 a[50:51], v69 offset:43520
    ds_read_b64_tr_b16 a[52:53], v70 offset:43008
    ds_read_b64_tr_b16 a[54:55], v70 offset:43520
    ds_read_b64_tr_b16 a[56:57], v71 offset:43008
    ds_read_b64_tr_b16 a[58:59], v71 offset:43520
    ds_read_b64_tr_b16 a[60:61], v72 offset:43008
    ds_read_b64_tr_b16 a[62:63], v72 offset:43520
    ds_read_b64_tr_b16 a[64:65], v69 offset:47104
    ds_read_b64_tr_b16 a[66:67], v69 offset:47616
    ds_read_b64_tr_b16 a[68:69], v70 offset:47104
    ds_read_b64_tr_b16 a[70:71], v70 offset:47616
    ds_read_b64_tr_b16 a[72:73], v71 offset:47104
    ds_read_b64_tr_b16 a[74:75], v71 offset:47616
    ds_read_b64_tr_b16 a[76:77], v72 offset:47104
    ds_read_b64_tr_b16 a[78:79], v72 offset:47616
    ds_read_b64_tr_b16 a[80:81], v69 offset:51200
    ds_read_b64_tr_b16 a[82:83], v69 offset:51712
    ds_read_b64_tr_b16 a[84:85], v70 offset:51200
    ds_read_b64_tr_b16 a[86:87], v70 offset:51712
    ds_read_b64_tr_b16 a[88:89], v71 offset:51200
    ds_read_b64_tr_b16 a[90:91], v71 offset:51712
    ds_read_b64_tr_b16 a[92:93], v72 offset:51200
    ds_read_b64_tr_b16 a[94:95], v72 offset:51712
    v_lshlrev_b32 v25, 10, v84
    v_and_b32 v8, 1, v3
    v_lshl_add_u32 v25, v8, 5, v25
    v_lshrrev_b32 v8, 1, v3
    v_lshl_add_u32 v25, v8, 4, v25
    v_lshlrev_b32 v86, 3, v84
    v_lshrrev_b32 v8, 5, v1
    v_lshl_add_u32 v86, v8, 2, v86
    s_lshl_b32 s33, s32, 14
    v_add_u32 v86, s33, v86
    v_lshl_add_u32 v26, v3, 4, v4
    v_bfe_u32 v8, v1, 2, 2
    v_lshl_add_u32 v9, v3, 2, v8
    v_bfe_u32 v10, v9, 1, 2
    v_lshlrev_b32 v10, 5, v10
    v_lshl_or_b32 v10, v9, 7, v10
    v_and_b32 v8, 3, v1
    v_lshl_or_b32 v27, v8, 3, v10
    v_xor_b32 v28, 32, v27
    v_xor_b32 v29, 64, v27
    v_xor_b32 v30, 96, v27
    s_mov_b32 s13, 0
    v_add_u32 v49, 0xc000, v27
    v_add_u32 v50, 0xc000, v28
    v_add_u32 v51, 0xc000, v29
    v_add_u32 v52, 0xc000, v30
    s_mul_i32 s33, s64, 16384
    s_add_u32 s33, s33, 0x200000
    v_add_u32 v53, s33, v24
    s_lshl_b32 s33, s64, 7
    s_add_u32 s33, s33, 0xfd4000
    v_lshl_add_u32 v48, v1, 2, s33
    s_mov_b32 s12, 0xff
    v_lshlrev_b32 v54, 3, v84
    v_lshl_add_u32 v54, v3, 15, v54
    s_lshl_b32 s33, s32, 11
    v_and_b32 v8, 1, v2
    v_lshlrev_b32 v8, 4, v8
    v_lshl_add_u32 v8, v3, 5, v8
    v_add_u32 v55, s33, v8
    s_and_b32 s33, s64, 7
    s_cmp_eq_u32 s33, 7
    s_cselect_b32 s34, 1, 0
    s_mov_b32 s16, 0x00030003
    s_cselect_b32 s16, 0xc000c000, s16
    s_mov_b32 s17, s16
    s_lshl_b32 s14, s29, 1
    s_add_u32 s14, s14, s34
    s_lshl_b32 s15, s14, 7
    s_lshl_b32 s14, s14, 14
    s_add_u32 s14, s14, 0xf00000
    s_lshl_b32 s34, s32, 2
    s_add_u32 s15, s15, s34
    s_add_u32 s15, s15, 0xfe4000
    s_add_u32 s33, s33, 1
    s_and_b32 s33, s33, 7
    s_cmp_le_u32 s33, 1
    s_cselect_b32 s18, 1, 0
    s_branch L_sequential_preLN__sliding_local_dilated__mixer_s_mlp__prompt_kernel_isl_173
L_sequential_preLN__sliding_local_dilated__mixer_s_mlp__prompt_kernel_lws_151:
    s_movk_i32 s42, 1
    s_call_b64 s[44:45], L_wait_c_0_52_0
    s_branch L_sequential_preLN__sliding_local_dilated__mixer_s_mlp__prompt_kernel_lwb_150
L_sequential_preLN__sliding_local_dilated__mixer_s_mlp__prompt_kernel_lws_153:
    s_movk_i32 s42, 2
    s_call_b64 s[44:45], L_wait_c_0_52_0
    s_branch L_sequential_preLN__sliding_local_dilated__mixer_s_mlp__prompt_kernel_lwb_152
L_sequential_preLN__sliding_local_dilated__mixer_s_mlp__prompt_kernel_lws_155:
    s_movk_i32 s42, 3
    s_call_b64 s[44:45], L_wait_c_0_52_0
    s_branch L_sequential_preLN__sliding_local_dilated__mixer_s_mlp__prompt_kernel_lwb_154
L_sequential_preLN__sliding_local_dilated__mixer_s_mlp__prompt_kernel_lws_157:
    s_movk_i32 s42, 4
    s_call_b64 s[44:45], L_wait_c_0_52_0
    s_branch L_sequential_preLN__sliding_local_dilated__mixer_s_mlp__prompt_kernel_lwb_156
L_sequential_preLN__sliding_local_dilated__mixer_s_mlp__prompt_kernel_lws_159:
    s_movk_i32 s42, 5
    s_call_b64 s[44:45], L_wait_c_0_52_0
    s_branch L_sequential_preLN__sliding_local_dilated__mixer_s_mlp__prompt_kernel_lwb_158
L_sequential_preLN__sliding_local_dilated__mixer_s_mlp__prompt_kernel_lws_161:
    s_movk_i32 s42, 6
    s_call_b64 s[44:45], L_wait_c_0_52_0
    s_branch L_sequential_preLN__sliding_local_dilated__mixer_s_mlp__prompt_kernel_lwb_160
L_sequential_preLN__sliding_local_dilated__mixer_s_mlp__prompt_kernel_lws_163:
    s_movk_i32 s42, 7
    s_call_b64 s[44:45], L_wait_c_0_52_0
    s_branch L_sequential_preLN__sliding_local_dilated__mixer_s_mlp__prompt_kernel_lwb_162
L_sequential_preLN__sliding_local_dilated__mixer_s_mlp__prompt_kernel_lws_165:
    s_movk_i32 s42, 8
    s_call_b64 s[44:45], L_wait_c_0_52_0
    s_branch L_sequential_preLN__sliding_local_dilated__mixer_s_mlp__prompt_kernel_lwb_164
L_sequential_preLN__sliding_local_dilated__mixer_s_mlp__prompt_kernel_lws_167:
    s_movk_i32 s42, 1
    s_call_b64 s[44:45], L_wait_c_64_53_0
    s_branch L_sequential_preLN__sliding_local_dilated__mixer_s_mlp__prompt_kernel_lwb_166
L_sequential_preLN__sliding_local_dilated__mixer_s_mlp__prompt_kernel_alt_168:
    s_mov_b64 exec, 15
    buffer_store_dword v6, v20, s[48:51], s41 offen sc1
    s_mov_b64 exec, -1
    s_branch L_sequential_preLN__sliding_local_dilated__mixer_s_mlp__prompt_kernel_altb_169
L_sequential_preLN__sliding_local_dilated__mixer_s_mlp__prompt_kernel_lws_171:
    s_movk_i32 s42, 9
    s_call_b64 s[44:45], L_wait_c_0_52_0
    s_branch L_sequential_preLN__sliding_local_dilated__mixer_s_mlp__prompt_kernel_lwb_170
L_sequential_preLN__sliding_local_dilated__mixer_s_mlp__prompt_kernel_psub_172:
    s_mov_b32 s27, 0
    s_mov_b64 exec, s[4:5]
L_sequential_preLN__sliding_local_dilated__mixer_s_mlp__prompt_kernel_psub_172_t:
    buffer_load_dword v21, v64, s[48:51], 0 offen sc1
    s_waitcnt vmcnt(0)
    v_cmp_eq_u32 vcc, s35, v21
    s_nop 0
    s_or_b32 s70, vcc_lo, s71
    s_andn2_b32 s33, s42, s70
    s_cbranch_scc0 L_sequential_preLN__sliding_local_dilated__mixer_s_mlp__prompt_kernel_psub_172_o
    s_sleep 2
    s_add_u32 s27, s27, 1
    s_cmp_lt_u32 s27, 0x40000
    s_cbranch_scc1 L_sequential_preLN__sliding_local_dilated__mixer_s_mlp__prompt_kernel_psub_172_t
L_sequential_preLN__sliding_local_dilated__mixer_s_mlp__prompt_kernel_psub_172_o:
    s_mov_b64 exec, -1
    s_setpc_b64 s[44:45]
L_sequential_preLN__sliding_local_dilated__mixer_s_mlp__prompt_kernel_isl_173:
    s_mov_b32 s27, 0
    s_mov_b64 exec, s[4:5]
L_sequential_preLN__sliding_local_dilated__mixer_s_mlp__prompt_kernel_gpoll_174:
    buffer_load_dword v8, v64, s[48:51], 0 offen sc1
    s_waitcnt vmcnt(0)
    v_cmp_ne_u32 vcc, s35, v8
    s_nop 0
    s_cmp_eq_u64 vcc, 0
    s_cbranch_scc1 L_sequential_preLN__sliding_local_dilated__mixer_s_mlp__prompt_kernel_gok_175
    s_sleep 2
    s_add_u32 s27, s27, 1
    s_cmp_lt_u32 s27, 0x40000
    s_cbranch_scc1 L_sequential_preLN__sliding_local_dilated__mixer_s_mlp__prompt_kernel_gpoll_174
L_sequential_preLN__sliding_local_dilated__mixer_s_mlp__prompt_kernel_gok_175:
    s_mov_b64 exec, -1
    s_mov_b32 s66, 0x0
    buffer_load_dwordx4 a[0:3], v77, s[48:51], s66 offen offset:0 sc1
    buffer_load_dwordx4 a[4:7], v77, s[48:51], s66 offen offset:1024 sc1
    buffer_load_dwordx4 a[8:11], v77, s[48:51], s66 offen offset:2048 sc1
    buffer_load_dwordx4 a[12:15], v77, s[48:51], s66 offen offset:3072 sc1
    s_mov_b32 s66, 0x1000
    buffer_load_dwordx4 a[16:19], v77, s[48:51], s66 offen offset:0 sc1
    buffer_load_dwordx4 a[20:23], v77, s[48:51], s66 offen offset:1024 sc1
    buffer_load_dwordx4 a[24:27], v77, s[48:51], s66 offen offset:2048 sc1
    buffer_load_dwordx4 a[28:31], v77, s[48:51], s66 offen offset:3072 sc1
    s_mov_b32 s66, 0x2000
    buffer_load_dwordx4 a[32:35], v77, s[48:51], s66 offen offset:0 sc1
    v_add_u32 v78, 0xf80000, v86
    s_add_u32 s69, s65, 0xfd4000
    s_waitcnt vmcnt(8) lgkmcnt(15)
    v_mfma_f32_16x16x32_bf16 v[88:91], a[48:51], a[0:3], v[88:91]
    ds_read_b64_tr_b16 a[48:49], v69 offset:55296
    ds_read_b64_tr_b16 a[50:51], v69 offset:55808
    v_mfma_f32_16x16x32_bf16 v[92:95], a[52:55], a[0:3], v[92:95]
    ds_read_b64_tr_b16 a[52:53], v70 offset:55296
    ds_read_b64_tr_b16 a[54:55], v70 offset:55808
    v_mfma_f32_16x16x32_bf16 v[96:99], a[56:59], a[0:3], v[96:99]
    ds_read_b64_tr_b16 a[56:57], v71 offset:55296
    ds_read_b64_tr_b16 a[58:59], v71 offset:55808
    v_mfma_f32_16x16x32_bf16 v[100:103], a[60:63], a[0:3], v[100:103]
    ds_read_b64_tr_b16 a[60:61], v72 offset:55296
    ds_read_b64_tr_b16 a[62:63], v72 offset:55808
    buffer_load_dwordx4 a[36:39], v77, s[48:51], s66 offen offset:1024 sc1
    s_waitcnt vmcnt(8) lgkmcnt(15)
    v_mfma_f32_16x16x32_bf16 v[88:91], a[64:67], a[4:7], v[88:91]
    s_cmp_lt_u32 s52, 10
    s_cbranch_scc1 L_sequential_preLN__sliding_local_dilated__mixer_s_mlp__prompt_kernel_lws_177
L_sequential_preLN__sliding_local_dilated__mixer_s_mlp__prompt_kernel_lwb_176:
    ds_read_b64_tr_b16 a[64:65], v73 offset:10240
    ds_read_b64_tr_b16 a[66:67], v73 offset:10752
    v_mfma_f32_16x16x32_bf16 v[92:95], a[68:71], a[4:7], v[92:95]
    ds_read_b64_tr_b16 a[68:69], v74 offset:10240
    ds_read_b64_tr_b16 a[70:71], v74 offset:10752
    v_mfma_f32_16x16x32_bf16 v[96:99], a[72:75], a[4:7], v[96:99]
    ds_read_b64_tr_b16 a[72:73], v75 offset:10240
    ds_read_b64_tr_b16 a[74:75], v75 offset:10752
    v_mfma_f32_16x16x32_bf16 v[100:103], a[76:79], a[4:7], v[100:103]
    ds_read_b64_tr_b16 a[76:77], v76 offset:10240
    ds_read_b64_tr_b16 a[78:79], v76 offset:10752
    buffer_load_dwordx4 a[40:43], v77, s[48:51], s66 offen offset:2048 sc1
    s_waitcnt vmcnt(8) lgkmcnt(15)
    v_mfma_f32_16x16x32_bf16 v[88:91], a[80:83], a[8:11], v[88:91]
    ds_read_b64_tr_b16 a[80:81], v73 offset:14336
    ds_read_b64_tr_b16 a[82:83], v73 offset:14848
    v_mfma_f32_16x16x32_bf16 v[92:95], a[84:87], a[8:11], v[92:95]
    ds_read_b64_tr_b16 a[84:85], v74 offset:14336
    ds_read_b64_tr_b16 a[86:87], v74 offset:14848
    v_mfma_f32_16x16x32_bf16 v[96:99], a[88:91], a[8:11], v[96:99]
    ds_read_b64_tr_b16 a[88:89], v75 offset:14336
    ds_read_b64_tr_b16 a[90:91], v75 offset:14848
    v_mfma_f32_16x16x32_bf16 v[100:103], a[92:95], a[8:11], v[100:103]
    ds_read_b64_tr_b16 a[92:93], v76 offset:14336
    ds_read_b64_tr_b16 a[94:95], v76 offset:14848
    buffer_load_dwordx4 a[44:47], v77, s[48:51], s66 offen offset:3072 sc1
    s_waitcnt vmcnt(8) lgkmcnt(15)
    v_mfma_f32_16x16x32_bf16 v[88:91], a[48:51], a[12:15], v[88:91]
    ds_read_b64_tr_b16 a[48:49], v73 offset:18432
    ds_read_b64_tr_b16 a[50:51], v73 offset:18944
    v_mfma_f32_16x16x32_bf16 v[92:95], a[52:55], a[12:15], v[92:95]
    ds_read_b64_tr_b16 a[52:53], v74 offset:18432
    ds_read_b64_tr_b16 a[54:55], v74 offset:18944
    v_mfma_f32_16x16x32_bf16 v[96:99], a[56:59], a[12:15], v[96:99]
    ds_read_b64_tr_b16 a[56:57], v75 offset:18432
    ds_read_b64_tr_b16 a[58:59], v75 offset:18944
    v_mfma_f32_16x16x32_bf16 v[100:103], a[60:63], a[12:15], v[100:103]
    ds_read_b64_tr_b16 a[60:61], v76 offset:18432
    ds_read_b64_tr_b16 a[62:63], v76 offset:18944
    v_mov_b32 v12, 9
    s_mov_b64 exec, 1
    ds_max_u32 v5, v12 offset:16
    s_mov_b64 exec, -1
    s_mov_b32 s66, 0x3000
    buffer_load_dwordx4 a[0:3], v77, s[48:51], s66 offen offset:0 sc1
    s_waitcnt vmcnt(8) lgkmcnt(15)
    v_mfma_f32_16x16x32_bf16 v[88:91], a[64:67], a[16:19], v[88:91]
    ds_read_b64_tr_b16 a[64:65], v73 offset:22528
    ds_read_b64_tr_b16 a[66:67], v73 offset:23040
    v_mfma_f32_16x16x32_bf16 v[92:95], a[68:71], a[16:19], v[92:95]
    ds_read_b64_tr_b16 a[68:69], v74 offset:22528
    ds_read_b64_tr_b16 a[70:71], v74 offset:23040
    v_mfma_f32_16x16x32_bf16 v[96:99], a[72:75], a[16:19], v[96:99]
    ds_read_b64_tr_b16 a[72:73], v75 offset:22528
    ds_read_b64_tr_b16 a[74:75], v75 offset:23040
    v_mfma_f32_16x16x32_bf16 v[100:103], a[76:79], a[16:19], v[100:103]
    ds_read_b64_tr_b16 a[76:77], v76 offset:22528
    ds_read_b64_tr_b16 a[78:79], v76 offset:23040
    buffer_load_dwordx4 a[4:7], v77, s[48:51], s66 offen offset:1024 sc1
    s_waitcnt vmcnt(8) lgkmcnt(15)
    v_mfma_f32_16x16x32_bf16 v[88:91], a[80:83], a[20:23], v[88:91]
    s_cmp_lt_u32 s52, 11
    s_cbranch_scc1 L_sequential_preLN__sliding_local_dilated__mixer_s_mlp__prompt_kernel_lws_179
L_sequential_preLN__sliding_local_dilated__mixer_s_mlp__prompt_kernel_lwb_178:
    ds_read_b64_tr_b16 a[80:81], v73 offset:26624
    ds_read_b64_tr_b16 a[82:83], v73 offset:27136
    v_mfma_f32_16x16x32_bf16 v[92:95], a[84:87], a[20:23], v[92:95]
    ds_read_b64_tr_b16 a[84:85], v74 offset:26624
    ds_read_b64_tr_b16 a[86:87], v74 offset:27136
    v_mfma_f32_16x16x32_bf16 v[96:99], a[88:91], a[20:23], v[96:99]
    ds_read_b64_tr_b16 a[88:89], v75 offset:26624
    ds_read_b64_tr_b16 a[90:91], v75 offset:27136
    v_mfma_f32_16x16x32_bf16 v[100:103], a[92:95], a[20:23], v[100:103]
    ds_read_b64_tr_b16 a[92:93], v76 offset:26624
    ds_read_b64_tr_b16 a[94:95], v76 offset:27136
    buffer_load_dwordx4 a[8:11], v77, s[48:51], s66 offen offset:2048 sc1
    s_waitcnt vmcnt(8) lgkmcnt(15)
    v_mfma_f32_16x16x32_bf16 v[88:91], a[48:51], a[24:27], v[88:91]
    ds_read_b64_tr_b16 a[48:49], v73 offset:30720
    ds_read_b64_tr_b16 a[50:51], v73 offset:31232
    v_mfma_f32_16x16x32_bf16 v[92:95], a[52:55], a[24:27], v[92:95]
    ds_read_b64_tr_b16 a[52:53], v74 offset:30720
    ds_read_b64_tr_b16 a[54:55], v74 offset:31232
    v_mfma_f32_16x16x32_bf16 v[96:99], a[56:59], a[24:27], v[96:99]
    ds_read_b64_tr_b16 a[56:57], v75 offset:30720
    ds_read_b64_tr_b16 a[58:59], v75 offset:31232
    v_mfma_f32_16x16x32_bf16 v[100:103], a[60:63], a[24:27], v[100:103]
    ds_read_b64_tr_b16 a[60:61], v76 offset:30720
    ds_read_b64_tr_b16 a[62:63], v76 offset:31232
    buffer_load_dwordx4 a[12:15], v77, s[48:51], s66 offen offset:3072 sc1
    s_waitcnt vmcnt(8) lgkmcnt(15)
    v_mfma_f32_16x16x32_bf16 v[88:91], a[64:67], a[28:31], v[88:91]
    ds_read_b64_tr_b16 a[64:65], v73 offset:34816
    ds_read_b64_tr_b16 a[66:67], v73 offset:35328
    v_mfma_f32_16x16x32_bf16 v[92:95], a[68:71], a[28:31], v[92:95]
    ds_read_b64_tr_b16 a[68:69], v74 offset:34816
    ds_read_b64_tr_b16 a[70:71], v74 offset:35328
    v_mfma_f32_16x16x32_bf16 v[96:99], a[72:75], a[28:31], v[96:99]
    ds_read_b64_tr_b16 a[72:73], v75 offset:34816
    ds_read_b64_tr_b16 a[74:75], v75 offset:35328
    v_mfma_f32_16x16x32_bf16 v[100:103], a[76:79], a[28:31], v[100:103]
    ds_read_b64_tr_b16 a[76:77], v76 offset:34816
    ds_read_b64_tr_b16 a[78:79], v76 offset:35328
    v_mov_b32 v12, 10
    s_mov_b64 exec, 1
    ds_max_u32 v5, v12 offset:16
    s_mov_b64 exec, -1
    s_waitcnt vmcnt(7) lgkmcnt(15)
    v_mfma_f32_16x16x32_bf16 v[88:91], a[80:83], a[32:35], v[88:91]
    ds_read_b64_tr_b16 a[80:81], v73 offset:38912
    ds_read_b64_tr_b16 a[82:83], v73 offset:39424
    v_mfma_f32_16x16x32_bf16 v[92:95], a[84:87], a[32:35], v[92:95]
    ds_read_b64_tr_b16 a[84:85], v74 offset:38912
    ds_read_b64_tr_b16 a[86:87], v74 offset:39424
    v_mfma_f32_16x16x32_bf16 v[96:99], a[88:91], a[32:35], v[96:99]
    ds_read_b64_tr_b16 a[88:89], v75 offset:38912
    ds_read_b64_tr_b16 a[90:91], v75 offset:39424
    v_mfma_f32_16x16x32_bf16 v[100:103], a[92:95], a[32:35], v[100:103]
    ds_read_b64_tr_b16 a[92:93], v76 offset:38912
    ds_read_b64_tr_b16 a[94:95], v76 offset:39424
    s_waitcnt vmcnt(6) lgkmcnt(15)
    v_mfma_f32_16x16x32_bf16 v[88:91], a[48:51], a[36:39], v[88:91]
    s_cmp_lt_u32 s52, 12
    s_cbranch_scc1 L_sequential_preLN__sliding_local_dilated__mixer_s_mlp__prompt_kernel_lws_181
L_sequential_preLN__sliding_local_dilated__mixer_s_mlp__prompt_kernel_lwb_180:
    ds_read_b64_tr_b16 a[48:49], v73 offset:43008
    ds_read_b64_tr_b16 a[50:51], v73 offset:43520
    v_mfma_f32_16x16x32_bf16 v[92:95], a[52:55], a[36:39], v[92:95]
    ds_read_b64_tr_b16 a[52:53], v74 offset:43008
    ds_read_b64_tr_b16 a[54:55], v74 offset:43520
    v_mfma_f32_16x16x32_bf16 v[96:99], a[56:59], a[36:39], v[96:99]
    ds_read_b64_tr_b16 a[56:57], v75 offset:43008
    ds_read_b64_tr_b16 a[58:59], v75 offset:43520
    v_mfma_f32_16x16x32_bf16 v[100:103], a[60:63], a[36:39], v[100:103]
    ds_read_b64_tr_b16 a[60:61], v76 offset:43008
    ds_read_b64_tr_b16 a[62:63], v76 offset:43520
    s_waitcnt vmcnt(5) lgkmcnt(15)
    v_mfma_f32_16x16x32_bf16 v[88:91], a[64:67], a[40:43], v[88:91]
    ds_read_b64_tr_b16 a[64:65], v73 offset:47104
    ds_read_b64_tr_b16 a[66:67], v73 offset:47616
    v_mfma_f32_16x16x32_bf16 v[92:95], a[68:71], a[40:43], v[92:95]
    ds_read_b64_tr_b16 a[68:69], v74 offset:47104
    ds_read_b64_tr_b16 a[70:71], v74 offset:47616
    v_mfma_f32_16x16x32_bf16 v[96:99], a[72:75], a[40:43], v[96:99]
    ds_read_b64_tr_b16 a[72:73], v75 offset:47104
    ds_read_b64_tr_b16 a[74:75], v75 offset:47616
    v_mfma_f32_16x16x32_bf16 v[100:103], a[76:79], a[40:43], v[100:103]
    ds_read_b64_tr_b16 a[76:77], v76 offset:47104
    ds_read_b64_tr_b16 a[78:79], v76 offset:47616
    s_waitcnt vmcnt(4) lgkmcnt(15)
    v_mfma_f32_16x16x32_bf16 v[88:91], a[80:83], a[44:47], v[88:91]
    ds_read_b64_tr_b16 a[80:81], v73 offset:51200
    ds_read_b64_tr_b16 a[82:83], v73 offset:51712
    v_mfma_f32_16x16x32_bf16 v[92:95], a[84:87], a[44:47], v[92:95]
    ds_read_b64_tr_b16 a[84:85], v74 offset:51200
    ds_read_b64_tr_b16 a[86:87], v74 offset:51712
    v_mfma_f32_16x16x32_bf16 v[96:99], a[88:91], a[44:47], v[96:99]
    ds_read_b64_tr_b16 a[88:89], v75 offset:51200
    ds_read_b64_tr_b16 a[90:91], v75 offset:51712
    v_mfma_f32_16x16x32_bf16 v[100:103], a[92:95], a[44:47], v[100:103]
    ds_read_b64_tr_b16 a[92:93], v76 offset:51200
    ds_read_b64_tr_b16 a[94:95], v76 offset:51712
    v_mov_b32 v12, 11
    s_mov_b64 exec, 1
    ds_max_u32 v5, v12 offset:16
    s_mov_b64 exec, -1
    s_waitcnt vmcnt(3) lgkmcnt(15)
    v_mfma_f32_16x16x32_bf16 v[88:91], a[48:51], a[0:3], v[88:91]
    ds_read_b64_tr_b16 a[48:49], v73 offset:55296
    ds_read_b64_tr_b16 a[50:51], v73 offset:55808
    v_mfma_f32_16x16x32_bf16 v[92:95], a[52:55], a[0:3], v[92:95]
    ds_read_b64_tr_b16 a[52:53], v74 offset:55296
    ds_read_b64_tr_b16 a[54:55], v74 offset:55808
    v_mfma_f32_16x16x32_bf16 v[96:99], a[56:59], a[0:3], v[96:99]
    ds_read_b64_tr_b16 a[56:57], v75 offset:55296
    ds_read_b64_tr_b16 a[58:59], v75 offset:55808
    v_mfma_f32_16x16x32_bf16 v[100:103], a[60:63], a[0:3], v[100:103]
    ds_read_b64_tr_b16 a[60:61], v76 offset:55296
    ds_read_b64_tr_b16 a[62:63], v76 offset:55808
    s_waitcnt vmcnt(2) lgkmcnt(15)
    v_mfma_f32_16x16x32_bf16 v[88:91], a[64:67], a[4:7], v[88:91]
    v_mfma_f32_16x16x32_bf16 v[92:95], a[68:71], a[4:7], v[92:95]
    v_mfma_f32_16x16x32_bf16 v[96:99], a[72:75], a[4:7], v[96:99]
    v_mfma_f32_16x16x32_bf16 v[100:103], a[76:79], a[4:7], v[100:103]
    s_waitcnt vmcnt(1) lgkmcnt(9)
    v_mfma_f32_16x16x32_bf16 v[88:91], a[80:83], a[8:11], v[88:91]
    v_mfma_f32_16x16x32_bf16 v[92:95], a[84:87], a[8:11], v[92:95]
    v_mfma_f32_16x16x32_bf16 v[96:99], a[88:91], a[8:11], v[96:99]
    v_mfma_f32_16x16x32_bf16 v[100:103], a[92:95], a[8:11], v[100:103]
    s_waitcnt vmcnt(0) lgkmcnt(0)
    v_mfma_f32_16x16x32_bf16 v[88:91], a[48:51], a[12:15], v[88:91]
    v_mfma_f32_16x16x32_bf16 v[92:95], a[52:55], a[12:15], v[92:95]
    v_mfma_f32_16x16x32_bf16 v[96:99], a[56:59], a[12:15], v[96:99]
    v_mfma_f32_16x16x32_bf16 v[100:103], a[60:63], a[12:15], v[100:103]
    v_mov_b32 v12, 12
    s_mov_b64 exec, 1
    ds_max_u32 v5, v12 offset:16
    s_mov_b64 exec, -1
    s_nop 4
    s_mov_b32 s66, 0x200000
    v_cvt_pk_bf16_f32 v32, v88, v89
    v_cvt_pk_bf16_f32 v33, v90, v91
    v_cvt_pk_bf16_f32 v34, v92, v93
    v_cvt_pk_bf16_f32 v35, v94, v95
    v_cvt_pk_bf16_f32 v36, v96, v97
    v_cvt_pk_bf16_f32 v37, v98, v99
    v_cvt_pk_bf16_f32 v38, v100, v101
    v_cvt_pk_bf16_f32 v39, v102, v103
    s_cmp_eq_u32 s36, 0
    s_cbranch_scc1 L_sequential_preLN__sliding_local_dilated__mixer_s_mlp__prompt_kernel_alt_182
    buffer_store_dwordx4 v[32:35], v85, s[48:51], s66 offen offset:0
    buffer_store_dwordx4 v[36:39], v85, s[48:51], s66 offen offset:1024
L_sequential_preLN__sliding_local_dilated__mixer_s_mlp__prompt_kernel_altb_183:
    v_mov_b32 v136, 0
    v_mov_b32 v137, 0
    v_dot2c_f32_bf16 v136, v32, v16
    v_dot2c_f32_bf16 v137, v32, v32
    v_dot2c_f32_bf16 v136, v33, v16
    v_dot2c_f32_bf16 v137, v33, v33
    v_dot2c_f32_bf16 v136, v34, v16
    v_dot2c_f32_bf16 v137, v34, v34
    v_dot2c_f32_bf16 v136, v35, v16
    v_dot2c_f32_bf16 v137, v35, v35
    v_dot2c_f32_bf16 v136, v36, v16
    v_dot2c_f32_bf16 v137, v36, v36
    v_dot2c_f32_bf16 v136, v37, v16
    v_dot2c_f32_bf16 v137, v37, v37
    v_dot2c_f32_bf16 v136, v38, v16
    v_dot2c_f32_bf16 v137, v38, v38
    v_dot2c_f32_bf16 v136, v39, v16
    v_dot2c_f32_bf16 v137, v39, v39
    s_nop 2
    v_permlane32_swap_b32 v136, v137
    s_nop 0
    v_add_f32 v136, v136, v137
    v_mov_b32 v138, v136
    s_nop 1
    v_permlane16_swap_b32 v136, v138
    s_nop 0
    v_add_f32 v136, v136, v138
    s_cmp_eq_u32 s36, 0
    s_cbranch_scc1 L_sequential_preLN__sliding_local_dilated__mixer_s_mlp__prompt_kernel_alt_184
    buffer_store_dword v136, v78, s[48:51], 0 offen
L_sequential_preLN__sliding_local_dilated__mixer_s_mlp__prompt_kernel_altb_185:
    s_waitcnt vmcnt(0)
    s_cmp_eq_u32 s36, 0
    s_cbranch_scc1 L_sequential_preLN__sliding_local_dilated__mixer_s_mlp__prompt_kernel_alt_186
    s_mov_b64 exec, 1
    buffer_store_dword v6, v7, s[48:51], s69 offen
    s_mov_b64 exec, -1
L_sequential_preLN__sliding_local_dilated__mixer_s_mlp__prompt_kernel_altb_187:
    s_cmp_lt_u32 s52, 13
    s_cbranch_scc1 L_sequential_preLN__sliding_local_dilated__mixer_s_mlp__prompt_kernel_lws_189
L_sequential_preLN__sliding_local_dilated__mixer_s_mlp__prompt_kernel_lwb_188:
    ds_read_b64_tr_b16 a[48:49], v27 offset:0
    ds_read_b64_tr_b16 a[50:51], v27 offset:2048
    ds_read_b64_tr_b16 a[52:53], v28 offset:0
    ds_read_b64_tr_b16 a[54:55], v28 offset:2048
    ds_read_b64_tr_b16 a[56:57], v29 offset:0
    ds_read_b64_tr_b16 a[58:59], v29 offset:2048
    ds_read_b64_tr_b16 a[60:61], v30 offset:0
    ds_read_b64_tr_b16 a[62:63], v30 offset:2048
    ds_read_b64_tr_b16 a[64:65], v27 offset:4096
    ds_read_b64_tr_b16 a[66:67], v27 offset:6144
    ds_read_b64_tr_b16 a[68:69], v28 offset:4096
    ds_read_b64_tr_b16 a[70:71], v28 offset:6144
    ds_read_b64_tr_b16 a[72:73], v29 offset:4096
    ds_read_b64_tr_b16 a[74:75], v29 offset:6144
    ds_read_b64_tr_b16 a[76:77], v30 offset:4096
    ds_read_b64_tr_b16 a[78:79], v30 offset:6144
    ds_read_b64_tr_b16 a[80:81], v27 offset:8192
    ds_read_b64_tr_b16 a[82:83], v27 offset:10240
    ds_read_b64_tr_b16 a[84:85], v28 offset:8192
    ds_read_b64_tr_b16 a[86:87], v28 offset:10240
    ds_read_b64_tr_b16 a[88:89], v29 offset:8192
    ds_read_b64_tr_b16 a[90:91], v29 offset:10240
    ds_read_b64_tr_b16 a[92:93], v30 offset:8192
    ds_read_b64_tr_b16 a[94:95], v30 offset:10240
    s_mov_b32 s5, 0
    v_add_u32 v65, 0xc000, v27
    v_add_u32 v66, 0xc000, v28
    v_add_u32 v67, 0xc000, v29
    v_add_u32 v68, 0xc000, v30
    v_add_u32 v69, 0x18000, v27
    v_add_u32 v70, 0x18000, v28
    v_add_u32 v71, 0x18000, v29
    v_add_u32 v72, 0x18000, v30
    v_add_u32 v8, -1, v84
    v_ashrrev_i32 v9, 4, v8
    v_lshlrev_b32 v9, 14, v9
    v_lshl_add_u32 v9, v3, 8, v9
    v_and_b32 v10, 15, v8
    v_lshl_add_u32 v9, v10, 4, v9
    v_add_u32 v9, s67, v9
    v_ashrrev_i32 v10, 7, v8
    v_lshlrev_b32 v11, 15, v10
    v_lshl_add_u32 v11, v3, 5, v11
    v_and_b32 v8, 1, v8
    v_cmp_ne_u32 vcc, s29, v10
    v_lshl_add_u32 v11, v8, 4, v11
    v_add_u32 v11, 0xf04000, v11
    v_cndmask_b32 v9, v9, v11, vcc
    v_cmp_lt_u32 vcc, 15, v10
    v_add_u32 v9, 0, v9
    v_mov_b32 v11, 0x40000000
    v_cndmask_b32 v73, v9, v11, vcc
    v_add_u32 v8, 1, v84
    v_ashrrev_i32 v9, 4, v8
    v_lshlrev_b32 v9, 14, v9
    v_lshl_add_u32 v9, v3, 8, v9
    v_and_b32 v10, 15, v8
    v_lshl_add_u32 v9, v10, 4, v9
    v_add_u32 v9, s67, v9
    v_ashrrev_i32 v10, 7, v8
    v_lshlrev_b32 v11, 15, v10
    v_lshl_add_u32 v11, v3, 5, v11
    v_and_b32 v8, 1, v8
    v_cmp_ne_u32 vcc, s29, v10
    v_lshl_add_u32 v11, v8, 4, v11
    v_add_u32 v11, 0xf00000, v11
    v_cndmask_b32 v9, v9, v11, vcc
    v_cmp_lt_u32 vcc, 15, v10
    v_add_u32 v9, 4096, v9
    v_mov_b32 v11, 0x40000000
    v_cndmask_b32 v74, v9, v11, vcc
    v_add_u32 v8, -2, v84
    v_ashrrev_i32 v9, 4, v8
    v_lshlrev_b32 v9, 14, v9
    v_lshl_add_u32 v9, v3, 8, v9
    v_and_b32 v10, 15, v8
    v_lshl_add_u32 v9, v10, 4, v9
    v_add_u32 v9, s67, v9
    v_ashrrev_i32 v10, 7, v8
    v_lshlrev_b32 v11, 15, v10
    v_lshl_add_u32 v11, v3, 5, v11
    v_and_b32 v8, 1, v8
    v_cmp_ne_u32 vcc, s29, v10
    v_lshl_add_u32 v11, v8, 4, v11
    v_add_u32 v11, 0xf04000, v11
    v_cndmask_b32 v9, v9, v11, vcc
    v_cmp_lt_u32 vcc, 15, v10
    v_add_u32 v9, 8192, v9
    v_mov_b32 v11, 0x40000000
    v_cndmask_b32 v75, v9, v11, vcc
    v_add_u32 v8, 2, v84
    v_ashrrev_i32 v9, 4, v8
    v_lshlrev_b32 v9, 14, v9
    v_lshl_add_u32 v9, v3, 8, v9
    v_and_b32 v10, 15, v8
    v_lshl_add_u32 v9, v10, 4, v9
    v_add_u32 v9, s67, v9
    v_ashrrev_i32 v10, 7, v8
    v_lshlrev_b32 v11, 15, v10
    v_lshl_add_u32 v11, v3, 5, v11
    v_and_b32 v8, 1, v8
    v_cmp_ne_u32 vcc, s29, v10
    v_lshl_add_u32 v11, v8, 4, v11
    v_add_u32 v11, 0xf00000, v11
    v_cndmask_b32 v9, v9, v11, vcc
    v_cmp_lt_u32 vcc, 15, v10
    v_add_u32 v9, 12288, v9
    v_mov_b32 v11, 0x40000000
    v_cndmask_b32 v76, v9, v11, vcc
    s_lshl_b32 s33, s64, 7
    s_add_u32 s33, s33, 0xfd8000
    s_lshl_b32 s34, s29, 8
    s_add_u32 s34, s34, 0xfe4000
    s_sub_u32 s6, s33, 128
    s_add_u32 s7, s33, 128
    s_and_b32 s8, s64, 7
    s_sub_u32 s9, s34, 128
    s_cmp_eq_u32 s8, 0
    s_cselect_b32 s6, s9, s6
    s_add_u32 s9, s34, 256
    s_cmp_eq_u32 s8, 7
    s_cselect_b32 s7, s9, s7
    v_mov_b32 v8, s33
    v_mov_b32 v9, s6
    v_cmp_gt_u32 vcc, 8, v1
    v_mov_b32 v10, s7
    v_and_b32 v11, 7, v1
    v_cndmask_b32 v8, v8, v9, vcc
    v_cmp_lt_u32 vcc, 15, v1
    s_nop 1
    v_cndmask_b32 v8, v8, v10, vcc
    v_lshl_add_u32 v64, v11, 2, v8
    s_mov_b32 s4, 0xccff33
    s_cmp_eq_u32 s64, 0
    s_cselect_b32 s4, 0xccff00, s4
    s_cmp_eq_u32 s64, 127
    s_cselect_b32 s4, 0x00ff33, s4
    s_branch L_sequential_preLN__sliding_local_dilated__mixer_s_mlp__prompt_kernel_isl_191
L_sequential_preLN__sliding_local_dilated__mixer_s_mlp__prompt_kernel_lws_177:
    s_movk_i32 s42, 10
    s_call_b64 s[44:45], L_wait_c_0_52_0
    s_branch L_sequential_preLN__sliding_local_dilated__mixer_s_mlp__prompt_kernel_lwb_176
L_sequential_preLN__sliding_local_dilated__mixer_s_mlp__prompt_kernel_lws_179:
    s_movk_i32 s42, 11
    s_call_b64 s[44:45], L_wait_c_0_52_0
    s_branch L_sequential_preLN__sliding_local_dilated__mixer_s_mlp__prompt_kernel_lwb_178
L_sequential_preLN__sliding_local_dilated__mixer_s_mlp__prompt_kernel_lws_181:
    s_movk_i32 s42, 12
    s_call_b64 s[44:45], L_wait_c_0_52_0
    s_branch L_sequential_preLN__sliding_local_dilated__mixer_s_mlp__prompt_kernel_lwb_180
L_sequential_preLN__sliding_local_dilated__mixer_s_mlp__prompt_kernel_alt_182:
    buffer_store_dwordx4 v[32:35], v85, s[48:51], s66 offen offset:0 sc1
    buffer_store_dwordx4 v[36:39], v85, s[48:51], s66 offen offset:1024 sc1
    s_branch L_sequential_preLN__sliding_local_dilated__mixer_s_mlp__prompt_kernel_altb_183
L_sequential_preLN__sliding_local_dilated__mixer_s_mlp__prompt_kernel_alt_184:
    buffer_store_dword v136, v78, s[48:51], 0 offen sc1
    s_branch L_sequential_preLN__sliding_local_dilated__mixer_s_mlp__prompt_kernel_altb_185
L_sequential_preLN__sliding_local_dilated__mixer_s_mlp__prompt_kernel_alt_186:
    s_mov_b64 exec, 1
    buffer_store_dword v6, v7, s[48:51], s69 offen sc1
    s_mov_b64 exec, -1
    s_branch L_sequential_preLN__sliding_local_dilated__mixer_s_mlp__prompt_kernel_altb_187
L_sequential_preLN__sliding_local_dilated__mixer_s_mlp__prompt_kernel_lws_189:
    s_movk_i32 s42, 13
    s_call_b64 s[44:45], L_wait_c_0_52_0
    s_branch L_sequential_preLN__sliding_local_dilated__mixer_s_mlp__prompt_kernel_lwb_188
L_sequential_preLN__sliding_local_dilated__mixer_s_mlp__prompt_kernel_psub_190:
    s_mov_b32 s27, 0
    s_mov_b64 exec, s[12:13]
L_sequential_preLN__sliding_local_dilated__mixer_s_mlp__prompt_kernel_psub_190_t:
    buffer_load_dword v21, v48, s[48:51], 0 offen sc1
    s_waitcnt vmcnt(0)
    v_cmp_eq_u32 vcc, s35, v21
    s_nop 0
    s_or_b32 s70, vcc_lo, s71
    s_andn2_b32 s33, s42, s70
    s_cbranch_scc0 L_sequential_preLN__sliding_local_dilated__mixer_s_mlp__prompt_kernel_psub_190_o
    s_sleep 2
    s_add_u32 s27, s27, 1
    s_cmp_lt_u32 s27, 0x40000
    s_cbranch_scc1 L_sequential_preLN__sliding_local_dilated__mixer_s_mlp__prompt_kernel_psub_190_t
L_sequential_preLN__sliding_local_dilated__mixer_s_mlp__prompt_kernel_psub_190_o:
    s_mov_b64 exec, -1
    s_setpc_b64 s[44:45]
L_sequential_preLN__sliding_local_dilated__mixer_s_mlp__prompt_kernel_isl_191:
    s_mov_b32 s27, 0
    s_mov_b64 exec, s[12:13]
L_sequential_preLN__sliding_local_dilated__mixer_s_mlp__prompt_kernel_gpoll_192:
    buffer_load_dword v8, v48, s[48:51], 0 offen sc1
    s_waitcnt vmcnt(0)
    v_cmp_ne_u32 vcc, s35, v8
    s_nop 0
    s_cmp_eq_u64 vcc, 0
    s_cbranch_scc1 L_sequential_preLN__sliding_local_dilated__mixer_s_mlp__prompt_kernel_gok_193
    s_sleep 2
    s_add_u32 s27, s27, 1
    s_cmp_lt_u32 s27, 0x40000
    s_cbranch_scc1 L_sequential_preLN__sliding_local_dilated__mixer_s_mlp__prompt_kernel_gpoll_192
L_sequential_preLN__sliding_local_dilated__mixer_s_mlp__prompt_kernel_gok_193:
    s_mov_b64 exec, -1
    s_mov_b32 s66, 0x0
    buffer_load_dwordx4 a[0:3], v53, s[48:51], s66 offen offset:0 sc1
    buffer_load_dwordx4 a[4:7], v53, s[48:51], s66 offen offset:1024 sc1
    buffer_load_dwordx4 a[8:11], v53, s[48:51], s66 offen offset:2048 sc1
    buffer_load_dwordx4 a[12:15], v53, s[48:51], s66 offen offset:3072 sc1
    s_mov_b32 s66, 0x1000
    buffer_load_dwordx4 a[16:19], v53, s[48:51], s66 offen offset:0 sc1
    buffer_load_dwordx4 a[20:23], v53, s[48:51], s66 offen offset:1024 sc1
    buffer_load_dwordx4 a[24:27], v53, s[48:51], s66 offen offset:2048 sc1
    buffer_load_dwordx4 a[28:31], v53, s[48:51], s66 offen offset:3072 sc1
    s_mov_b32 s66, 0x2000
    buffer_load_dwordx4 a[32:35], v53, s[48:51], s66 offen offset:0 sc1
    s_add_u32 s69, s65, 0xfd8000
    s_waitcnt vmcnt(8) lgkmcnt(15)
    v_mfma_f32_16x16x32_bf16 v[104:107], a[48:51], a[0:3], 0
    ds_read_b64_tr_b16 a[48:49], v27 offset:12288
    ds_read_b64_tr_b16 a[50:51], v27 offset:14336
    v_mfma_f32_16x16x32_bf16 v[108:111], a[52:55], a[0:3], 0
    ds_read_b64_tr_b16 a[52:53], v28 offset:12288
    ds_read_b64_tr_b16 a[54:55], v28 offset:14336
    v_mfma_f32_16x16x32_bf16 v[112:115], a[56:59], a[0:3], 0
    ds_read_b64_tr_b16 a[56:57], v29 offset:12288
    ds_read_b64_tr_b16 a[58:59], v29 offset:14336
    v_mfma_f32_16x16x32_bf16 v[116:119], a[60:63], a[0:3], 0
    ds_read_b64_tr_b16 a[60:61], v30 offset:12288
    ds_read_b64_tr_b16 a[62:63], v30 offset:14336
    buffer_load_dwordx4 a[36:39], v53, s[48:51], s66 offen offset:1024 sc1
    s_waitcnt vmcnt(8) lgkmcnt(15)
    v_mfma_f32_16x16x32_bf16 v[104:107], a[64:67], a[4:7], v[104:107]
    s_cmp_lt_u32 s52, 14
    s_cbranch_scc1 L_sequential_preLN__sliding_local_dilated__mixer_s_mlp__prompt_kernel_lws_195
L_sequential_preLN__sliding_local_dilated__mixer_s_mlp__prompt_kernel_lwb_194:
    ds_read_b64_tr_b16 a[64:65], v27 offset:16384
    ds_read_b64_tr_b16 a[66:67], v27 offset:18432
    v_mfma_f32_16x16x32_bf16 v[108:111], a[68:71], a[4:7], v[108:111]
    ds_read_b64_tr_b16 a[68:69], v28 offset:16384
    ds_read_b64_tr_b16 a[70:71], v28 offset:18432
    v_mfma_f32_16x16x32_bf16 v[112:115], a[72:75], a[4:7], v[112:115]
    ds_read_b64_tr_b16 a[72:73], v29 offset:16384
    ds_read_b64_tr_b16 a[74:75], v29 offset:18432
    v_mfma_f32_16x16x32_bf16 v[116:119], a[76:79], a[4:7], v[116:119]
    ds_read_b64_tr_b16 a[76:77], v30 offset:16384
    ds_read_b64_tr_b16 a[78:79], v30 offset:18432
    buffer_load_dwordx4 a[40:43], v53, s[48:51], s66 offen offset:2048 sc1
    s_waitcnt vmcnt(8) lgkmcnt(15)
    v_mfma_f32_16x16x32_bf16 v[104:107], a[80:83], a[8:11], v[104:107]
    ds_read_b64_tr_b16 a[80:81], v27 offset:20480
    ds_read_b64_tr_b16 a[82:83], v27 offset:22528
    v_mfma_f32_16x16x32_bf16 v[108:111], a[84:87], a[8:11], v[108:111]
    ds_read_b64_tr_b16 a[84:85], v28 offset:20480
    ds_read_b64_tr_b16 a[86:87], v28 offset:22528
    v_mfma_f32_16x16x32_bf16 v[112:115], a[88:91], a[8:11], v[112:115]
    ds_read_b64_tr_b16 a[88:89], v29 offset:20480
    ds_read_b64_tr_b16 a[90:91], v29 offset:22528
    v_mfma_f32_16x16x32_bf16 v[116:119], a[92:95], a[8:11], v[116:119]
    ds_read_b64_tr_b16 a[92:93], v30 offset:20480
    ds_read_b64_tr_b16 a[94:95], v30 offset:22528
    buffer_load_dwordx4 a[44:47], v53, s[48:51], s66 offen offset:3072 sc1
    s_waitcnt vmcnt(8) lgkmcnt(15)
    v_mfma_f32_16x16x32_bf16 v[104:107], a[48:51], a[12:15], v[104:107]
    ds_read_b64_tr_b16 a[48:49], v27 offset:24576
    ds_read_b64_tr_b16 a[50:51], v27 offset:26624
    v_mfma_f32_16x16x32_bf16 v[108:111], a[52:55], a[12:15], v[108:111]
    ds_read_b64_tr_b16 a[52:53], v28 offset:24576
    ds_read_b64_tr_b16 a[54:55], v28 offset:26624
    v_mfma_f32_16x16x32_bf16 v[112:115], a[56:59], a[12:15], v[112:115]
    ds_read_b64_tr_b16 a[56:57], v29 offset:24576
    ds_read_b64_tr_b16 a[58:59], v29 offset:26624
    v_mfma_f32_16x16x32_bf16 v[116:119], a[60:63], a[12:15], v[116:119]
    ds_read_b64_tr_b16 a[60:61], v30 offset:24576
    ds_read_b64_tr_b16 a[62:63], v30 offset:26624
    s_mov_b32 s66, 0x3000
    buffer_load_dwordx4 a[0:3], v53, s[48:51], s66 offen offset:0 sc1
    s_waitcnt vmcnt(8) lgkmcnt(15)
    v_mfma_f32_16x16x32_bf16 v[104:107], a[64:67], a[16:19], v[104:107]
    ds_read_b64_tr_b16 a[64:65], v27 offset:28672
    ds_read_b64_tr_b16 a[66:67], v27 offset:30720
    v_mfma_f32_16x16x32_bf16 v[108:111], a[68:71], a[16:19], v[108:111]
    ds_read_b64_tr_b16 a[68:69], v28 offset:28672
    ds_read_b64_tr_b16 a[70:71], v28 offset:30720
    v_mfma_f32_16x16x32_bf16 v[112:115], a[72:75], a[16:19], v[112:115]
    ds_read_b64_tr_b16 a[72:73], v29 offset:28672
    ds_read_b64_tr_b16 a[74:75], v29 offset:30720
    v_mfma_f32_16x16x32_bf16 v[116:119], a[76:79], a[16:19], v[116:119]
    ds_read_b64_tr_b16 a[76:77], v30 offset:28672
    ds_read_b64_tr_b16 a[78:79], v30 offset:30720
    buffer_load_dwordx4 a[4:7], v53, s[48:51], s66 offen offset:1024 sc1
    s_waitcnt vmcnt(8) lgkmcnt(15)
    v_mfma_f32_16x16x32_bf16 v[104:107], a[80:83], a[20:23], v[104:107]
    s_cmp_lt_u32 s52, 15
    s_cbranch_scc1 L_sequential_preLN__sliding_local_dilated__mixer_s_mlp__prompt_kernel_lws_197
L_sequential_preLN__sliding_local_dilated__mixer_s_mlp__prompt_kernel_lwb_196:
    ds_read_b64_tr_b16 a[80:81], v27 offset:32768
    ds_read_b64_tr_b16 a[82:83], v27 offset:34816
    v_mfma_f32_16x16x32_bf16 v[108:111], a[84:87], a[20:23], v[108:111]
    ds_read_b64_tr_b16 a[84:85], v28 offset:32768
    ds_read_b64_tr_b16 a[86:87], v28 offset:34816
    v_mfma_f32_16x16x32_bf16 v[112:115], a[88:91], a[20:23], v[112:115]
    ds_read_b64_tr_b16 a[88:89], v29 offset:32768
    ds_read_b64_tr_b16 a[90:91], v29 offset:34816
    v_mfma_f32_16x16x32_bf16 v[116:119], a[92:95], a[20:23], v[116:119]
    ds_read_b64_tr_b16 a[92:93], v30 offset:32768
    ds_read_b64_tr_b16 a[94:95], v30 offset:34816
    buffer_load_dwordx4 a[8:11], v53, s[48:51], s66 offen offset:2048 sc1
    s_waitcnt vmcnt(8) lgkmcnt(15)
    v_mfma_f32_16x16x32_bf16 v[104:107], a[48:51], a[24:27], v[104:107]
    ds_read_b64_tr_b16 a[48:49], v27 offset:36864
    ds_read_b64_tr_b16 a[50:51], v27 offset:38912
    v_mfma_f32_16x16x32_bf16 v[108:111], a[52:55], a[24:27], v[108:111]
    ds_read_b64_tr_b16 a[52:53], v28 offset:36864
    ds_read_b64_tr_b16 a[54:55], v28 offset:38912
    v_mfma_f32_16x16x32_bf16 v[112:115], a[56:59], a[24:27], v[112:115]
    ds_read_b64_tr_b16 a[56:57], v29 offset:36864
    ds_read_b64_tr_b16 a[58:59], v29 offset:38912
    v_mfma_f32_16x16x32_bf16 v[116:119], a[60:63], a[24:27], v[116:119]
    ds_read_b64_tr_b16 a[60:61], v30 offset:36864
    ds_read_b64_tr_b16 a[62:63], v30 offset:38912
    buffer_load_dwordx4 a[12:15], v53, s[48:51], s66 offen offset:3072 sc1
    s_waitcnt vmcnt(8) lgkmcnt(15)
    v_mfma_f32_16x16x32_bf16 v[104:107], a[64:67], a[28:31], v[104:107]
    ds_read_b64_tr_b16 a[64:65], v27 offset:40960
    ds_read_b64_tr_b16 a[66:67], v27 offset:43008
    v_mfma_f32_16x16x32_bf16 v[108:111], a[68:71], a[28:31], v[108:111]
    ds_read_b64_tr_b16 a[68:69], v28 offset:40960
    ds_read_b64_tr_b16 a[70:71], v28 offset:43008
    v_mfma_f32_16x16x32_bf16 v[112:115], a[72:75], a[28:31], v[112:115]
    ds_read_b64_tr_b16 a[72:73], v29 offset:40960
    ds_read_b64_tr_b16 a[74:75], v29 offset:43008
    v_mfma_f32_16x16x32_bf16 v[116:119], a[76:79], a[28:31], v[116:119]
    ds_read_b64_tr_b16 a[76:77], v30 offset:40960
    ds_read_b64_tr_b16 a[78:79], v30 offset:43008
    v_mov_b32 v12, 14
    s_mov_b64 exec, 1
    ds_max_u32 v5, v12 offset:16
    s_mov_b64 exec, -1
    s_mov_b32 s66, 0xf80000
    buffer_load_dwordx2 v[136:137], v54, s[48:51], s66 offen sc1
    s_waitcnt vmcnt(8) lgkmcnt(15)
    v_mfma_f32_16x16x32_bf16 v[104:107], a[80:83], a[32:35], v[104:107]
    ds_read_b64_tr_b16 a[80:81], v27 offset:45056
    ds_read_b64_tr_b16 a[82:83], v27 offset:47104
    v_mfma_f32_16x16x32_bf16 v[108:111], a[84:87], a[32:35], v[108:111]
    ds_read_b64_tr_b16 a[84:85], v28 offset:45056
    ds_read_b64_tr_b16 a[86:87], v28 offset:47104
    v_mfma_f32_16x16x32_bf16 v[112:115], a[88:91], a[32:35], v[112:115]
    ds_read_b64_tr_b16 a[88:89], v29 offset:45056
    ds_read_b64_tr_b16 a[90:91], v29 offset:47104
    v_mfma_f32_16x16x32_bf16 v[116:119], a[92:95], a[32:35], v[116:119]
    ds_read_b64_tr_b16 a[92:93], v30 offset:45056
    ds_read_b64_tr_b16 a[94:95], v30 offset:47104
    s_mov_b32 s66, 0xf84000
    buffer_load_dwordx2 v[138:139], v54, s[48:51], s66 offen sc1
    s_waitcnt vmcnt(8) lgkmcnt(15)
    v_mfma_f32_16x16x32_bf16 v[104:107], a[48:51], a[36:39], v[104:107]
    s_cmp_lt_u32 s52, 16
    s_cbranch_scc1 L_sequential_preLN__sliding_local_dilated__mixer_s_mlp__prompt_kernel_lws_199
L_sequential_preLN__sliding_local_dilated__mixer_s_mlp__prompt_kernel_lwb_198:
    ds_read_b64_tr_b16 a[48:49], v49 offset:0
    ds_read_b64_tr_b16 a[50:51], v49 offset:2048
    v_mfma_f32_16x16x32_bf16 v[108:111], a[52:55], a[36:39], v[108:111]
    ds_read_b64_tr_b16 a[52:53], v50 offset:0
    ds_read_b64_tr_b16 a[54:55], v50 offset:2048
    v_mfma_f32_16x16x32_bf16 v[112:115], a[56:59], a[36:39], v[112:115]
    ds_read_b64_tr_b16 a[56:57], v51 offset:0
    ds_read_b64_tr_b16 a[58:59], v51 offset:2048
    v_mfma_f32_16x16x32_bf16 v[116:119], a[60:63], a[36:39], v[116:119]
    ds_read_b64_tr_b16 a[60:61], v52 offset:0
    ds_read_b64_tr_b16 a[62:63], v52 offset:2048
    s_waitcnt vmcnt(7) lgkmcnt(15)
    v_mfma_f32_16x16x32_bf16 v[104:107], a[64:67], a[40:43], v[104:107]
    ds_read_b64_tr_b16 a[64:65], v49 offset:4096
    ds_read_b64_tr_b16 a[66:67], v49 offset:6144
    v_mfma_f32_16x16x32_bf16 v[108:111], a[68:71], a[40:43], v[108:111]
    ds_read_b64_tr_b16 a[68:69], v50 offset:4096
    ds_read_b64_tr_b16 a[70:71], v50 offset:6144
    v_mfma_f32_16x16x32_bf16 v[112:115], a[72:75], a[40:43], v[112:115]
    ds_read_b64_tr_b16 a[72:73], v51 offset:4096
    ds_read_b64_tr_b16 a[74:75], v51 offset:6144
    v_mfma_f32_16x16x32_bf16 v[116:119], a[76:79], a[40:43], v[116:119]
    ds_read_b64_tr_b16 a[76:77], v52 offset:4096
    ds_read_b64_tr_b16 a[78:79], v52 offset:6144
    s_waitcnt vmcnt(6) lgkmcnt(15)
    v_mfma_f32_16x16x32_bf16 v[104:107], a[80:83], a[44:47], v[104:107]
    ds_read_b64_tr_b16 a[80:81], v49 offset:8192
    ds_read_b64_tr_b16 a[82:83], v49 offset:10240
    v_mfma_f32_16x16x32_bf16 v[108:111], a[84:87], a[44:47], v[108:111]
    ds_read_b64_tr_b16 a[84:85], v50 offset:8192
    ds_read_b64_tr_b16 a[86:87], v50 offset:10240
    v_mfma_f32_16x16x32_bf16 v[112:115], a[88:91], a[44:47], v[112:115]
    ds_read_b64_tr_b16 a[88:89], v51 offset:8192
    ds_read_b64_tr_b16 a[90:91], v51 offset:10240
    v_mfma_f32_16x16x32_bf16 v[116:119], a[92:95], a[44:47], v[116:119]
    ds_read_b64_tr_b16 a[92:93], v52 offset:8192
    ds_read_b64_tr_b16 a[94:95], v52 offset:10240
    s_waitcnt vmcnt(5) lgkmcnt(15)
    v_mfma_f32_16x16x32_bf16 v[104:107], a[48:51], a[0:3], v[104:107]
    ds_read_b64_tr_b16 a[48:49], v49 offset:12288
    ds_read_b64_tr_b16 a[50:51], v49 offset:14336
    v_mfma_f32_16x16x32_bf16 v[108:111], a[52:55], a[0:3], v[108:111]
    ds_read_b64_tr_b16 a[52:53], v50 offset:12288
    ds_read_b64_tr_b16 a[54:55], v50 offset:14336
    v_mfma_f32_16x16x32_bf16 v[112:115], a[56:59], a[0:3], v[112:115]
    ds_read_b64_tr_b16 a[56:57], v51 offset:12288
    ds_read_b64_tr_b16 a[58:59], v51 offset:14336
    v_mfma_f32_16x16x32_bf16 v[116:119], a[60:63], a[0:3], v[116:119]
    ds_read_b64_tr_b16 a[60:61], v52 offset:12288
    ds_read_b64_tr_b16 a[62:63], v52 offset:14336
    s_waitcnt vmcnt(4) lgkmcnt(15)
    v_mfma_f32_16x16x32_bf16 v[104:107], a[64:67], a[4:7], v[104:107]
    v_mfma_f32_16x16x32_bf16 v[108:111], a[68:71], a[4:7], v[108:111]
    v_mfma_f32_16x16x32_bf16 v[112:115], a[72:75], a[4:7], v[112:115]
    v_mfma_f32_16x16x32_bf16 v[116:119], a[76:79], a[4:7], v[116:119]
    s_cmp_lt_u32 s53, 2
    s_cbranch_scc1 L_sequential_preLN__sliding_local_dilated__mixer_s_mlp__prompt_kernel_lws_201
L_sequential_preLN__sliding_local_dilated__mixer_s_mlp__prompt_kernel_lwb_200:
    ds_read_b128 v[120:123], v26 offset:512
    ds_read_b128 v[124:127], v26 offset:576
    ds_read_b128 v[128:131], v26 offset:640
    ds_read_b128 v[132:135], v26 offset:704
    s_waitcnt vmcnt(0)
    v_pk_add_f32 v[136:137], v[136:137], v[138:139]
    v_mov_b32 v138, v136
    v_mov_b32 v139, v137
    s_nop 0
    v_permlane32_swap_b32 v136, v138
    v_permlane32_swap_b32 v137, v139
    s_nop 0
    v_pk_add_f32 v[136:137], v[136:137], v[138:139]
    v_mov_b32 v138, v136
    v_mov_b32 v139, v137
    s_nop 0
    v_permlane16_swap_b32 v136, v138
    v_permlane16_swap_b32 v137, v139
    s_nop 0
    v_pk_add_f32 v[136:137], v[136:137], v[138:139]
    v_mul_f32 v80, 0xbb000000, v136
    v_mul_f32 v140, 0x3b000000, v137
    v_fma_f32 v140, -v80, v80, v140
    v_max_f32 v140, 0, v140
    v_add_f32 v82, 0x3727c5ac, v140
    v_rsq_f32 v82, v82
    s_nop 0
    v_mul_f32 v140, v140, v82
    v_fmaak_f32 v140, v140, v82, 0x3727c5ac
    v_rsq_f32 v140, v140
    s_nop 0
    v_mul_f32 v138, v82, v140
    v_rcp_f32 v144, v138
    v_mul_f32 v142, v138, v138
    v_mul_f32 v143, 0xc0135761, v138
    v_mul_f32 v142, v142, v143
    v_mul_f32 v142, 0x3d372713, v142
    s_waitcnt vmcnt(3) lgkmcnt(12)
    v_mfma_f32_16x16x32_bf16 v[104:107], a[80:83], a[8:11], v[104:107]
    v_mfma_f32_16x16x32_bf16 v[108:111], a[84:87], a[8:11], v[108:111]
    v_mfma_f32_16x16x32_bf16 v[112:115], a[88:91], a[8:11], v[112:115]
    v_mfma_f32_16x16x32_bf16 v[116:119], a[92:95], a[8:11], v[116:119]
    s_waitcnt vmcnt(2) lgkmcnt(4)
    v_mfma_f32_16x16x32_bf16 v[104:107], a[48:51], a[12:15], v[104:107]
    v_mfma_f32_16x16x32_bf16 v[108:111], a[52:55], a[12:15], v[108:111]
    v_mfma_f32_16x16x32_bf16 v[112:115], a[56:59], a[12:15], v[112:115]
    v_mfma_f32_16x16x32_bf16 v[116:119], a[60:63], a[12:15], v[116:119]
    v_mov_b32 v12, 16
    s_mov_b64 exec, 1
    ds_max_u32 v5, v12 offset:16
    s_mov_b64 exec, -1
    s_waitcnt lgkmcnt(0)
    s_nop 4
    v_pk_fma_f32 v[104:105], v[120:121], v[80:81], v[104:105] op_sel_hi:[1,0,1]
    v_pk_fma_f32 v[106:107], v[122:123], v[80:81], v[106:107] op_sel_hi:[1,0,1]
    v_pk_fma_f32 v[108:109], v[124:125], v[80:81], v[108:109] op_sel_hi:[1,0,1]
    v_pk_fma_f32 v[110:111], v[126:127], v[80:81], v[110:111] op_sel_hi:[1,0,1]
    v_pk_fma_f32 v[112:113], v[128:129], v[80:81], v[112:113] op_sel_hi:[1,0,1]
    v_pk_fma_f32 v[114:115], v[130:131], v[80:81], v[114:115] op_sel_hi:[1,0,1]
    v_pk_fma_f32 v[116:117], v[132:133], v[80:81], v[116:117] op_sel_hi:[1,0,1]
    v_pk_fma_f32 v[118:119], v[134:135], v[80:81], v[118:119] op_sel_hi:[1,0,1]
    v_pk_mul_f32 v[120:121], v[104:105], v[104:105]
    v_pk_mul_f32 v[122:123], v[106:107], v[106:107]
    v_pk_mul_f32 v[124:125], v[108:109], v[108:109]
    v_pk_mul_f32 v[126:127], v[110:111], v[110:111]
    v_pk_mul_f32 v[128:129], v[112:113], v[112:113]
    v_pk_mul_f32 v[130:131], v[114:115], v[114:115]
    v_pk_mul_f32 v[132:133], v[116:117], v[116:117]
    v_pk_mul_f32 v[134:135], v[118:119], v[118:119]
    v_pk_fma_f32 v[120:121], v[120:121], v[142:143], v[142:143] op_sel:[0,0,1] op_sel_hi:[1,0,1]
    v_pk_fma_f32 v[122:123], v[122:123], v[142:143], v[142:143] op_sel:[0,0,1] op_sel_hi:[1,0,1]
    v_pk_fma_f32 v[124:125], v[124:125], v[142:143], v[142:143] op_sel:[0,0,1] op_sel_hi:[1,0,1]
    v_pk_fma_f32 v[126:127], v[126:127], v[142:143], v[142:143] op_sel:[0,0,1] op_sel_hi:[1,0,1]
    v_pk_fma_f32 v[128:129], v[128:129], v[142:143], v[142:143] op_sel:[0,0,1] op_sel_hi:[1,0,1]
    v_pk_fma_f32 v[130:131], v[130:131], v[142:143], v[142:143] op_sel:[0,0,1] op_sel_hi:[1,0,1]
    v_pk_fma_f32 v[132:133], v[132:133], v[142:143], v[142:143] op_sel:[0,0,1] op_sel_hi:[1,0,1]
    v_pk_fma_f32 v[134:135], v[134:135], v[142:143], v[142:143] op_sel:[0,0,1] op_sel_hi:[1,0,1]
    v_pk_mul_f32 v[120:121], v[120:121], v[104:105]
    v_pk_mul_f32 v[122:123], v[122:123], v[106:107]
    v_pk_mul_f32 v[124:125], v[124:125], v[108:109]
    v_pk_mul_f32 v[126:127], v[126:127], v[110:111]
    v_pk_mul_f32 v[128:129], v[128:129], v[112:113]
    v_pk_mul_f32 v[130:131], v[130:131], v[114:115]
    v_pk_mul_f32 v[132:133], v[132:133], v[116:117]
    v_pk_mul_f32 v[134:135], v[134:135], v[118:119]
    v_exp_f32 v120, v120
    v_exp_f32 v121, v121
    v_exp_f32 v122, v122
    v_exp_f32 v123, v123
    v_exp_f32 v124, v124
    v_exp_f32 v125, v125
    v_exp_f32 v126, v126
    v_exp_f32 v127, v127
    v_exp_f32 v128, v128
    v_exp_f32 v129, v129
    v_exp_f32 v130, v130
    v_exp_f32 v131, v131
    v_exp_f32 v132, v132
    v_exp_f32 v133, v133
    v_exp_f32 v134, v134
    v_exp_f32 v135, v135
    s_nop 0
    v_pk_fma_f32 v[120:121], v[120:121], v[144:145], v[144:145] op_sel_hi:[1,0,0]
    v_pk_fma_f32 v[122:123], v[122:123], v[144:145], v[144:145] op_sel_hi:[1,0,0]
    v_pk_fma_f32 v[124:125], v[124:125], v[144:145], v[144:145] op_sel_hi:[1,0,0]
    v_pk_fma_f32 v[126:127], v[126:127], v[144:145], v[144:145] op_sel_hi:[1,0,0]
    v_pk_fma_f32 v[128:129], v[128:129], v[144:145], v[144:145] op_sel_hi:[1,0,0]
    v_pk_fma_f32 v[130:131], v[130:131], v[144:145], v[144:145] op_sel_hi:[1,0,0]
    v_pk_fma_f32 v[132:133], v[132:133], v[144:145], v[144:145] op_sel_hi:[1,0,0]
    v_pk_fma_f32 v[134:135], v[134:135], v[144:145], v[144:145] op_sel_hi:[1,0,0]
    v_rcp_f32 v120, v120
    v_rcp_f32 v121, v121
    v_rcp_f32 v122, v122
    v_rcp_f32 v123, v123
    v_rcp_f32 v124, v124
    v_rcp_f32 v125, v125
    v_rcp_f32 v126, v126
    v_rcp_f32 v127, v127
    v_rcp_f32 v128, v128
    v_rcp_f32 v129, v129
    v_rcp_f32 v130, v130
    v_rcp_f32 v131, v131
    v_rcp_f32 v132, v132
    v_rcp_f32 v133, v133
    v_rcp_f32 v134, v134
    v_rcp_f32 v135, v135
    s_nop 0
    v_pk_mul_f32 v[104:105], v[104:105], v[120:121]
    v_pk_mul_f32 v[106:107], v[106:107], v[122:123]
    v_pk_mul_f32 v[108:109], v[108:109], v[124:125]
    v_pk_mul_f32 v[110:111], v[110:111], v[126:127]
    v_pk_mul_f32 v[112:113], v[112:113], v[128:129]
    v_pk_mul_f32 v[114:115], v[114:115], v[130:131]
    v_pk_mul_f32 v[116:117], v[116:117], v[132:133]
    v_pk_mul_f32 v[118:119], v[118:119], v[134:135]
    s_mov_b32 s66, s67
    v_cvt_pk_bf16_f32 v120, v104, v105
    v_cvt_pk_bf16_f32 v121, v106, v107
    v_cvt_pk_bf16_f32 v122, v108, v109
    v_cvt_pk_bf16_f32 v123, v110, v111
    v_cvt_pk_bf16_f32 v124, v112, v113
    v_cvt_pk_bf16_f32 v125, v114, v115
    v_cvt_pk_bf16_f32 v126, v116, v117
    v_cvt_pk_bf16_f32 v127, v118, v119
    s_cmp_eq_u32 s36, 0
    s_cbranch_scc1 L_sequential_preLN__sliding_local_dilated__mixer_s_mlp__prompt_kernel_alt_202
    buffer_store_dwordx4 v[120:123], v85, s[48:51], s66 offen offset:0
    buffer_store_dwordx4 v[124:127], v85, s[48:51], s66 offen offset:1024
L_sequential_preLN__sliding_local_dilated__mixer_s_mlp__prompt_kernel_altb_203:
    s_cmp_lg_u32 s18, 0
    s_cbranch_scc1 L_sequential_preLN__sliding_local_dilated__mixer_s_mlp__prompt_kernel_shadow_204
L_sequential_preLN__sliding_local_dilated__mixer_s_mlp__prompt_kernel_nobd_205:
    v_lshlrev_b32 v88, 16, v32
    v_and_b32 v89, 0xffff0000, v32
    v_lshlrev_b32 v90, 16, v33
    v_and_b32 v91, 0xffff0000, v33
    v_lshlrev_b32 v92, 16, v34
    v_and_b32 v93, 0xffff0000, v34
    v_lshlrev_b32 v94, 16, v35
    v_and_b32 v95, 0xffff0000, v35
    v_lshlrev_b32 v96, 16, v36
    v_and_b32 v97, 0xffff0000, v36
    v_lshlrev_b32 v98, 16, v37
    v_and_b32 v99, 0xffff0000, v37
    v_lshlrev_b32 v100, 16, v38
    v_and_b32 v101, 0xffff0000, v38
    v_lshlrev_b32 v102, 16, v39
    v_and_b32 v103, 0xffff0000, v39
    v_pk_add_f32 v[88:89], v[88:89], v[80:81] op_sel_hi:[1,0]
    v_pk_add_f32 v[90:91], v[90:91], v[80:81] op_sel_hi:[1,0]
    v_pk_add_f32 v[92:93], v[92:93], v[80:81] op_sel_hi:[1,0]
    v_pk_add_f32 v[94:95], v[94:95], v[80:81] op_sel_hi:[1,0]
    v_pk_add_f32 v[96:97], v[96:97], v[80:81] op_sel_hi:[1,0]
    v_pk_add_f32 v[98:99], v[98:99], v[80:81] op_sel_hi:[1,0]
    v_pk_add_f32 v[100:101], v[100:101], v[80:81] op_sel_hi:[1,0]
    v_pk_add_f32 v[102:103], v[102:103], v[80:81] op_sel_hi:[1,0]
    v_pk_mul_f32 v[88:89], v[88:89], v[82:83] op_sel_hi:[1,0]
    v_pk_mul_f32 v[90:91], v[90:91], v[82:83] op_sel_hi:[1,0]
    v_pk_mul_f32 v[92:93], v[92:93], v[82:83] op_sel_hi:[1,0]
    v_pk_mul_f32 v[94:95], v[94:95], v[82:83] op_sel_hi:[1,0]
    v_pk_mul_f32 v[96:97], v[96:97], v[82:83] op_sel_hi:[1,0]
    v_pk_mul_f32 v[98:99], v[98:99], v[82:83] op_sel_hi:[1,0]
    v_pk_mul_f32 v[100:101], v[100:101], v[82:83] op_sel_hi:[1,0]
    v_pk_mul_f32 v[102:103], v[102:103], v[82:83] op_sel_hi:[1,0]
    s_cmp_lg_u32 s18, 0
    s_cbranch_scc1 L_sequential_preLN__sliding_local_dilated__mixer_s_mlp__prompt_kernel_shadowf_206
    s_waitcnt vmcnt(0)
    s_cmp_eq_u32 s36, 0
    s_cbranch_scc1 L_sequential_preLN__sliding_local_dilated__mixer_s_mlp__prompt_kernel_alt_210
    s_mov_b64 exec, 1
    buffer_store_dword v6, v7, s[48:51], s69 offen
    s_mov_b64 exec, -1
L_sequential_preLN__sliding_local_dilated__mixer_s_mlp__prompt_kernel_altb_211:
L_sequential_preLN__sliding_local_dilated__mixer_s_mlp__prompt_kernel_nobdf_207:
    s_cmp_lt_u32 s52, 17
    s_cbranch_scc1 L_sequential_preLN__sliding_local_dilated__mixer_s_mlp__prompt_kernel_lws_213
L_sequential_preLN__sliding_local_dilated__mixer_s_mlp__prompt_kernel_lwb_212:
    ds_read_b64_tr_b16 a[48:49], v65 offset:16384
    ds_read_b64_tr_b16 a[50:51], v65 offset:18432
    ds_read_b64_tr_b16 a[52:53], v66 offset:16384
    ds_read_b64_tr_b16 a[54:55], v66 offset:18432
    ds_read_b64_tr_b16 a[56:57], v67 offset:16384
    ds_read_b64_tr_b16 a[58:59], v67 offset:18432
    ds_read_b64_tr_b16 a[60:61], v68 offset:16384
    ds_read_b64_tr_b16 a[62:63], v68 offset:18432
    ds_read_b64_tr_b16 a[64:65], v65 offset:20480
    ds_read_b64_tr_b16 a[66:67], v65 offset:22528
    ds_read_b64_tr_b16 a[68:69], v66 offset:20480
    ds_read_b64_tr_b16 a[70:71], v66 offset:22528
    ds_read_b64_tr_b16 a[72:73], v67 offset:20480
    ds_read_b64_tr_b16 a[74:75], v67 offset:22528
    ds_read_b64_tr_b16 a[76:77], v68 offset:20480
    ds_read_b64_tr_b16 a[78:79], v68 offset:22528
    ds_read_b64_tr_b16 a[80:81], v65 offset:24576
    ds_read_b64_tr_b16 a[82:83], v65 offset:26624
    ds_read_b64_tr_b16 a[84:85], v66 offset:24576
    ds_read_b64_tr_b16 a[86:87], v66 offset:26624
    ds_read_b64_tr_b16 a[88:89], v67 offset:24576
    ds_read_b64_tr_b16 a[90:91], v67 offset:26624
    ds_read_b64_tr_b16 a[92:93], v68 offset:24576
    ds_read_b64_tr_b16 a[94:95], v68 offset:26624
    s_mov_b32 s13, 0
    v_bfe_u32 v8, v1, 2, 2
    v_lshl_add_u32 v8, v3, 2, v8
    v_mul_u32_u24 v8, 224, v8
    v_and_b32 v9, 3, v1
    v_lshl_add_u32 v49, v9, 3, v8
    v_add_u32 v50, 0x8000, v49
    v_add_u32 v51, 0x10000, v49
    s_lshl_b32 s14, s29, 2
    s_add_u32 s14, s14, s26
    s_lshl_b32 s14, s14, 1
    s_lshl_b32 s33, s14, 14
    s_add_u32 s33, s33, s68
    v_add_u32 v52, s33, v24
    v_lshrrev_b32 v8, 3, v1
    v_and_b32 v9, 7, v1
    v_lshlrev_b32 v9, 2, v9
    v_lshl_add_u32 v48, v8, 7, v9
    s_lshl_b32 s33, s14, 7
    s_add_u32 s34, s33, 0xfdc000
    v_add_u32 v48, s34, v48
    s_mov_b32 s12, 0xffff
    v_lshl_add_u32 v53, v2, 3, s33
    v_lshl_add_u32 v53, v3, 15, v53
    s_lshl_b32 s34, s30, 2
    s_add_u32 s17, s33, s34
    s_add_u32 s17, s17, 0xfe0000
    s_mul_i32 s33, s14, 56
    s_lshr_b32 s34, s30, 1
    s_mul_i32 s34, s34, 7
    s_add_u32 s33, s33, s34
    s_lshl_b32 s33, s33, 10
    s_add_u32 s33, s33, 0x800000
    s_and_b32 s34, s30, 1
    s_lshl_b32 s15, s34, 12
    s_add_u32 s15, s15, s33
    s_lshl_b32 s16, s34, 3
    s_add_u32 s16, s16, s33
    s_add_u32 s16, s16, 3072
    v_lshlrev_b32 v54, 7, v1
    s_branch L_sequential_preLN__sliding_local_dilated__mixer_s_mlp__prompt_kernel_isl_215
L_sequential_preLN__sliding_local_dilated__mixer_s_mlp__prompt_kernel_lws_195:
    s_movk_i32 s42, 14
    s_call_b64 s[44:45], L_wait_c_0_52_0
    s_branch L_sequential_preLN__sliding_local_dilated__mixer_s_mlp__prompt_kernel_lwb_194
L_sequential_preLN__sliding_local_dilated__mixer_s_mlp__prompt_kernel_lws_197:
    s_movk_i32 s42, 15
    s_call_b64 s[44:45], L_wait_c_0_52_0
    s_branch L_sequential_preLN__sliding_local_dilated__mixer_s_mlp__prompt_kernel_lwb_196
L_sequential_preLN__sliding_local_dilated__mixer_s_mlp__prompt_kernel_lws_199:
    s_movk_i32 s42, 16
    s_call_b64 s[44:45], L_wait_c_0_52_0
    s_branch L_sequential_preLN__sliding_local_dilated__mixer_s_mlp__prompt_kernel_lwb_198
L_sequential_preLN__sliding_local_dilated__mixer_s_mlp__prompt_kernel_lws_201:
    s_movk_i32 s42, 2
    s_call_b64 s[44:45], L_wait_c_64_53_0
    s_branch L_sequential_preLN__sliding_local_dilated__mixer_s_mlp__prompt_kernel_lwb_200
L_sequential_preLN__sliding_local_dilated__mixer_s_mlp__prompt_kernel_alt_202:
    buffer_store_dwordx4 v[120:123], v85, s[48:51], s66 offen offset:0 sc1
    buffer_store_dwordx4 v[124:127], v85, s[48:51], s66 offen offset:1024 sc1
    s_branch L_sequential_preLN__sliding_local_dilated__mixer_s_mlp__prompt_kernel_altb_203
L_sequential_preLN__sliding_local_dilated__mixer_s_mlp__prompt_kernel_shadow_204:
    s_mov_b64 exec, s[16:17]
    buffer_store_dwordx4 v[120:123], v55, s[48:51], s14 offen offset:0 sc1
    buffer_store_dwordx4 v[124:127], v55, s[48:51], s14 offen offset:1024 sc1
    s_mov_b64 exec, -1
    s_branch L_sequential_preLN__sliding_local_dilated__mixer_s_mlp__prompt_kernel_nobd_205
L_sequential_preLN__sliding_local_dilated__mixer_s_mlp__prompt_kernel_alt_210:
    s_mov_b64 exec, 1
    buffer_store_dword v6, v7, s[48:51], s69 offen sc1
    s_mov_b64 exec, -1
    s_branch L_sequential_preLN__sliding_local_dilated__mixer_s_mlp__prompt_kernel_altb_211
L_sequential_preLN__sliding_local_dilated__mixer_s_mlp__prompt_kernel_shadowf_206:
    s_mov_b64 exec, 1
    s_waitcnt vmcnt(2)
    s_cmp_eq_u32 s36, 0
    s_cbranch_scc1 L_sequential_preLN__sliding_local_dilated__mixer_s_mlp__prompt_kernel_shrem_208
    buffer_store_dword v6, v7, s[48:51], s69 offen
    s_branch L_sequential_preLN__sliding_local_dilated__mixer_s_mlp__prompt_kernel_shfl_209
L_sequential_preLN__sliding_local_dilated__mixer_s_mlp__prompt_kernel_shrem_208:
    buffer_store_dword v6, v7, s[48:51], s69 offen sc1
L_sequential_preLN__sliding_local_dilated__mixer_s_mlp__prompt_kernel_shfl_209:
    s_waitcnt vmcnt(1)
    buffer_store_dword v6, v7, s[48:51], s15 offen sc1
    s_mov_b64 exec, -1
    s_branch L_sequential_preLN__sliding_local_dilated__mixer_s_mlp__prompt_kernel_nobdf_207
L_sequential_preLN__sliding_local_dilated__mixer_s_mlp__prompt_kernel_lws_213:
    s_movk_i32 s42, 17
    s_call_b64 s[44:45], L_wait_c_0_52_0
    s_branch L_sequential_preLN__sliding_local_dilated__mixer_s_mlp__prompt_kernel_lwb_212
L_sequential_preLN__sliding_local_dilated__mixer_s_mlp__prompt_kernel_psub_214:
    s_mov_b32 s27, 0
    s_mov_b64 exec, s[4:5]
L_sequential_preLN__sliding_local_dilated__mixer_s_mlp__prompt_kernel_psub_214_t:
    buffer_load_dword v21, v64, s[48:51], 0 offen sc1
    s_waitcnt vmcnt(0)
    v_cmp_eq_u32 vcc, s35, v21
    s_nop 0
    s_or_b32 s70, vcc_lo, s71
    s_andn2_b32 s33, s42, s70
    s_cbranch_scc0 L_sequential_preLN__sliding_local_dilated__mixer_s_mlp__prompt_kernel_psub_214_o
    s_sleep 2
    s_add_u32 s27, s27, 1
    s_cmp_lt_u32 s27, 0x40000
    s_cbranch_scc1 L_sequential_preLN__sliding_local_dilated__mixer_s_mlp__prompt_kernel_psub_214_t
L_sequential_preLN__sliding_local_dilated__mixer_s_mlp__prompt_kernel_psub_214_o:
    s_mov_b64 exec, -1
    s_setpc_b64 s[44:45]
L_sequential_preLN__sliding_local_dilated__mixer_s_mlp__prompt_kernel_isl_215:
    s_mov_b32 s27, 0
    s_mov_b64 exec, s[4:5]
L_sequential_preLN__sliding_local_dilated__mixer_s_mlp__prompt_kernel_gpoll_216:
    buffer_load_dword v8, v64, s[48:51], 0 offen sc1
    s_waitcnt vmcnt(0)
    v_cmp_ne_u32 vcc, s35, v8
    s_nop 0
    s_cmp_eq_u64 vcc, 0
    s_cbranch_scc1 L_sequential_preLN__sliding_local_dilated__mixer_s_mlp__prompt_kernel_gok_217
    s_sleep 2
    s_add_u32 s27, s27, 1
    s_cmp_lt_u32 s27, 0x40000
    s_cbranch_scc1 L_sequential_preLN__sliding_local_dilated__mixer_s_mlp__prompt_kernel_gpoll_216
L_sequential_preLN__sliding_local_dilated__mixer_s_mlp__prompt_kernel_gok_217:
    s_mov_b64 exec, -1
    buffer_load_dwordx4 a[0:3], v73, s[48:51], 0 offen offset:0 sc1
    buffer_load_dwordx4 a[4:7], v73, s[48:51], 0 offen offset:1024 sc1
    buffer_load_dwordx4 a[8:11], v73, s[48:51], 0 offen offset:2048 sc1
    buffer_load_dwordx4 a[12:15], v73, s[48:51], 0 offen offset:3072 sc1
    buffer_load_dwordx4 a[16:19], v74, s[48:51], 0 offen offset:0 sc1
    buffer_load_dwordx4 a[20:23], v74, s[48:51], 0 offen offset:1024 sc1
    buffer_load_dwordx4 a[24:27], v74, s[48:51], 0 offen offset:2048 sc1
    buffer_load_dwordx4 a[28:31], v74, s[48:51], 0 offen offset:3072 sc1
    buffer_load_dwordx4 a[32:35], v75, s[48:51], 0 offen offset:0 sc1
    v_add_u32 v77, 0xfa0000, v86
    s_add_u32 s69, s65, 0xfdc000
    s_waitcnt vmcnt(8) lgkmcnt(15)
    v_mfma_f32_16x16x32_bf16 v[88:91], a[48:51], a[0:3], v[88:91]
    ds_read_b64_tr_b16 a[48:49], v65 offset:28672
    ds_read_b64_tr_b16 a[50:51], v65 offset:30720
    v_mfma_f32_16x16x32_bf16 v[92:95], a[52:55], a[0:3], v[92:95]
    ds_read_b64_tr_b16 a[52:53], v66 offset:28672
    ds_read_b64_tr_b16 a[54:55], v66 offset:30720
    v_mfma_f32_16x16x32_bf16 v[96:99], a[56:59], a[0:3], v[96:99]
    ds_read_b64_tr_b16 a[56:57], v67 offset:28672
    ds_read_b64_tr_b16 a[58:59], v67 offset:30720
    v_mfma_f32_16x16x32_bf16 v[100:103], a[60:63], a[0:3], v[100:103]
    ds_read_b64_tr_b16 a[60:61], v68 offset:28672
    ds_read_b64_tr_b16 a[62:63], v68 offset:30720
    buffer_load_dwordx4 a[36:39], v75, s[48:51], 0 offen offset:1024 sc1
    s_waitcnt vmcnt(8) lgkmcnt(15)
    v_mfma_f32_16x16x32_bf16 v[88:91], a[64:67], a[4:7], v[88:91]
    s_cmp_lt_u32 s52, 18
    s_cbranch_scc1 L_sequential_preLN__sliding_local_dilated__mixer_s_mlp__prompt_kernel_lws_219
L_sequential_preLN__sliding_local_dilated__mixer_s_mlp__prompt_kernel_lwb_218:
    ds_read_b64_tr_b16 a[64:65], v65 offset:32768
    ds_read_b64_tr_b16 a[66:67], v65 offset:34816
    v_mfma_f32_16x16x32_bf16 v[92:95], a[68:71], a[4:7], v[92:95]
    ds_read_b64_tr_b16 a[68:69], v66 offset:32768
    ds_read_b64_tr_b16 a[70:71], v66 offset:34816
    v_mfma_f32_16x16x32_bf16 v[96:99], a[72:75], a[4:7], v[96:99]
    ds_read_b64_tr_b16 a[72:73], v67 offset:32768
    ds_read_b64_tr_b16 a[74:75], v67 offset:34816
    v_mfma_f32_16x16x32_bf16 v[100:103], a[76:79], a[4:7], v[100:103]
    ds_read_b64_tr_b16 a[76:77], v68 offset:32768
    ds_read_b64_tr_b16 a[78:79], v68 offset:34816
    buffer_load_dwordx4 a[40:43], v75, s[48:51], 0 offen offset:2048 sc1
    s_waitcnt vmcnt(8) lgkmcnt(15)
    v_mfma_f32_16x16x32_bf16 v[88:91], a[80:83], a[8:11], v[88:91]
    ds_read_b64_tr_b16 a[80:81], v65 offset:36864
    ds_read_b64_tr_b16 a[82:83], v65 offset:38912
    v_mfma_f32_16x16x32_bf16 v[92:95], a[84:87], a[8:11], v[92:95]
    ds_read_b64_tr_b16 a[84:85], v66 offset:36864
    ds_read_b64_tr_b16 a[86:87], v66 offset:38912
    v_mfma_f32_16x16x32_bf16 v[96:99], a[88:91], a[8:11], v[96:99]
    ds_read_b64_tr_b16 a[88:89], v67 offset:36864
    ds_read_b64_tr_b16 a[90:91], v67 offset:38912
    v_mfma_f32_16x16x32_bf16 v[100:103], a[92:95], a[8:11], v[100:103]
    ds_read_b64_tr_b16 a[92:93], v68 offset:36864
    ds_read_b64_tr_b16 a[94:95], v68 offset:38912
    buffer_load_dwordx4 a[44:47], v75, s[48:51], 0 offen offset:3072 sc1
    s_waitcnt vmcnt(8) lgkmcnt(15)
    v_mfma_f32_16x16x32_bf16 v[88:91], a[48:51], a[12:15], v[88:91]
    ds_read_b64_tr_b16 a[48:49], v65 offset:40960
    ds_read_b64_tr_b16 a[50:51], v65 offset:43008
    v_mfma_f32_16x16x32_bf16 v[92:95], a[52:55], a[12:15], v[92:95]
    ds_read_b64_tr_b16 a[52:53], v66 offset:40960
    ds_read_b64_tr_b16 a[54:55], v66 offset:43008
    v_mfma_f32_16x16x32_bf16 v[96:99], a[56:59], a[12:15], v[96:99]
    ds_read_b64_tr_b16 a[56:57], v67 offset:40960
    ds_read_b64_tr_b16 a[58:59], v67 offset:43008
    v_mfma_f32_16x16x32_bf16 v[100:103], a[60:63], a[12:15], v[100:103]
    ds_read_b64_tr_b16 a[60:61], v68 offset:40960
    ds_read_b64_tr_b16 a[62:63], v68 offset:43008
    buffer_load_dwordx4 a[0:3], v76, s[48:51], 0 offen offset:0 sc1
    s_waitcnt vmcnt(8) lgkmcnt(15)
    v_mfma_f32_16x16x32_bf16 v[88:91], a[64:67], a[16:19], v[88:91]
    ds_read_b64_tr_b16 a[64:65], v65 offset:45056
    ds_read_b64_tr_b16 a[66:67], v65 offset:47104
    v_mfma_f32_16x16x32_bf16 v[92:95], a[68:71], a[16:19], v[92:95]
    ds_read_b64_tr_b16 a[68:69], v66 offset:45056
    ds_read_b64_tr_b16 a[70:71], v66 offset:47104
    v_mfma_f32_16x16x32_bf16 v[96:99], a[72:75], a[16:19], v[96:99]
    ds_read_b64_tr_b16 a[72:73], v67 offset:45056
    ds_read_b64_tr_b16 a[74:75], v67 offset:47104
    v_mfma_f32_16x16x32_bf16 v[100:103], a[76:79], a[16:19], v[100:103]
    ds_read_b64_tr_b16 a[76:77], v68 offset:45056
    ds_read_b64_tr_b16 a[78:79], v68 offset:47104
    buffer_load_dwordx4 a[4:7], v76, s[48:51], 0 offen offset:1024 sc1
    s_waitcnt vmcnt(8) lgkmcnt(15)
    v_mfma_f32_16x16x32_bf16 v[88:91], a[80:83], a[20:23], v[88:91]
    s_cmp_lt_u32 s52, 19
    s_cbranch_scc1 L_sequential_preLN__sliding_local_dilated__mixer_s_mlp__prompt_kernel_lws_221
L_sequential_preLN__sliding_local_dilated__mixer_s_mlp__prompt_kernel_lwb_220:
    ds_read_b64_tr_b16 a[80:81], v69 offset:0
    ds_read_b64_tr_b16 a[82:83], v69 offset:2048
    v_mfma_f32_16x16x32_bf16 v[92:95], a[84:87], a[20:23], v[92:95]
    ds_read_b64_tr_b16 a[84:85], v70 offset:0
    ds_read_b64_tr_b16 a[86:87], v70 offset:2048
    v_mfma_f32_16x16x32_bf16 v[96:99], a[88:91], a[20:23], v[96:99]
    ds_read_b64_tr_b16 a[88:89], v71 offset:0
    ds_read_b64_tr_b16 a[90:91], v71 offset:2048
    v_mfma_f32_16x16x32_bf16 v[100:103], a[92:95], a[20:23], v[100:103]
    ds_read_b64_tr_b16 a[92:93], v72 offset:0
    ds_read_b64_tr_b16 a[94:95], v72 offset:2048
    buffer_load_dwordx4 a[8:11], v76, s[48:51], 0 offen offset:2048 sc1
    s_waitcnt vmcnt(8) lgkmcnt(15)
    v_mfma_f32_16x16x32_bf16 v[88:91], a[48:51], a[24:27], v[88:91]
    ds_read_b64_tr_b16 a[48:49], v69 offset:4096
    ds_read_b64_tr_b16 a[50:51], v69 offset:6144
    v_mfma_f32_16x16x32_bf16 v[92:95], a[52:55], a[24:27], v[92:95]
    ds_read_b64_tr_b16 a[52:53], v70 offset:4096
    ds_read_b64_tr_b16 a[54:55], v70 offset:6144
    v_mfma_f32_16x16x32_bf16 v[96:99], a[56:59], a[24:27], v[96:99]
    ds_read_b64_tr_b16 a[56:57], v71 offset:4096
    ds_read_b64_tr_b16 a[58:59], v71 offset:6144
    v_mfma_f32_16x16x32_bf16 v[100:103], a[60:63], a[24:27], v[100:103]
    ds_read_b64_tr_b16 a[60:61], v72 offset:4096
    ds_read_b64_tr_b16 a[62:63], v72 offset:6144
    buffer_load_dwordx4 a[12:15], v76, s[48:51], 0 offen offset:3072 sc1
    s_waitcnt vmcnt(8) lgkmcnt(15)
    v_mfma_f32_16x16x32_bf16 v[88:91], a[64:67], a[28:31], v[88:91]
    ds_read_b64_tr_b16 a[64:65], v69 offset:8192
    ds_read_b64_tr_b16 a[66:67], v69 offset:10240
    v_mfma_f32_16x16x32_bf16 v[92:95], a[68:71], a[28:31], v[92:95]
    ds_read_b64_tr_b16 a[68:69], v70 offset:8192
    ds_read_b64_tr_b16 a[70:71], v70 offset:10240
    v_mfma_f32_16x16x32_bf16 v[96:99], a[72:75], a[28:31], v[96:99]
    ds_read_b64_tr_b16 a[72:73], v71 offset:8192
    ds_read_b64_tr_b16 a[74:75], v71 offset:10240
    v_mfma_f32_16x16x32_bf16 v[100:103], a[76:79], a[28:31], v[100:103]
    ds_read_b64_tr_b16 a[76:77], v72 offset:8192
    ds_read_b64_tr_b16 a[78:79], v72 offset:10240
    v_mov_b32 v12, 18
    s_mov_b64 exec, 1
    ds_max_u32 v5, v12 offset:16
    s_mov_b64 exec, -1
    s_waitcnt vmcnt(7) lgkmcnt(15)
    v_mfma_f32_16x16x32_bf16 v[88:91], a[80:83], a[32:35], v[88:91]
    ds_read_b64_tr_b16 a[80:81], v69 offset:12288
    ds_read_b64_tr_b16 a[82:83], v69 offset:14336
    v_mfma_f32_16x16x32_bf16 v[92:95], a[84:87], a[32:35], v[92:95]
    ds_read_b64_tr_b16 a[84:85], v70 offset:12288
    ds_read_b64_tr_b16 a[86:87], v70 offset:14336
    v_mfma_f32_16x16x32_bf16 v[96:99], a[88:91], a[32:35], v[96:99]
    ds_read_b64_tr_b16 a[88:89], v71 offset:12288
    ds_read_b64_tr_b16 a[90:91], v71 offset:14336
    v_mfma_f32_16x16x32_bf16 v[100:103], a[92:95], a[32:35], v[100:103]
    ds_read_b64_tr_b16 a[92:93], v72 offset:12288
    ds_read_b64_tr_b16 a[94:95], v72 offset:14336
    s_waitcnt vmcnt(6) lgkmcnt(15)
    v_mfma_f32_16x16x32_bf16 v[88:91], a[48:51], a[36:39], v[88:91]
    s_cmp_lt_u32 s52, 20
    s_cbranch_scc1 L_sequential_preLN__sliding_local_dilated__mixer_s_mlp__prompt_kernel_lws_223
L_sequential_preLN__sliding_local_dilated__mixer_s_mlp__prompt_kernel_lwb_222:
    ds_read_b64_tr_b16 a[48:49], v69 offset:16384
    ds_read_b64_tr_b16 a[50:51], v69 offset:18432
    v_mfma_f32_16x16x32_bf16 v[92:95], a[52:55], a[36:39], v[92:95]
    ds_read_b64_tr_b16 a[52:53], v70 offset:16384
    ds_read_b64_tr_b16 a[54:55], v70 offset:18432
    v_mfma_f32_16x16x32_bf16 v[96:99], a[56:59], a[36:39], v[96:99]
    ds_read_b64_tr_b16 a[56:57], v71 offset:16384
    ds_read_b64_tr_b16 a[58:59], v71 offset:18432
    v_mfma_f32_16x16x32_bf16 v[100:103], a[60:63], a[36:39], v[100:103]
    ds_read_b64_tr_b16 a[60:61], v72 offset:16384
    ds_read_b64_tr_b16 a[62:63], v72 offset:18432
    s_waitcnt vmcnt(5) lgkmcnt(15)
    v_mfma_f32_16x16x32_bf16 v[88:91], a[64:67], a[40:43], v[88:91]
    ds_read_b64_tr_b16 a[64:65], v69 offset:20480
    ds_read_b64_tr_b16 a[66:67], v69 offset:22528
    v_mfma_f32_16x16x32_bf16 v[92:95], a[68:71], a[40:43], v[92:95]
    ds_read_b64_tr_b16 a[68:69], v70 offset:20480
    ds_read_b64_tr_b16 a[70:71], v70 offset:22528
    v_mfma_f32_16x16x32_bf16 v[96:99], a[72:75], a[40:43], v[96:99]
    ds_read_b64_tr_b16 a[72:73], v71 offset:20480
    ds_read_b64_tr_b16 a[74:75], v71 offset:22528
    v_mfma_f32_16x16x32_bf16 v[100:103], a[76:79], a[40:43], v[100:103]
    ds_read_b64_tr_b16 a[76:77], v72 offset:20480
    ds_read_b64_tr_b16 a[78:79], v72 offset:22528
    s_waitcnt vmcnt(4) lgkmcnt(15)
    v_mfma_f32_16x16x32_bf16 v[88:91], a[80:83], a[44:47], v[88:91]
    ds_read_b64_tr_b16 a[80:81], v69 offset:24576
    ds_read_b64_tr_b16 a[82:83], v69 offset:26624
    v_mfma_f32_16x16x32_bf16 v[92:95], a[84:87], a[44:47], v[92:95]
    ds_read_b64_tr_b16 a[84:85], v70 offset:24576
    ds_read_b64_tr_b16 a[86:87], v70 offset:26624
    v_mfma_f32_16x16x32_bf16 v[96:99], a[88:91], a[44:47], v[96:99]
    ds_read_b64_tr_b16 a[88:89], v71 offset:24576
    ds_read_b64_tr_b16 a[90:91], v71 offset:26624
    v_mfma_f32_16x16x32_bf16 v[100:103], a[92:95], a[44:47], v[100:103]
    ds_read_b64_tr_b16 a[92:93], v72 offset:24576
    ds_read_b64_tr_b16 a[94:95], v72 offset:26624
    v_mov_b32 v12, 19
    s_mov_b64 exec, 1
    ds_max_u32 v5, v12 offset:16
    s_mov_b64 exec, -1
    s_waitcnt vmcnt(3) lgkmcnt(15)
    v_mfma_f32_16x16x32_bf16 v[88:91], a[48:51], a[0:3], v[88:91]
    ds_read_b64_tr_b16 a[48:49], v69 offset:28672
    ds_read_b64_tr_b16 a[50:51], v69 offset:30720
    v_mfma_f32_16x16x32_bf16 v[92:95], a[52:55], a[0:3], v[92:95]
    ds_read_b64_tr_b16 a[52:53], v70 offset:28672
    ds_read_b64_tr_b16 a[54:55], v70 offset:30720
    v_mfma_f32_16x16x32_bf16 v[96:99], a[56:59], a[0:3], v[96:99]
    ds_read_b64_tr_b16 a[56:57], v71 offset:28672
    ds_read_b64_tr_b16 a[58:59], v71 offset:30720
    v_mfma_f32_16x16x32_bf16 v[100:103], a[60:63], a[0:3], v[100:103]
    ds_read_b64_tr_b16 a[60:61], v72 offset:28672
    ds_read_b64_tr_b16 a[62:63], v72 offset:30720
    s_waitcnt vmcnt(2) lgkmcnt(15)
    v_mfma_f32_16x16x32_bf16 v[88:91], a[64:67], a[4:7], v[88:91]
    v_mfma_f32_16x16x32_bf16 v[92:95], a[68:71], a[4:7], v[92:95]
    v_mfma_f32_16x16x32_bf16 v[96:99], a[72:75], a[4:7], v[96:99]
    v_mfma_f32_16x16x32_bf16 v[100:103], a[76:79], a[4:7], v[100:103]
    s_waitcnt vmcnt(1) lgkmcnt(9)
    v_mfma_f32_16x16x32_bf16 v[88:91], a[80:83], a[8:11], v[88:91]
    v_mfma_f32_16x16x32_bf16 v[92:95], a[84:87], a[8:11], v[92:95]
    v_mfma_f32_16x16x32_bf16 v[96:99], a[88:91], a[8:11], v[96:99]
    v_mfma_f32_16x16x32_bf16 v[100:103], a[92:95], a[8:11], v[100:103]
    s_waitcnt vmcnt(0) lgkmcnt(0)
    v_mfma_f32_16x16x32_bf16 v[88:91], a[48:51], a[12:15], v[88:91]
    v_mfma_f32_16x16x32_bf16 v[92:95], a[52:55], a[12:15], v[92:95]
    v_mfma_f32_16x16x32_bf16 v[96:99], a[56:59], a[12:15], v[96:99]
    v_mfma_f32_16x16x32_bf16 v[100:103], a[60:63], a[12:15], v[100:103]
    v_mov_b32 v12, 20
    s_mov_b64 exec, 1
    ds_max_u32 v5, v12 offset:16
    s_mov_b64 exec, -1
    s_nop 4
    s_mov_b32 s66, s68
    v_cvt_pk_bf16_f32 v40, v88, v89
    v_cvt_pk_bf16_f32 v41, v90, v91
    v_cvt_pk_bf16_f32 v42, v92, v93
    v_cvt_pk_bf16_f32 v43, v94, v95
    v_cvt_pk_bf16_f32 v44, v96, v97
    v_cvt_pk_bf16_f32 v45, v98, v99
    v_cvt_pk_bf16_f32 v46, v100, v101
    v_cvt_pk_bf16_f32 v47, v102, v103
    s_cmp_eq_u32 s36, 0
    s_cbranch_scc1 L_sequential_preLN__sliding_local_dilated__mixer_s_mlp__prompt_kernel_alt_224
    buffer_store_dwordx4 v[40:43], v85, s[48:51], s66 offen offset:0
    buffer_store_dwordx4 v[44:47], v85, s[48:51], s66 offen offset:1024
L_sequential_preLN__sliding_local_dilated__mixer_s_mlp__prompt_kernel_altb_225:
    v_mov_b32 v136, 0
    v_mov_b32 v137, 0
    v_dot2c_f32_bf16 v136, v40, v16
    v_dot2c_f32_bf16 v137, v40, v40
    v_dot2c_f32_bf16 v136, v41, v16
    v_dot2c_f32_bf16 v137, v41, v41
    v_dot2c_f32_bf16 v136, v42, v16
    v_dot2c_f32_bf16 v137, v42, v42
    v_dot2c_f32_bf16 v136, v43, v16
    v_dot2c_f32_bf16 v137, v43, v43
    v_dot2c_f32_bf16 v136, v44, v16
    v_dot2c_f32_bf16 v137, v44, v44
    v_dot2c_f32_bf16 v136, v45, v16
    v_dot2c_f32_bf16 v137, v45, v45
    v_dot2c_f32_bf16 v136, v46, v16
    v_dot2c_f32_bf16 v137, v46, v46
    v_dot2c_f32_bf16 v136, v47, v16
    v_dot2c_f32_bf16 v137, v47, v47
    s_nop 2
    v_permlane32_swap_b32 v136, v137
    s_nop 0
    v_add_f32 v136, v136, v137
    v_mov_b32 v138, v136
    s_nop 1
    v_permlane16_swap_b32 v136, v138
    s_nop 0
    v_add_f32 v136, v136, v138
    s_cmp_eq_u32 s36, 0
    s_cbranch_scc1 L_sequential_preLN__sliding_local_dilated__mixer_s_mlp__prompt_kernel_alt_226
    buffer_store_dword v136, v77, s[48:51], 0 offen
L_sequential_preLN__sliding_local_dilated__mixer_s_mlp__prompt_kernel_altb_227:
    s_waitcnt vmcnt(0)
    s_cmp_eq_u32 s36, 0
    s_cbranch_scc1 L_sequential_preLN__sliding_local_dilated__mixer_s_mlp__prompt_kernel_alt_228
    s_mov_b64 exec, 1
    buffer_store_dword v6, v7, s[48:51], s69 offen
    s_mov_b64 exec, -1
L_sequential_preLN__sliding_local_dilated__mixer_s_mlp__prompt_kernel_altb_229:
    s_cmp_lt_u32 s52, 21
    s_cbranch_scc1 L_sequential_preLN__sliding_local_dilated__mixer_s_mlp__prompt_kernel_lws_231
L_sequential_preLN__sliding_local_dilated__mixer_s_mlp__prompt_kernel_lwb_230:
    ds_read_b64_tr_b16 a[56:57], v49 offset:0
    ds_read_b64_tr_b16 a[58:59], v49 offset:3584
    ds_read_b64_tr_b16 a[60:61], v49 offset:32
    ds_read_b64_tr_b16 a[62:63], v49 offset:3616
    ds_read_b64_tr_b16 a[64:65], v49 offset:64
    ds_read_b64_tr_b16 a[66:67], v49 offset:3648
    ds_read_b64_tr_b16 a[68:69], v49 offset:96
    ds_read_b64_tr_b16 a[70:71], v49 offset:3680
    ds_read_b64_tr_b16 a[72:73], v49 offset:128
    ds_read_b64_tr_b16 a[74:75], v49 offset:3712
    ds_read_b64_tr_b16 a[76:77], v49 offset:160
    ds_read_b64_tr_b16 a[78:79], v49 offset:3744
    ds_read_b64_tr_b16 a[80:81], v49 offset:192
    ds_read_b64_tr_b16 a[82:83], v49 offset:3776
    ds_read_b64_tr_b16 a[84:85], v49 offset:7168
    ds_read_b64_tr_b16 a[86:87], v49 offset:10752
    ds_read_b64_tr_b16 a[88:89], v49 offset:7200
    ds_read_b64_tr_b16 a[90:91], v49 offset:10784
    s_branch L_sequential_preLN__sliding_local_dilated__mixer_s_mlp__prompt_kernel_isl_233
L_sequential_preLN__sliding_local_dilated__mixer_s_mlp__prompt_kernel_lws_219:
    s_movk_i32 s42, 18
    s_call_b64 s[44:45], L_wait_c_0_52_0
    s_branch L_sequential_preLN__sliding_local_dilated__mixer_s_mlp__prompt_kernel_lwb_218
L_sequential_preLN__sliding_local_dilated__mixer_s_mlp__prompt_kernel_lws_221:
    s_movk_i32 s42, 19
    s_call_b64 s[44:45], L_wait_c_0_52_0
    s_branch L_sequential_preLN__sliding_local_dilated__mixer_s_mlp__prompt_kernel_lwb_220
L_sequential_preLN__sliding_local_dilated__mixer_s_mlp__prompt_kernel_lws_223:
    s_movk_i32 s42, 20
    s_call_b64 s[44:45], L_wait_c_0_52_0
    s_branch L_sequential_preLN__sliding_local_dilated__mixer_s_mlp__prompt_kernel_lwb_222
L_sequential_preLN__sliding_local_dilated__mixer_s_mlp__prompt_kernel_alt_224:
    buffer_store_dwordx4 v[40:43], v85, s[48:51], s66 offen offset:0 sc1
    buffer_store_dwordx4 v[44:47], v85, s[48:51], s66 offen offset:1024 sc1
    s_branch L_sequential_preLN__sliding_local_dilated__mixer_s_mlp__prompt_kernel_altb_225
L_sequential_preLN__sliding_local_dilated__mixer_s_mlp__prompt_kernel_alt_226:
    buffer_store_dword v136, v77, s[48:51], 0 offen sc1
    s_branch L_sequential_preLN__sliding_local_dilated__mixer_s_mlp__prompt_kernel_altb_227
L_sequential_preLN__sliding_local_dilated__mixer_s_mlp__prompt_kernel_alt_228:
    s_mov_b64 exec, 1
    buffer_store_dword v6, v7, s[48:51], s69 offen sc1
    s_mov_b64 exec, -1
    s_branch L_sequential_preLN__sliding_local_dilated__mixer_s_mlp__prompt_kernel_altb_229
L_sequential_preLN__sliding_local_dilated__mixer_s_mlp__prompt_kernel_lws_231:
    s_movk_i32 s42, 21
    s_call_b64 s[44:45], L_wait_c_0_52_0
    s_branch L_sequential_preLN__sliding_local_dilated__mixer_s_mlp__prompt_kernel_lwb_230
L_sequential_preLN__sliding_local_dilated__mixer_s_mlp__prompt_kernel_psub_232:
    s_mov_b32 s27, 0
    s_mov_b64 exec, s[12:13]
L_sequential_preLN__sliding_local_dilated__mixer_s_mlp__prompt_kernel_psub_232_t:
    buffer_load_dword v21, v48, s[48:51], 0 offen sc1
    s_waitcnt vmcnt(0)
    v_cmp_eq_u32 vcc, s35, v21
    s_nop 0
    s_or_b32 s70, vcc_lo, s71
    s_andn2_b32 s33, s42, s70
    s_cbranch_scc0 L_sequential_preLN__sliding_local_dilated__mixer_s_mlp__prompt_kernel_psub_232_o
    s_sleep 2
    s_add_u32 s27, s27, 1
    s_cmp_lt_u32 s27, 0x40000
    s_cbranch_scc1 L_sequential_preLN__sliding_local_dilated__mixer_s_mlp__prompt_kernel_psub_232_t
L_sequential_preLN__sliding_local_dilated__mixer_s_mlp__prompt_kernel_psub_232_o:
    s_mov_b64 exec, -1
    s_setpc_b64 s[44:45]
L_sequential_preLN__sliding_local_dilated__mixer_s_mlp__prompt_kernel_isl_233:
    s_mov_b32 s27, 0
    s_mov_b64 exec, s[12:13]
L_sequential_preLN__sliding_local_dilated__mixer_s_mlp__prompt_kernel_gpoll_234:
    buffer_load_dword v8, v48, s[48:51], 0 offen sc1
    s_waitcnt vmcnt(0)
    v_cmp_ne_u32 vcc, s35, v8
    s_nop 0
    s_cmp_eq_u64 vcc, 0
    s_cbranch_scc1 L_sequential_preLN__sliding_local_dilated__mixer_s_mlp__prompt_kernel_gok_235
    s_sleep 2
    s_add_u32 s27, s27, 1
    s_cmp_lt_u32 s27, 0x40000
    s_cbranch_scc1 L_sequential_preLN__sliding_local_dilated__mixer_s_mlp__prompt_kernel_gpoll_234
L_sequential_preLN__sliding_local_dilated__mixer_s_mlp__prompt_kernel_gok_235:
    s_mov_b64 exec, -1
    s_mov_b32 s66, 0x0
    buffer_load_dwordx4 a[0:3], v52, s[48:51], s66 offen sc1
    s_mov_b32 s66, 0x4000
    buffer_load_dwordx4 a[4:7], v52, s[48:51], s66 offen sc1
    s_mov_b32 s66, 0x400
    buffer_load_dwordx4 a[8:11], v52, s[48:51], s66 offen sc1
    s_mov_b32 s66, 0x4400
    buffer_load_dwordx4 a[12:15], v52, s[48:51], s66 offen sc1
    s_mov_b32 s66, 0x800
    buffer_load_dwordx4 a[16:19], v52, s[48:51], s66 offen sc1
    s_mov_b32 s66, 0x4800
    buffer_load_dwordx4 a[20:23], v52, s[48:51], s66 offen sc1
    s_mov_b32 s66, 0xc00
    buffer_load_dwordx4 a[24:27], v52, s[48:51], s66 offen sc1
    s_mov_b32 s66, 0x4c00
    buffer_load_dwordx4 a[28:31], v52, s[48:51], s66 offen sc1
    s_mov_b32 s66, 0x1000
    buffer_load_dwordx4 a[32:35], v52, s[48:51], s66 offen sc1
    s_mov_b32 s66, 0x5000
    buffer_load_dwordx4 a[36:39], v52, s[48:51], s66 offen sc1
    s_mov_b32 s66, 0x1400
    buffer_load_dwordx4 a[40:43], v52, s[48:51], s66 offen sc1
    s_mov_b32 s66, 0x5400
    buffer_load_dwordx4 a[44:47], v52, s[48:51], s66 offen sc1
    s_waitcnt vmcnt(10) lgkmcnt(10)
    v_mfma_f32_16x16x32_bf16 v[88:91], a[56:59], a[0:3], 0
    ds_read_b64_tr_b16 a[92:93], v49 offset:7232
    v_mfma_f32_16x16x32_bf16 v[116:119], a[56:59], a[4:7], 0
    ds_read_b64_tr_b16 a[94:95], v49 offset:10816
    v_mfma_f32_16x16x32_bf16 v[92:95], a[60:63], a[0:3], 0
    ds_read_b64_tr_b16 a[56:57], v49 offset:7264
    v_mfma_f32_16x16x32_bf16 v[120:123], a[60:63], a[4:7], 0
    ds_read_b64_tr_b16 a[58:59], v49 offset:10848
    s_mov_b32 s66, 0x1800
    buffer_load_dwordx4 a[48:51], v52, s[48:51], s66 offen sc1
    s_mov_b32 s66, 0x5800
    buffer_load_dwordx4 a[52:55], v52, s[48:51], s66 offen sc1
    v_mfma_f32_16x16x32_bf16 v[96:99], a[64:67], a[0:3], 0
    ds_read_b64_tr_b16 a[60:61], v49 offset:7296
    v_mfma_f32_16x16x32_bf16 v[124:127], a[64:67], a[4:7], 0
    ds_read_b64_tr_b16 a[62:63], v49 offset:10880
    v_mfma_f32_16x16x32_bf16 v[100:103], a[68:71], a[0:3], 0
    ds_read_b64_tr_b16 a[64:65], v49 offset:7328
    v_mfma_f32_16x16x32_bf16 v[128:131], a[68:71], a[4:7], 0
    ds_read_b64_tr_b16 a[66:67], v49 offset:10912
    s_waitcnt lgkmcnt(12)
    v_mfma_f32_16x16x32_bf16 v[104:107], a[72:75], a[0:3], 0
    ds_read_b64_tr_b16 a[68:69], v49 offset:7360
    v_mfma_f32_16x16x32_bf16 v[132:135], a[72:75], a[4:7], 0
    ds_read_b64_tr_b16 a[70:71], v49 offset:10944
    v_mfma_f32_16x16x32_bf16 v[108:111], a[76:79], a[0:3], 0
    ds_read_b64_tr_b16 a[72:73], v49 offset:14336
    v_mfma_f32_16x16x32_bf16 v[136:139], a[76:79], a[4:7], 0
    ds_read_b64_tr_b16 a[74:75], v49 offset:17920
    v_mfma_f32_16x16x32_bf16 v[112:115], a[80:83], a[0:3], 0
    ds_read_b64_tr_b16 a[76:77], v49 offset:14368
    v_mfma_f32_16x16x32_bf16 v[140:143], a[80:83], a[4:7], 0
    ds_read_b64_tr_b16 a[78:79], v49 offset:17952
    s_waitcnt vmcnt(10) lgkmcnt(10)
    v_mfma_f32_16x16x32_bf16 v[88:91], a[84:87], a[8:11], v[88:91]
    ds_read_b64_tr_b16 a[80:81], v49 offset:14400
    v_mfma_f32_16x16x32_bf16 v[116:119], a[84:87], a[12:15], v[116:119]
    ds_read_b64_tr_b16 a[82:83], v49 offset:17984
    v_mfma_f32_16x16x32_bf16 v[92:95], a[88:91], a[8:11], v[92:95]
    ds_read_b64_tr_b16 a[84:85], v49 offset:14432
    v_mfma_f32_16x16x32_bf16 v[120:123], a[88:91], a[12:15], v[120:123]
    ds_read_b64_tr_b16 a[86:87], v49 offset:18016
    s_mov_b32 s66, 0x1c00
    buffer_load_dwordx4 a[0:3], v52, s[48:51], s66 offen sc1
    s_mov_b32 s66, 0x5c00
    buffer_load_dwordx4 a[4:7], v52, s[48:51], s66 offen sc1
    v_mfma_f32_16x16x32_bf16 v[96:99], a[92:95], a[8:11], v[96:99]
    ds_read_b64_tr_b16 a[88:89], v49 offset:14464
    v_mfma_f32_16x16x32_bf16 v[124:127], a[92:95], a[12:15], v[124:127]
    ds_read_b64_tr_b16 a[90:91], v49 offset:18048
    v_mfma_f32_16x16x32_bf16 v[100:103], a[56:59], a[8:11], v[100:103]
    ds_read_b64_tr_b16 a[92:93], v49 offset:14496
    v_mfma_f32_16x16x32_bf16 v[128:131], a[56:59], a[12:15], v[128:131]
    ds_read_b64_tr_b16 a[94:95], v49 offset:18080
    s_waitcnt lgkmcnt(12)
    v_mfma_f32_16x16x32_bf16 v[104:107], a[60:63], a[8:11], v[104:107]
    ds_read_b64_tr_b16 a[56:57], v49 offset:14528
    v_mfma_f32_16x16x32_bf16 v[132:135], a[60:63], a[12:15], v[132:135]
    ds_read_b64_tr_b16 a[58:59], v49 offset:18112
    v_mfma_f32_16x16x32_bf16 v[108:111], a[64:67], a[8:11], v[108:111]
    ds_read_b64_tr_b16 a[60:61], v49 offset:21504
    v_mfma_f32_16x16x32_bf16 v[136:139], a[64:67], a[12:15], v[136:139]
    ds_read_b64_tr_b16 a[62:63], v49 offset:25088
    s_cmp_ge_u32 s52, 22
    s_cbranch_scc0 L_sequential_preLN__sliding_local_dilated__mixer_s_mlp__prompt_kernel_nopeek_236_d
L_sequential_preLN__sliding_local_dilated__mixer_s_mlp__prompt_kernel_nopeek_236:
    v_mfma_f32_16x16x32_bf16 v[112:115], a[68:71], a[8:11], v[112:115]
    ds_read_b64_tr_b16 a[64:65], v49 offset:21536
    v_mfma_f32_16x16x32_bf16 v[140:143], a[68:71], a[12:15], v[140:143]
    ds_read_b64_tr_b16 a[66:67], v49 offset:25120
    s_waitcnt vmcnt(10) lgkmcnt(10)
    v_mfma_f32_16x16x32_bf16 v[88:91], a[72:75], a[16:19], v[88:91]
    ds_read_b64_tr_b16 a[68:69], v49 offset:21568
    v_mfma_f32_16x16x32_bf16 v[116:119], a[72:75], a[20:23], v[116:119]
    ds_read_b64_tr_b16 a[70:71], v49 offset:25152
    v_mfma_f32_16x16x32_bf16 v[92:95], a[76:79], a[16:19], v[92:95]
    ds_read_b64_tr_b16 a[72:73], v49 offset:21600
    v_mfma_f32_16x16x32_bf16 v[120:123], a[76:79], a[20:23], v[120:123]
    ds_read_b64_tr_b16 a[74:75], v49 offset:25184
    s_mov_b32 s66, 0x2000
    buffer_load_dwordx4 a[8:11], v52, s[48:51], s66 offen sc1
    s_mov_b32 s66, 0x6000
    buffer_load_dwordx4 a[12:15], v52, s[48:51], s66 offen sc1
    v_mfma_f32_16x16x32_bf16 v[96:99], a[80:83], a[16:19], v[96:99]
    ds_read_b64_tr_b16 a[76:77], v49 offset:21632
    v_mfma_f32_16x16x32_bf16 v[124:127], a[80:83], a[20:23], v[124:127]
    ds_read_b64_tr_b16 a[78:79], v49 offset:25216
    v_mfma_f32_16x16x32_bf16 v[100:103], a[84:87], a[16:19], v[100:103]
    ds_read_b64_tr_b16 a[80:81], v49 offset:21664
    v_mfma_f32_16x16x32_bf16 v[128:131], a[84:87], a[20:23], v[128:131]
    ds_read_b64_tr_b16 a[82:83], v49 offset:25248
    s_waitcnt lgkmcnt(12)
    v_mfma_f32_16x16x32_bf16 v[104:107], a[88:91], a[16:19], v[104:107]
    ds_read_b64_tr_b16 a[84:85], v49 offset:21696
    v_mfma_f32_16x16x32_bf16 v[132:135], a[88:91], a[20:23], v[132:135]
    ds_read_b64_tr_b16 a[86:87], v49 offset:25280
    v_mfma_f32_16x16x32_bf16 v[108:111], a[92:95], a[16:19], v[108:111]
    s_cmp_lt_u32 s52, 22
    s_cbranch_scc1 L_sequential_preLN__sliding_local_dilated__mixer_s_mlp__prompt_kernel_lws_238
L_sequential_preLN__sliding_local_dilated__mixer_s_mlp__prompt_kernel_lwb_237:
    ds_read_b64_tr_b16 a[88:89], v49 offset:28672
    v_mfma_f32_16x16x32_bf16 v[136:139], a[92:95], a[20:23], v[136:139]
    ds_read_b64_tr_b16 a[90:91], v49 offset:32256
    v_mfma_f32_16x16x32_bf16 v[112:115], a[56:59], a[16:19], v[112:115]
    ds_read_b64_tr_b16 a[92:93], v49 offset:28704
    v_mfma_f32_16x16x32_bf16 v[140:143], a[56:59], a[20:23], v[140:143]
    ds_read_b64_tr_b16 a[94:95], v49 offset:32288
    s_waitcnt vmcnt(10) lgkmcnt(10)
    v_mfma_f32_16x16x32_bf16 v[88:91], a[60:63], a[24:27], v[88:91]
    ds_read_b64_tr_b16 a[56:57], v49 offset:28736
    v_mfma_f32_16x16x32_bf16 v[116:119], a[60:63], a[28:31], v[116:119]
    ds_read_b64_tr_b16 a[58:59], v49 offset:32320
    v_mfma_f32_16x16x32_bf16 v[92:95], a[64:67], a[24:27], v[92:95]
    ds_read_b64_tr_b16 a[60:61], v49 offset:28768
    v_mfma_f32_16x16x32_bf16 v[120:123], a[64:67], a[28:31], v[120:123]
    ds_read_b64_tr_b16 a[62:63], v49 offset:32352
    s_mov_b32 s66, 0x2400
    buffer_load_dwordx4 a[16:19], v52, s[48:51], s66 offen sc1
    s_mov_b32 s66, 0x6400
    buffer_load_dwordx4 a[20:23], v52, s[48:51], s66 offen sc1
    v_mfma_f32_16x16x32_bf16 v[96:99], a[68:71], a[24:27], v[96:99]
    ds_read_b64_tr_b16 a[64:65], v49 offset:28800
    v_mfma_f32_16x16x32_bf16 v[124:127], a[68:71], a[28:31], v[124:127]
    ds_read_b64_tr_b16 a[66:67], v49 offset:32384
    v_mfma_f32_16x16x32_bf16 v[100:103], a[72:75], a[24:27], v[100:103]
    ds_read_b64_tr_b16 a[68:69], v49 offset:28832
    v_mfma_f32_16x16x32_bf16 v[128:131], a[72:75], a[28:31], v[128:131]
    ds_read_b64_tr_b16 a[70:71], v49 offset:32416
    s_waitcnt lgkmcnt(12)
    v_mfma_f32_16x16x32_bf16 v[104:107], a[76:79], a[24:27], v[104:107]
    ds_read_b64_tr_b16 a[72:73], v49 offset:28864
    v_mfma_f32_16x16x32_bf16 v[132:135], a[76:79], a[28:31], v[132:135]
    ds_read_b64_tr_b16 a[74:75], v49 offset:32448
    v_mfma_f32_16x16x32_bf16 v[108:111], a[80:83], a[24:27], v[108:111]
    ds_read_b64_tr_b16 a[76:77], v49 offset:35840
    v_mfma_f32_16x16x32_bf16 v[136:139], a[80:83], a[28:31], v[136:139]
    ds_read_b64_tr_b16 a[78:79], v49 offset:39424
    v_mfma_f32_16x16x32_bf16 v[112:115], a[84:87], a[24:27], v[112:115]
    ds_read_b64_tr_b16 a[80:81], v49 offset:35872
    v_mfma_f32_16x16x32_bf16 v[140:143], a[84:87], a[28:31], v[140:143]
    ds_read_b64_tr_b16 a[82:83], v49 offset:39456
    v_mov_b32 v12, 21
    s_mov_b64 exec, 1
    ds_max_u32 v5, v12 offset:16
    s_mov_b64 exec, -1
    s_waitcnt vmcnt(10) lgkmcnt(11)
    v_mfma_f32_16x16x32_bf16 v[88:91], a[88:91], a[32:35], v[88:91]
    ds_read_b64_tr_b16 a[84:85], v49 offset:35904
    v_mfma_f32_16x16x32_bf16 v[116:119], a[88:91], a[36:39], v[116:119]
    ds_read_b64_tr_b16 a[86:87], v49 offset:39488
    v_mfma_f32_16x16x32_bf16 v[92:95], a[92:95], a[32:35], v[92:95]
    ds_read_b64_tr_b16 a[88:89], v49 offset:35936
    v_mfma_f32_16x16x32_bf16 v[120:123], a[92:95], a[36:39], v[120:123]
    ds_read_b64_tr_b16 a[90:91], v49 offset:39520
    s_mov_b32 s66, 0x2800
    buffer_load_dwordx4 a[24:27], v52, s[48:51], s66 offen sc1
    s_mov_b32 s66, 0x6800
    buffer_load_dwordx4 a[28:31], v52, s[48:51], s66 offen sc1
    v_mfma_f32_16x16x32_bf16 v[96:99], a[56:59], a[32:35], v[96:99]
    ds_read_b64_tr_b16 a[92:93], v49 offset:35968
    v_mfma_f32_16x16x32_bf16 v[124:127], a[56:59], a[36:39], v[124:127]
    ds_read_b64_tr_b16 a[94:95], v49 offset:39552
    v_mfma_f32_16x16x32_bf16 v[100:103], a[60:63], a[32:35], v[100:103]
    ds_read_b64_tr_b16 a[56:57], v49 offset:36000
    v_mfma_f32_16x16x32_bf16 v[128:131], a[60:63], a[36:39], v[128:131]
    ds_read_b64_tr_b16 a[58:59], v49 offset:39584
    s_waitcnt lgkmcnt(13)
    v_mfma_f32_16x16x32_bf16 v[104:107], a[64:67], a[32:35], v[104:107]
    ds_read_b64_tr_b16 a[60:61], v49 offset:36032
    v_mfma_f32_16x16x32_bf16 v[132:135], a[64:67], a[36:39], v[132:135]
    ds_read_b64_tr_b16 a[62:63], v49 offset:39616
    v_mfma_f32_16x16x32_bf16 v[108:111], a[68:71], a[32:35], v[108:111]
    ds_read_b64_tr_b16 a[64:65], v49 offset:43008
    v_mfma_f32_16x16x32_bf16 v[136:139], a[68:71], a[36:39], v[136:139]
    ds_read_b64_tr_b16 a[66:67], v49 offset:46592
    v_mfma_f32_16x16x32_bf16 v[112:115], a[72:75], a[32:35], v[112:115]
    ds_read_b64_tr_b16 a[68:69], v49 offset:43040
    v_mfma_f32_16x16x32_bf16 v[140:143], a[72:75], a[36:39], v[140:143]
    ds_read_b64_tr_b16 a[70:71], v49 offset:46624
    s_waitcnt vmcnt(10) lgkmcnt(10)
    v_mfma_f32_16x16x32_bf16 v[88:91], a[76:79], a[40:43], v[88:91]
    ds_read_b64_tr_b16 a[72:73], v49 offset:43072
    v_mfma_f32_16x16x32_bf16 v[116:119], a[76:79], a[44:47], v[116:119]
    ds_read_b64_tr_b16 a[74:75], v49 offset:46656
    v_mfma_f32_16x16x32_bf16 v[92:95], a[80:83], a[40:43], v[92:95]
    ds_read_b64_tr_b16 a[76:77], v49 offset:43104
    v_mfma_f32_16x16x32_bf16 v[120:123], a[80:83], a[44:47], v[120:123]
    ds_read_b64_tr_b16 a[78:79], v49 offset:46688
    s_mov_b32 s66, 0x2c00
    buffer_load_dwordx4 a[32:35], v52, s[48:51], s66 offen sc1
    s_mov_b32 s66, 0x6c00
    buffer_load_dwordx4 a[36:39], v52, s[48:51], s66 offen sc1
    v_mfma_f32_16x16x32_bf16 v[96:99], a[84:87], a[40:43], v[96:99]
    ds_read_b64_tr_b16 a[80:81], v49 offset:43136
    v_mfma_f32_16x16x32_bf16 v[124:127], a[84:87], a[44:47], v[124:127]
    ds_read_b64_tr_b16 a[82:83], v49 offset:46720
    v_mfma_f32_16x16x32_bf16 v[100:103], a[88:91], a[40:43], v[100:103]
    ds_read_b64_tr_b16 a[84:85], v49 offset:43168
    v_mfma_f32_16x16x32_bf16 v[128:131], a[88:91], a[44:47], v[128:131]
    ds_read_b64_tr_b16 a[86:87], v49 offset:46752
    s_waitcnt lgkmcnt(12)
    v_mfma_f32_16x16x32_bf16 v[104:107], a[92:95], a[40:43], v[104:107]
    ds_read_b64_tr_b16 a[88:89], v49 offset:43200
    v_mfma_f32_16x16x32_bf16 v[132:135], a[92:95], a[44:47], v[132:135]
    ds_read_b64_tr_b16 a[90:91], v49 offset:46784
    v_mfma_f32_16x16x32_bf16 v[108:111], a[56:59], a[40:43], v[108:111]
    ds_read_b64_tr_b16 a[92:93], v49 offset:50176
    v_mfma_f32_16x16x32_bf16 v[136:139], a[56:59], a[44:47], v[136:139]
    ds_read_b64_tr_b16 a[94:95], v49 offset:53760
    s_cmp_ge_u32 s52, 23
    s_cbranch_scc0 L_sequential_preLN__sliding_local_dilated__mixer_s_mlp__prompt_kernel_nopeek_239_d
L_sequential_preLN__sliding_local_dilated__mixer_s_mlp__prompt_kernel_nopeek_239:
    v_mfma_f32_16x16x32_bf16 v[112:115], a[60:63], a[40:43], v[112:115]
    ds_read_b64_tr_b16 a[56:57], v49 offset:50208
    v_mfma_f32_16x16x32_bf16 v[140:143], a[60:63], a[44:47], v[140:143]
    ds_read_b64_tr_b16 a[58:59], v49 offset:53792
    s_waitcnt vmcnt(10) lgkmcnt(10)
    v_mfma_f32_16x16x32_bf16 v[88:91], a[64:67], a[48:51], v[88:91]
    ds_read_b64_tr_b16 a[60:61], v49 offset:50240
    v_mfma_f32_16x16x32_bf16 v[116:119], a[64:67], a[52:55], v[116:119]
    ds_read_b64_tr_b16 a[62:63], v49 offset:53824
    v_mfma_f32_16x16x32_bf16 v[92:95], a[68:71], a[48:51], v[92:95]
    ds_read_b64_tr_b16 a[64:65], v49 offset:50272
    v_mfma_f32_16x16x32_bf16 v[120:123], a[68:71], a[52:55], v[120:123]
    ds_read_b64_tr_b16 a[66:67], v49 offset:53856
    s_mov_b32 s66, 0x3000
    buffer_load_dwordx4 a[40:43], v52, s[48:51], s66 offen sc1
    s_mov_b32 s66, 0x7000
    buffer_load_dwordx4 a[44:47], v52, s[48:51], s66 offen sc1
    v_mfma_f32_16x16x32_bf16 v[96:99], a[72:75], a[48:51], v[96:99]
    ds_read_b64_tr_b16 a[68:69], v49 offset:50304
    v_mfma_f32_16x16x32_bf16 v[124:127], a[72:75], a[52:55], v[124:127]
    ds_read_b64_tr_b16 a[70:71], v49 offset:53888
    v_mfma_f32_16x16x32_bf16 v[100:103], a[76:79], a[48:51], v[100:103]
    ds_read_b64_tr_b16 a[72:73], v49 offset:50336
    v_mfma_f32_16x16x32_bf16 v[128:131], a[76:79], a[52:55], v[128:131]
    ds_read_b64_tr_b16 a[74:75], v49 offset:53920
    s_waitcnt lgkmcnt(12)
    v_mfma_f32_16x16x32_bf16 v[104:107], a[80:83], a[48:51], v[104:107]
    ds_read_b64_tr_b16 a[76:77], v49 offset:50368
    v_mfma_f32_16x16x32_bf16 v[132:135], a[80:83], a[52:55], v[132:135]
    ds_read_b64_tr_b16 a[78:79], v49 offset:53952
    v_mfma_f32_16x16x32_bf16 v[108:111], a[84:87], a[48:51], v[108:111]
    s_cmp_lt_u32 s52, 23
    s_cbranch_scc1 L_sequential_preLN__sliding_local_dilated__mixer_s_mlp__prompt_kernel_lws_241
L_sequential_preLN__sliding_local_dilated__mixer_s_mlp__prompt_kernel_lwb_240:
    ds_read_b64_tr_b16 a[80:81], v50 offset:24576
    v_mfma_f32_16x16x32_bf16 v[136:139], a[84:87], a[52:55], v[136:139]
    ds_read_b64_tr_b16 a[82:83], v50 offset:28160
    v_mfma_f32_16x16x32_bf16 v[112:115], a[88:91], a[48:51], v[112:115]
    ds_read_b64_tr_b16 a[84:85], v50 offset:24608
    v_mfma_f32_16x16x32_bf16 v[140:143], a[88:91], a[52:55], v[140:143]
    ds_read_b64_tr_b16 a[86:87], v50 offset:28192
    s_waitcnt vmcnt(10) lgkmcnt(10)
    v_mfma_f32_16x16x32_bf16 v[88:91], a[92:95], a[0:3], v[88:91]
    ds_read_b64_tr_b16 a[88:89], v50 offset:24640
    v_mfma_f32_16x16x32_bf16 v[116:119], a[92:95], a[4:7], v[116:119]
    ds_read_b64_tr_b16 a[90:91], v50 offset:28224
    v_mfma_f32_16x16x32_bf16 v[92:95], a[56:59], a[0:3], v[92:95]
    ds_read_b64_tr_b16 a[92:93], v50 offset:24672
    v_mfma_f32_16x16x32_bf16 v[120:123], a[56:59], a[4:7], v[120:123]
    ds_read_b64_tr_b16 a[94:95], v50 offset:28256
    s_mov_b32 s66, 0x3400
    buffer_load_dwordx4 a[48:51], v52, s[48:51], s66 offen sc1
    s_mov_b32 s66, 0x7400
    buffer_load_dwordx4 a[52:55], v52, s[48:51], s66 offen sc1
    v_mfma_f32_16x16x32_bf16 v[96:99], a[60:63], a[0:3], v[96:99]
    ds_read_b64_tr_b16 a[56:57], v50 offset:24704
    v_mfma_f32_16x16x32_bf16 v[124:127], a[60:63], a[4:7], v[124:127]
    ds_read_b64_tr_b16 a[58:59], v50 offset:28288
    v_mfma_f32_16x16x32_bf16 v[100:103], a[64:67], a[0:3], v[100:103]
    ds_read_b64_tr_b16 a[60:61], v50 offset:24736
    v_mfma_f32_16x16x32_bf16 v[128:131], a[64:67], a[4:7], v[128:131]
    ds_read_b64_tr_b16 a[62:63], v50 offset:28320
    s_waitcnt lgkmcnt(12)
    v_mfma_f32_16x16x32_bf16 v[104:107], a[68:71], a[0:3], v[104:107]
    ds_read_b64_tr_b16 a[64:65], v50 offset:24768
    v_mfma_f32_16x16x32_bf16 v[132:135], a[68:71], a[4:7], v[132:135]
    ds_read_b64_tr_b16 a[66:67], v50 offset:28352
    v_mfma_f32_16x16x32_bf16 v[108:111], a[72:75], a[0:3], v[108:111]
    ds_read_b64_tr_b16 a[68:69], v50 offset:31744
    v_mfma_f32_16x16x32_bf16 v[136:139], a[72:75], a[4:7], v[136:139]
    ds_read_b64_tr_b16 a[70:71], v50 offset:35328
    v_mfma_f32_16x16x32_bf16 v[112:115], a[76:79], a[0:3], v[112:115]
    ds_read_b64_tr_b16 a[72:73], v50 offset:31776
    v_mfma_f32_16x16x32_bf16 v[140:143], a[76:79], a[4:7], v[140:143]
    ds_read_b64_tr_b16 a[74:75], v50 offset:35360
    v_mov_b32 v12, 22
    s_mov_b64 exec, 1
    ds_max_u32 v5, v12 offset:16
    s_mov_b64 exec, -1
    s_waitcnt vmcnt(10) lgkmcnt(11)
    v_mfma_f32_16x16x32_bf16 v[88:91], a[80:83], a[8:11], v[88:91]
    ds_read_b64_tr_b16 a[76:77], v50 offset:31808
    v_mfma_f32_16x16x32_bf16 v[116:119], a[80:83], a[12:15], v[116:119]
    ds_read_b64_tr_b16 a[78:79], v50 offset:35392
    v_mfma_f32_16x16x32_bf16 v[92:95], a[84:87], a[8:11], v[92:95]
    ds_read_b64_tr_b16 a[80:81], v50 offset:31840
    v_mfma_f32_16x16x32_bf16 v[120:123], a[84:87], a[12:15], v[120:123]
    ds_read_b64_tr_b16 a[82:83], v50 offset:35424
    s_mov_b32 s66, 0x3800
    buffer_load_dwordx4 a[0:3], v52, s[48:51], s66 offen sc1
    s_mov_b32 s66, 0x7800
    buffer_load_dwordx4 a[4:7], v52, s[48:51], s66 offen sc1
    v_mfma_f32_16x16x32_bf16 v[96:99], a[88:91], a[8:11], v[96:99]
    ds_read_b64_tr_b16 a[84:85], v50 offset:31872
    v_mfma_f32_16x16x32_bf16 v[124:127], a[88:91], a[12:15], v[124:127]
    ds_read_b64_tr_b16 a[86:87], v50 offset:35456
    v_mfma_f32_16x16x32_bf16 v[100:103], a[92:95], a[8:11], v[100:103]
    ds_read_b64_tr_b16 a[88:89], v50 offset:31904
    v_mfma_f32_16x16x32_bf16 v[128:131], a[92:95], a[12:15], v[128:131]
    ds_read_b64_tr_b16 a[90:91], v50 offset:35488
    s_waitcnt lgkmcnt(13)
    v_mfma_f32_16x16x32_bf16 v[104:107], a[56:59], a[8:11], v[104:107]
    ds_read_b64_tr_b16 a[92:93], v50 offset:31936
    v_mfma_f32_16x16x32_bf16 v[132:135], a[56:59], a[12:15], v[132:135]
    ds_read_b64_tr_b16 a[94:95], v50 offset:35520
    v_mfma_f32_16x16x32_bf16 v[108:111], a[60:63], a[8:11], v[108:111]
    ds_read_b64_tr_b16 a[56:57], v50 offset:38912
    v_mfma_f32_16x16x32_bf16 v[136:139], a[60:63], a[12:15], v[136:139]
    ds_read_b64_tr_b16 a[58:59], v50 offset:42496
    v_mfma_f32_16x16x32_bf16 v[112:115], a[64:67], a[8:11], v[112:115]
    ds_read_b64_tr_b16 a[60:61], v50 offset:38944
    v_mfma_f32_16x16x32_bf16 v[140:143], a[64:67], a[12:15], v[140:143]
    ds_read_b64_tr_b16 a[62:63], v50 offset:42528
    s_waitcnt vmcnt(10) lgkmcnt(10)
    v_mfma_f32_16x16x32_bf16 v[88:91], a[68:71], a[16:19], v[88:91]
    ds_read_b64_tr_b16 a[64:65], v50 offset:38976
    v_mfma_f32_16x16x32_bf16 v[116:119], a[68:71], a[20:23], v[116:119]
    ds_read_b64_tr_b16 a[66:67], v50 offset:42560
    v_mfma_f32_16x16x32_bf16 v[92:95], a[72:75], a[16:19], v[92:95]
    ds_read_b64_tr_b16 a[68:69], v50 offset:39008
    v_mfma_f32_16x16x32_bf16 v[120:123], a[72:75], a[20:23], v[120:123]
    ds_read_b64_tr_b16 a[70:71], v50 offset:42592
    s_mov_b32 s66, 0x3c00
    buffer_load_dwordx4 a[8:11], v52, s[48:51], s66 offen sc1
    s_mov_b32 s66, 0x7c00
    buffer_load_dwordx4 a[12:15], v52, s[48:51], s66 offen sc1
    v_mfma_f32_16x16x32_bf16 v[96:99], a[76:79], a[16:19], v[96:99]
    ds_read_b64_tr_b16 a[72:73], v50 offset:39040
    v_mfma_f32_16x16x32_bf16 v[124:127], a[76:79], a[20:23], v[124:127]
    ds_read_b64_tr_b16 a[74:75], v50 offset:42624
    v_mfma_f32_16x16x32_bf16 v[100:103], a[80:83], a[16:19], v[100:103]
    ds_read_b64_tr_b16 a[76:77], v50 offset:39072
    v_mfma_f32_16x16x32_bf16 v[128:131], a[80:83], a[20:23], v[128:131]
    ds_read_b64_tr_b16 a[78:79], v50 offset:42656
    s_waitcnt lgkmcnt(12)
    v_mfma_f32_16x16x32_bf16 v[104:107], a[84:87], a[16:19], v[104:107]
    ds_read_b64_tr_b16 a[80:81], v50 offset:39104
    v_mfma_f32_16x16x32_bf16 v[132:135], a[84:87], a[20:23], v[132:135]
    ds_read_b64_tr_b16 a[82:83], v50 offset:42688
    v_mfma_f32_16x16x32_bf16 v[108:111], a[88:91], a[16:19], v[108:111]
    ds_read_b64_tr_b16 a[84:85], v50 offset:46080
    v_mfma_f32_16x16x32_bf16 v[136:139], a[88:91], a[20:23], v[136:139]
    ds_read_b64_tr_b16 a[86:87], v50 offset:49664
    s_cmp_ge_u32 s52, 24
    s_cbranch_scc0 L_sequential_preLN__sliding_local_dilated__mixer_s_mlp__prompt_kernel_nopeek_242_d
L_sequential_preLN__sliding_local_dilated__mixer_s_mlp__prompt_kernel_nopeek_242:
    v_mfma_f32_16x16x32_bf16 v[112:115], a[92:95], a[16:19], v[112:115]
    ds_read_b64_tr_b16 a[88:89], v50 offset:46112
    v_mfma_f32_16x16x32_bf16 v[140:143], a[92:95], a[20:23], v[140:143]
    ds_read_b64_tr_b16 a[90:91], v50 offset:49696
    s_waitcnt vmcnt(10) lgkmcnt(10)
    v_mfma_f32_16x16x32_bf16 v[88:91], a[56:59], a[24:27], v[88:91]
    ds_read_b64_tr_b16 a[92:93], v50 offset:46144
    v_mfma_f32_16x16x32_bf16 v[116:119], a[56:59], a[28:31], v[116:119]
    ds_read_b64_tr_b16 a[94:95], v50 offset:49728
    v_mfma_f32_16x16x32_bf16 v[92:95], a[60:63], a[24:27], v[92:95]
    ds_read_b64_tr_b16 a[56:57], v50 offset:46176
    v_mfma_f32_16x16x32_bf16 v[120:123], a[60:63], a[28:31], v[120:123]
    ds_read_b64_tr_b16 a[58:59], v50 offset:49760
    s_mov_b32 s66, 0xfa0000
    buffer_load_dwordx2 v[72:73], v53, s[48:51], s66 offen offset:0 sc1
    v_mfma_f32_16x16x32_bf16 v[96:99], a[64:67], a[24:27], v[96:99]
    ds_read_b64_tr_b16 a[60:61], v50 offset:46208
    v_mfma_f32_16x16x32_bf16 v[124:127], a[64:67], a[28:31], v[124:127]
    ds_read_b64_tr_b16 a[62:63], v50 offset:49792
    v_mfma_f32_16x16x32_bf16 v[100:103], a[68:71], a[24:27], v[100:103]
    ds_read_b64_tr_b16 a[64:65], v50 offset:46240
    v_mfma_f32_16x16x32_bf16 v[128:131], a[68:71], a[28:31], v[128:131]
    ds_read_b64_tr_b16 a[66:67], v50 offset:49824
    s_waitcnt lgkmcnt(12)
    v_mfma_f32_16x16x32_bf16 v[104:107], a[72:75], a[24:27], v[104:107]
    ds_read_b64_tr_b16 a[68:69], v50 offset:46272
    v_mfma_f32_16x16x32_bf16 v[132:135], a[72:75], a[28:31], v[132:135]
    ds_read_b64_tr_b16 a[70:71], v50 offset:49856
    s_mov_b32 s66, 0xfa4000
    buffer_load_dwordx2 v[74:75], v53, s[48:51], s66 offen offset:0 sc1
    v_mfma_f32_16x16x32_bf16 v[108:111], a[76:79], a[24:27], v[108:111]
    s_cmp_lt_u32 s52, 24
    s_cbranch_scc1 L_sequential_preLN__sliding_local_dilated__mixer_s_mlp__prompt_kernel_lws_244
L_sequential_preLN__sliding_local_dilated__mixer_s_mlp__prompt_kernel_lwb_243:
    ds_read_b64_tr_b16 a[72:73], v51 offset:20480
    v_mfma_f32_16x16x32_bf16 v[136:139], a[76:79], a[28:31], v[136:139]
    ds_read_b64_tr_b16 a[74:75], v51 offset:24064
    v_mfma_f32_16x16x32_bf16 v[112:115], a[80:83], a[24:27], v[112:115]
    ds_read_b64_tr_b16 a[76:77], v51 offset:20512
    v_mfma_f32_16x16x32_bf16 v[140:143], a[80:83], a[28:31], v[140:143]
    ds_read_b64_tr_b16 a[78:79], v51 offset:24096
    s_waitcnt vmcnt(10) lgkmcnt(10)
    v_mfma_f32_16x16x32_bf16 v[88:91], a[84:87], a[32:35], v[88:91]
    ds_read_b64_tr_b16 a[80:81], v51 offset:20544
    v_mfma_f32_16x16x32_bf16 v[116:119], a[84:87], a[36:39], v[116:119]
    ds_read_b64_tr_b16 a[82:83], v51 offset:24128
    v_mfma_f32_16x16x32_bf16 v[92:95], a[88:91], a[32:35], v[92:95]
    ds_read_b64_tr_b16 a[84:85], v51 offset:20576
    v_mfma_f32_16x16x32_bf16 v[120:123], a[88:91], a[36:39], v[120:123]
    ds_read_b64_tr_b16 a[86:87], v51 offset:24160
    s_mov_b32 s66, 0xfa0000
    buffer_load_dwordx2 v[78:79], v53, s[48:51], s66 offen offset:128 sc1
    v_mfma_f32_16x16x32_bf16 v[96:99], a[92:95], a[32:35], v[96:99]
    ds_read_b64_tr_b16 a[88:89], v51 offset:20608
    v_mfma_f32_16x16x32_bf16 v[124:127], a[92:95], a[36:39], v[124:127]
    ds_read_b64_tr_b16 a[90:91], v51 offset:24192
    v_mfma_f32_16x16x32_bf16 v[100:103], a[56:59], a[32:35], v[100:103]
    ds_read_b64_tr_b16 a[92:93], v51 offset:20640
    v_mfma_f32_16x16x32_bf16 v[128:131], a[56:59], a[36:39], v[128:131]
    ds_read_b64_tr_b16 a[94:95], v51 offset:24224
    s_waitcnt lgkmcnt(12)
    v_mfma_f32_16x16x32_bf16 v[104:107], a[60:63], a[32:35], v[104:107]
    ds_read_b64_tr_b16 a[56:57], v51 offset:20672
    v_mfma_f32_16x16x32_bf16 v[132:135], a[60:63], a[36:39], v[132:135]
    ds_read_b64_tr_b16 a[58:59], v51 offset:24256
    s_mov_b32 s66, 0xfa4000
    buffer_load_dwordx2 v[80:81], v53, s[48:51], s66 offen offset:128 sc1
    v_mfma_f32_16x16x32_bf16 v[108:111], a[64:67], a[32:35], v[108:111]
    ds_read_b64_tr_b16 a[60:61], v51 offset:27648
    v_mfma_f32_16x16x32_bf16 v[136:139], a[64:67], a[36:39], v[136:139]
    ds_read_b64_tr_b16 a[62:63], v51 offset:31232
    v_mfma_f32_16x16x32_bf16 v[112:115], a[68:71], a[32:35], v[112:115]
    ds_read_b64_tr_b16 a[64:65], v51 offset:27680
    v_mfma_f32_16x16x32_bf16 v[140:143], a[68:71], a[36:39], v[140:143]
    ds_read_b64_tr_b16 a[66:67], v51 offset:31264
    v_mov_b32 v12, 23
    s_mov_b64 exec, 1
    ds_max_u32 v5, v12 offset:16
    s_mov_b64 exec, -1
    s_waitcnt vmcnt(10) lgkmcnt(11)
    v_mfma_f32_16x16x32_bf16 v[88:91], a[72:75], a[40:43], v[88:91]
    ds_read_b64_tr_b16 a[68:69], v51 offset:27712
    v_mfma_f32_16x16x32_bf16 v[116:119], a[72:75], a[44:47], v[116:119]
    ds_read_b64_tr_b16 a[70:71], v51 offset:31296
    v_mfma_f32_16x16x32_bf16 v[92:95], a[76:79], a[40:43], v[92:95]
    ds_read_b64_tr_b16 a[72:73], v51 offset:27744
    v_mfma_f32_16x16x32_bf16 v[120:123], a[76:79], a[44:47], v[120:123]
    ds_read_b64_tr_b16 a[74:75], v51 offset:31328
    v_mfma_f32_16x16x32_bf16 v[96:99], a[80:83], a[40:43], v[96:99]
    ds_read_b64_tr_b16 a[76:77], v51 offset:27776
    v_mfma_f32_16x16x32_bf16 v[124:127], a[80:83], a[44:47], v[124:127]
    ds_read_b64_tr_b16 a[78:79], v51 offset:31360
    v_mfma_f32_16x16x32_bf16 v[100:103], a[84:87], a[40:43], v[100:103]
    ds_read_b64_tr_b16 a[80:81], v51 offset:27808
    v_mfma_f32_16x16x32_bf16 v[128:131], a[84:87], a[44:47], v[128:131]
    ds_read_b64_tr_b16 a[82:83], v51 offset:31392
    s_waitcnt lgkmcnt(13)
    v_mfma_f32_16x16x32_bf16 v[104:107], a[88:91], a[40:43], v[104:107]
    ds_read_b64_tr_b16 a[84:85], v51 offset:27840
    v_mfma_f32_16x16x32_bf16 v[132:135], a[88:91], a[44:47], v[132:135]
    ds_read_b64_tr_b16 a[86:87], v51 offset:31424
    v_mfma_f32_16x16x32_bf16 v[108:111], a[92:95], a[40:43], v[108:111]
    ds_read_b64_tr_b16 a[88:89], v51 offset:34816
    v_mfma_f32_16x16x32_bf16 v[136:139], a[92:95], a[44:47], v[136:139]
    ds_read_b64_tr_b16 a[90:91], v51 offset:38400
    v_mfma_f32_16x16x32_bf16 v[112:115], a[56:59], a[40:43], v[112:115]
    ds_read_b64_tr_b16 a[92:93], v51 offset:34848
    v_mfma_f32_16x16x32_bf16 v[140:143], a[56:59], a[44:47], v[140:143]
    ds_read_b64_tr_b16 a[94:95], v51 offset:38432
    s_waitcnt vmcnt(8) lgkmcnt(10)
    v_mfma_f32_16x16x32_bf16 v[88:91], a[60:63], a[48:51], v[88:91]
    ds_read_b64_tr_b16 a[56:57], v51 offset:34880
    v_mfma_f32_16x16x32_bf16 v[116:119], a[60:63], a[52:55], v[116:119]
    ds_read_b64_tr_b16 a[58:59], v51 offset:38464
    v_mfma_f32_16x16x32_bf16 v[92:95], a[64:67], a[48:51], v[92:95]
    ds_read_b64_tr_b16 a[60:61], v51 offset:34912
    v_mfma_f32_16x16x32_bf16 v[120:123], a[64:67], a[52:55], v[120:123]
    ds_read_b64_tr_b16 a[62:63], v51 offset:38496
    v_mfma_f32_16x16x32_bf16 v[96:99], a[68:71], a[48:51], v[96:99]
    ds_read_b64_tr_b16 a[64:65], v51 offset:34944
    v_mfma_f32_16x16x32_bf16 v[124:127], a[68:71], a[52:55], v[124:127]
    ds_read_b64_tr_b16 a[66:67], v51 offset:38528
    v_mfma_f32_16x16x32_bf16 v[100:103], a[72:75], a[48:51], v[100:103]
    ds_read_b64_tr_b16 a[68:69], v51 offset:34976
    v_mfma_f32_16x16x32_bf16 v[128:131], a[72:75], a[52:55], v[128:131]
    ds_read_b64_tr_b16 a[70:71], v51 offset:38560
    s_waitcnt lgkmcnt(12)
    v_mfma_f32_16x16x32_bf16 v[104:107], a[76:79], a[48:51], v[104:107]
    ds_read_b64_tr_b16 a[72:73], v51 offset:35008
    v_mfma_f32_16x16x32_bf16 v[132:135], a[76:79], a[52:55], v[132:135]
    ds_read_b64_tr_b16 a[74:75], v51 offset:38592
    v_mfma_f32_16x16x32_bf16 v[108:111], a[80:83], a[48:51], v[108:111]
    ds_read_b64_tr_b16 a[76:77], v51 offset:41984
    v_mfma_f32_16x16x32_bf16 v[136:139], a[80:83], a[52:55], v[136:139]
    ds_read_b64_tr_b16 a[78:79], v51 offset:45568
    v_mfma_f32_16x16x32_bf16 v[112:115], a[84:87], a[48:51], v[112:115]
    ds_read_b64_tr_b16 a[80:81], v51 offset:42016
    v_mfma_f32_16x16x32_bf16 v[140:143], a[84:87], a[52:55], v[140:143]
    ds_read_b64_tr_b16 a[82:83], v51 offset:45600
    s_waitcnt vmcnt(6) lgkmcnt(10)
    v_mfma_f32_16x16x32_bf16 v[88:91], a[88:91], a[0:3], v[88:91]
    ds_read_b64_tr_b16 a[84:85], v51 offset:42048
    v_mfma_f32_16x16x32_bf16 v[116:119], a[88:91], a[4:7], v[116:119]
    ds_read_b64_tr_b16 a[86:87], v51 offset:45632
    v_mfma_f32_16x16x32_bf16 v[92:95], a[92:95], a[0:3], v[92:95]
    ds_read_b64_tr_b16 a[88:89], v51 offset:42080
    v_mfma_f32_16x16x32_bf16 v[120:123], a[92:95], a[4:7], v[120:123]
    ds_read_b64_tr_b16 a[90:91], v51 offset:45664
    v_mfma_f32_16x16x32_bf16 v[96:99], a[56:59], a[0:3], v[96:99]
    ds_read_b64_tr_b16 a[92:93], v51 offset:42112
    v_mfma_f32_16x16x32_bf16 v[124:127], a[56:59], a[4:7], v[124:127]
    ds_read_b64_tr_b16 a[94:95], v51 offset:45696
    v_mfma_f32_16x16x32_bf16 v[100:103], a[60:63], a[0:3], v[100:103]
    ds_read_b64_tr_b16 a[56:57], v51 offset:42144
    v_mfma_f32_16x16x32_bf16 v[128:131], a[60:63], a[4:7], v[128:131]
    ds_read_b64_tr_b16 a[58:59], v51 offset:45728
    s_waitcnt lgkmcnt(12)
    v_mfma_f32_16x16x32_bf16 v[104:107], a[64:67], a[0:3], v[104:107]
    ds_read_b64_tr_b16 a[60:61], v51 offset:42176
    v_mfma_f32_16x16x32_bf16 v[132:135], a[64:67], a[4:7], v[132:135]
    ds_read_b64_tr_b16 a[62:63], v51 offset:45760
    v_mfma_f32_16x16x32_bf16 v[108:111], a[68:71], a[0:3], v[108:111]
    v_mfma_f32_16x16x32_bf16 v[136:139], a[68:71], a[4:7], v[136:139]
    v_mfma_f32_16x16x32_bf16 v[112:115], a[72:75], a[0:3], v[112:115]
    v_mfma_f32_16x16x32_bf16 v[140:143], a[72:75], a[4:7], v[140:143]
    s_waitcnt vmcnt(4) lgkmcnt(6)
    v_mfma_f32_16x16x32_bf16 v[88:91], a[76:79], a[8:11], v[88:91]
    v_mfma_f32_16x16x32_bf16 v[116:119], a[76:79], a[12:15], v[116:119]
    v_mfma_f32_16x16x32_bf16 v[92:95], a[80:83], a[8:11], v[92:95]
    v_mfma_f32_16x16x32_bf16 v[120:123], a[80:83], a[12:15], v[120:123]
    s_cmp_lt_u32 s53, 3
    s_cbranch_scc1 L_sequential_preLN__sliding_local_dilated__mixer_s_mlp__prompt_kernel_lws_246
L_sequential_preLN__sliding_local_dilated__mixer_s_mlp__prompt_kernel_lwb_245:
    ds_read_b128 v[64:67], v26 offset:768
    ds_read_b128 v[68:71], v26 offset:832
    v_mfma_f32_16x16x32_bf16 v[96:99], a[84:87], a[8:11], v[96:99]
    v_mfma_f32_16x16x32_bf16 v[124:127], a[84:87], a[12:15], v[124:127]
    v_mfma_f32_16x16x32_bf16 v[100:103], a[88:91], a[8:11], v[100:103]
    v_mfma_f32_16x16x32_bf16 v[128:131], a[88:91], a[12:15], v[128:131]
    s_waitcnt lgkmcnt(2)
    v_mfma_f32_16x16x32_bf16 v[104:107], a[92:95], a[8:11], v[104:107]
    v_mfma_f32_16x16x32_bf16 v[132:135], a[92:95], a[12:15], v[132:135]
    v_mfma_f32_16x16x32_bf16 v[108:111], a[56:59], a[8:11], v[108:111]
    v_mfma_f32_16x16x32_bf16 v[136:139], a[56:59], a[12:15], v[136:139]
    v_mfma_f32_16x16x32_bf16 v[112:115], a[60:63], a[8:11], v[112:115]
    v_mfma_f32_16x16x32_bf16 v[140:143], a[60:63], a[12:15], v[140:143]
    v_mov_b32 v12, 24
    s_mov_b64 exec, 1
    ds_max_u32 v5, v12 offset:16
    s_mov_b64 exec, -1
    s_waitcnt vmcnt(0)
    v_pk_add_f32 v[72:73], v[72:73], v[74:75]
    v_mov_b32 v74, v72
    v_mov_b32 v75, v73
    s_nop 0
    v_permlane32_swap_b32 v72, v74
    v_permlane32_swap_b32 v73, v75
    s_nop 0
    v_pk_add_f32 v[72:73], v[72:73], v[74:75]
    v_mov_b32 v74, v72
    v_mov_b32 v75, v73
    s_nop 0
    v_permlane16_swap_b32 v72, v74
    v_permlane16_swap_b32 v73, v75
    s_nop 0
    v_pk_add_f32 v[72:73], v[72:73], v[74:75]
    v_mul_f32 v72, 0xbb000000, v72
    v_mul_f32 v76, 0x3b000000, v73
    v_fma_f32 v76, -v72, v72, v76
    v_max_f32 v76, 0, v76
    v_add_f32 v73, 0x3727c5ac, v76
    v_rsq_f32 v73, v73
    s_nop 0
    v_rcp_f32 v76, v73
    v_mul_f32 v74, v73, v73
    v_mul_f32 v75, 0xc0135761, v73
    v_mul_f32 v74, v74, v75
    v_mul_f32 v74, 0x3d372713, v74
    v_pk_add_f32 v[78:79], v[78:79], v[80:81]
    v_mov_b32 v80, v78
    v_mov_b32 v81, v79
    s_nop 0
    v_permlane32_swap_b32 v78, v80
    v_permlane32_swap_b32 v79, v81
    s_nop 0
    v_pk_add_f32 v[78:79], v[78:79], v[80:81]
    v_mov_b32 v80, v78
    v_mov_b32 v81, v79
    s_nop 0
    v_permlane16_swap_b32 v78, v80
    v_permlane16_swap_b32 v79, v81
    s_nop 0
    v_pk_add_f32 v[78:79], v[78:79], v[80:81]
    v_mul_f32 v78, 0xbb000000, v78
    v_mul_f32 v82, 0x3b000000, v79
    v_fma_f32 v82, -v78, v78, v82
    v_max_f32 v82, 0, v82
    v_add_f32 v79, 0x3727c5ac, v82
    v_rsq_f32 v79, v79
    s_nop 0
    v_rcp_f32 v82, v79
    v_mul_f32 v80, v79, v79
    v_mul_f32 v81, 0xc0135761, v79
    v_mul_f32 v80, v80, v81
    v_mul_f32 v80, 0x3d372713, v80
    s_add_u32 s66, s15, 0xe000
    s_waitcnt lgkmcnt(0)
    v_pk_fma_f32 v[88:89], v[64:65], v[72:73], v[88:89] op_sel_hi:[1,0,1]
    v_pk_fma_f32 v[90:91], v[66:67], v[72:73], v[90:91] op_sel_hi:[1,0,1]
    v_pk_fma_f32 v[92:93], v[68:69], v[72:73], v[92:93] op_sel_hi:[1,0,1]
    v_pk_fma_f32 v[94:95], v[70:71], v[72:73], v[94:95] op_sel_hi:[1,0,1]
    v_pk_fma_f32 v[116:117], v[64:65], v[78:79], v[116:117] op_sel_hi:[1,0,1]
    v_pk_fma_f32 v[118:119], v[66:67], v[78:79], v[118:119] op_sel_hi:[1,0,1]
    v_pk_fma_f32 v[120:121], v[68:69], v[78:79], v[120:121] op_sel_hi:[1,0,1]
    v_pk_fma_f32 v[122:123], v[70:71], v[78:79], v[122:123] op_sel_hi:[1,0,1]
    ds_read_b128 v[64:67], v26 offset:896
    ds_read_b128 v[68:71], v26 offset:960
    v_pk_mul_f32 v[144:145], v[88:89], v[88:89]
    v_pk_mul_f32 v[146:147], v[90:91], v[90:91]
    v_pk_mul_f32 v[148:149], v[92:93], v[92:93]
    v_pk_mul_f32 v[150:151], v[94:95], v[94:95]
    v_pk_mul_f32 v[152:153], v[116:117], v[116:117]
    v_pk_mul_f32 v[154:155], v[118:119], v[118:119]
    v_pk_mul_f32 v[156:157], v[120:121], v[120:121]
    v_pk_mul_f32 v[158:159], v[122:123], v[122:123]
    v_pk_fma_f32 v[144:145], v[144:145], v[74:75], v[74:75] op_sel:[0,0,1] op_sel_hi:[1,0,1]
    v_pk_fma_f32 v[146:147], v[146:147], v[74:75], v[74:75] op_sel:[0,0,1] op_sel_hi:[1,0,1]
    v_pk_fma_f32 v[148:149], v[148:149], v[74:75], v[74:75] op_sel:[0,0,1] op_sel_hi:[1,0,1]
    v_pk_fma_f32 v[150:151], v[150:151], v[74:75], v[74:75] op_sel:[0,0,1] op_sel_hi:[1,0,1]
    v_pk_fma_f32 v[152:153], v[152:153], v[80:81], v[80:81] op_sel:[0,0,1] op_sel_hi:[1,0,1]
    v_pk_fma_f32 v[154:155], v[154:155], v[80:81], v[80:81] op_sel:[0,0,1] op_sel_hi:[1,0,1]
    v_pk_fma_f32 v[156:157], v[156:157], v[80:81], v[80:81] op_sel:[0,0,1] op_sel_hi:[1,0,1]
    v_pk_fma_f32 v[158:159], v[158:159], v[80:81], v[80:81] op_sel:[0,0,1] op_sel_hi:[1,0,1]
    v_pk_mul_f32 v[144:145], v[144:145], v[88:89]
    v_pk_mul_f32 v[146:147], v[146:147], v[90:91]
    v_pk_mul_f32 v[148:149], v[148:149], v[92:93]
    v_pk_mul_f32 v[150:151], v[150:151], v[94:95]
    v_pk_mul_f32 v[152:153], v[152:153], v[116:117]
    v_pk_mul_f32 v[154:155], v[154:155], v[118:119]
    v_pk_mul_f32 v[156:157], v[156:157], v[120:121]
    v_pk_mul_f32 v[158:159], v[158:159], v[122:123]
    v_exp_f32 v144, v144
    v_exp_f32 v145, v145
    v_exp_f32 v146, v146
    v_exp_f32 v147, v147
    v_exp_f32 v148, v148
    v_exp_f32 v149, v149
    v_exp_f32 v150, v150
    v_exp_f32 v151, v151
    v_exp_f32 v152, v152
    v_exp_f32 v153, v153
    v_exp_f32 v154, v154
    v_exp_f32 v155, v155
    v_exp_f32 v156, v156
    v_exp_f32 v157, v157
    v_exp_f32 v158, v158
    v_exp_f32 v159, v159
    s_nop 0
    v_pk_fma_f32 v[144:145], v[144:145], v[76:77], v[76:77] op_sel_hi:[1,0,0]
    v_pk_fma_f32 v[146:147], v[146:147], v[76:77], v[76:77] op_sel_hi:[1,0,0]
    v_pk_fma_f32 v[148:149], v[148:149], v[76:77], v[76:77] op_sel_hi:[1,0,0]
    v_pk_fma_f32 v[150:151], v[150:151], v[76:77], v[76:77] op_sel_hi:[1,0,0]
    v_pk_fma_f32 v[152:153], v[152:153], v[82:83], v[82:83] op_sel_hi:[1,0,0]
    v_pk_fma_f32 v[154:155], v[154:155], v[82:83], v[82:83] op_sel_hi:[1,0,0]
    v_pk_fma_f32 v[156:157], v[156:157], v[82:83], v[82:83] op_sel_hi:[1,0,0]
    v_pk_fma_f32 v[158:159], v[158:159], v[82:83], v[82:83] op_sel_hi:[1,0,0]
    v_rcp_f32 v144, v144
    v_rcp_f32 v145, v145
    v_rcp_f32 v146, v146
    v_rcp_f32 v147, v147
    v_rcp_f32 v148, v148
    v_rcp_f32 v149, v149
    v_rcp_f32 v150, v150
    v_rcp_f32 v151, v151
    v_rcp_f32 v152, v152
    v_rcp_f32 v153, v153
    v_rcp_f32 v154, v154
    v_rcp_f32 v155, v155
    v_rcp_f32 v156, v156
    v_rcp_f32 v157, v157
    v_rcp_f32 v158, v158
    v_rcp_f32 v159, v159
    s_nop 0
    v_pk_mul_f32 v[88:89], v[88:89], v[144:145]
    v_pk_mul_f32 v[90:91], v[90:91], v[146:147]
    v_pk_mul_f32 v[92:93], v[92:93], v[148:149]
    v_pk_mul_f32 v[94:95], v[94:95], v[150:151]
    v_pk_mul_f32 v[116:117], v[116:117], v[152:153]
    v_pk_mul_f32 v[118:119], v[118:119], v[154:155]
    v_pk_mul_f32 v[120:121], v[120:121], v[156:157]
    v_pk_mul_f32 v[122:123], v[122:123], v[158:159]
    v_cvt_pk_bf16_f32 v144, v88, v89
    v_cvt_pk_bf16_f32 v145, v90, v91
    v_cvt_pk_bf16_f32 v146, v92, v93
    v_cvt_pk_bf16_f32 v147, v94, v95
    v_cvt_pk_bf16_f32 v148, v116, v117
    v_cvt_pk_bf16_f32 v149, v118, v119
    v_cvt_pk_bf16_f32 v150, v120, v121
    v_cvt_pk_bf16_f32 v151, v122, v123
    buffer_store_dwordx4 v[144:147], v24, s[48:51], s15 offen offset:0 sc1
    buffer_store_dwordx4 v[148:151], v24, s[48:51], s66 offen offset:0 sc1
    s_waitcnt lgkmcnt(0)
    v_pk_fma_f32 v[96:97], v[64:65], v[72:73], v[96:97] op_sel_hi:[1,0,1]
    v_pk_fma_f32 v[98:99], v[66:67], v[72:73], v[98:99] op_sel_hi:[1,0,1]
    v_pk_fma_f32 v[100:101], v[68:69], v[72:73], v[100:101] op_sel_hi:[1,0,1]
    v_pk_fma_f32 v[102:103], v[70:71], v[72:73], v[102:103] op_sel_hi:[1,0,1]
    v_pk_fma_f32 v[124:125], v[64:65], v[78:79], v[124:125] op_sel_hi:[1,0,1]
    v_pk_fma_f32 v[126:127], v[66:67], v[78:79], v[126:127] op_sel_hi:[1,0,1]
    v_pk_fma_f32 v[128:129], v[68:69], v[78:79], v[128:129] op_sel_hi:[1,0,1]
    v_pk_fma_f32 v[130:131], v[70:71], v[78:79], v[130:131] op_sel_hi:[1,0,1]
    ds_read_b128 v[64:67], v26 offset:1024
    ds_read_b128 v[68:71], v26 offset:1088
    v_pk_mul_f32 v[144:145], v[96:97], v[96:97]
    v_pk_mul_f32 v[146:147], v[98:99], v[98:99]
    v_pk_mul_f32 v[148:149], v[100:101], v[100:101]
    v_pk_mul_f32 v[150:151], v[102:103], v[102:103]
    v_pk_mul_f32 v[152:153], v[124:125], v[124:125]
    v_pk_mul_f32 v[154:155], v[126:127], v[126:127]
    v_pk_mul_f32 v[156:157], v[128:129], v[128:129]
    v_pk_mul_f32 v[158:159], v[130:131], v[130:131]
    v_pk_fma_f32 v[144:145], v[144:145], v[74:75], v[74:75] op_sel:[0,0,1] op_sel_hi:[1,0,1]
    v_pk_fma_f32 v[146:147], v[146:147], v[74:75], v[74:75] op_sel:[0,0,1] op_sel_hi:[1,0,1]
    v_pk_fma_f32 v[148:149], v[148:149], v[74:75], v[74:75] op_sel:[0,0,1] op_sel_hi:[1,0,1]
    v_pk_fma_f32 v[150:151], v[150:151], v[74:75], v[74:75] op_sel:[0,0,1] op_sel_hi:[1,0,1]
    v_pk_fma_f32 v[152:153], v[152:153], v[80:81], v[80:81] op_sel:[0,0,1] op_sel_hi:[1,0,1]
    v_pk_fma_f32 v[154:155], v[154:155], v[80:81], v[80:81] op_sel:[0,0,1] op_sel_hi:[1,0,1]
    v_pk_fma_f32 v[156:157], v[156:157], v[80:81], v[80:81] op_sel:[0,0,1] op_sel_hi:[1,0,1]
    v_pk_fma_f32 v[158:159], v[158:159], v[80:81], v[80:81] op_sel:[0,0,1] op_sel_hi:[1,0,1]
    v_pk_mul_f32 v[144:145], v[144:145], v[96:97]
    v_pk_mul_f32 v[146:147], v[146:147], v[98:99]
    v_pk_mul_f32 v[148:149], v[148:149], v[100:101]
    v_pk_mul_f32 v[150:151], v[150:151], v[102:103]
    v_pk_mul_f32 v[152:153], v[152:153], v[124:125]
    v_pk_mul_f32 v[154:155], v[154:155], v[126:127]
    v_pk_mul_f32 v[156:157], v[156:157], v[128:129]
    v_pk_mul_f32 v[158:159], v[158:159], v[130:131]
    v_exp_f32 v144, v144
    v_exp_f32 v145, v145
    v_exp_f32 v146, v146
    v_exp_f32 v147, v147
    v_exp_f32 v148, v148
    v_exp_f32 v149, v149
    v_exp_f32 v150, v150
    v_exp_f32 v151, v151
    v_exp_f32 v152, v152
    v_exp_f32 v153, v153
    v_exp_f32 v154, v154
    v_exp_f32 v155, v155
    v_exp_f32 v156, v156
    v_exp_f32 v157, v157
    v_exp_f32 v158, v158
    v_exp_f32 v159, v159
    s_nop 0
    v_pk_fma_f32 v[144:145], v[144:145], v[76:77], v[76:77] op_sel_hi:[1,0,0]
    v_pk_fma_f32 v[146:147], v[146:147], v[76:77], v[76:77] op_sel_hi:[1,0,0]
    v_pk_fma_f32 v[148:149], v[148:149], v[76:77], v[76:77] op_sel_hi:[1,0,0]
    v_pk_fma_f32 v[150:151], v[150:151], v[76:77], v[76:77] op_sel_hi:[1,0,0]
    v_pk_fma_f32 v[152:153], v[152:153], v[82:83], v[82:83] op_sel_hi:[1,0,0]
    v_pk_fma_f32 v[154:155], v[154:155], v[82:83], v[82:83] op_sel_hi:[1,0,0]
    v_pk_fma_f32 v[156:157], v[156:157], v[82:83], v[82:83] op_sel_hi:[1,0,0]
    v_pk_fma_f32 v[158:159], v[158:159], v[82:83], v[82:83] op_sel_hi:[1,0,0]
    v_rcp_f32 v144, v144
    v_rcp_f32 v145, v145
    v_rcp_f32 v146, v146
    v_rcp_f32 v147, v147
    v_rcp_f32 v148, v148
    v_rcp_f32 v149, v149
    v_rcp_f32 v150, v150
    v_rcp_f32 v151, v151
    v_rcp_f32 v152, v152
    v_rcp_f32 v153, v153
    v_rcp_f32 v154, v154
    v_rcp_f32 v155, v155
    v_rcp_f32 v156, v156
    v_rcp_f32 v157, v157
    v_rcp_f32 v158, v158
    v_rcp_f32 v159, v159
    s_nop 0
    v_pk_mul_f32 v[96:97], v[96:97], v[144:145]
    v_pk_mul_f32 v[98:99], v[98:99], v[146:147]
    v_pk_mul_f32 v[100:101], v[100:101], v[148:149]
    v_pk_mul_f32 v[102:103], v[102:103], v[150:151]
    v_pk_mul_f32 v[124:125], v[124:125], v[152:153]
    v_pk_mul_f32 v[126:127], v[126:127], v[154:155]
    v_pk_mul_f32 v[128:129], v[128:129], v[156:157]
    v_pk_mul_f32 v[130:131], v[130:131], v[158:159]
    v_cvt_pk_bf16_f32 v144, v96, v97
    v_cvt_pk_bf16_f32 v145, v98, v99
    v_cvt_pk_bf16_f32 v146, v100, v101
    v_cvt_pk_bf16_f32 v147, v102, v103
    v_cvt_pk_bf16_f32 v148, v124, v125
    v_cvt_pk_bf16_f32 v149, v126, v127
    v_cvt_pk_bf16_f32 v150, v128, v129
    v_cvt_pk_bf16_f32 v151, v130, v131
    buffer_store_dwordx4 v[144:147], v24, s[48:51], s15 offen offset:1024 sc1
    buffer_store_dwordx4 v[148:151], v24, s[48:51], s66 offen offset:1024 sc1
    s_waitcnt lgkmcnt(0)
    v_pk_fma_f32 v[104:105], v[64:65], v[72:73], v[104:105] op_sel_hi:[1,0,1]
    v_pk_fma_f32 v[106:107], v[66:67], v[72:73], v[106:107] op_sel_hi:[1,0,1]
    v_pk_fma_f32 v[108:109], v[68:69], v[72:73], v[108:109] op_sel_hi:[1,0,1]
    v_pk_fma_f32 v[110:111], v[70:71], v[72:73], v[110:111] op_sel_hi:[1,0,1]
    v_pk_fma_f32 v[132:133], v[64:65], v[78:79], v[132:133] op_sel_hi:[1,0,1]
    v_pk_fma_f32 v[134:135], v[66:67], v[78:79], v[134:135] op_sel_hi:[1,0,1]
    v_pk_fma_f32 v[136:137], v[68:69], v[78:79], v[136:137] op_sel_hi:[1,0,1]
    v_pk_fma_f32 v[138:139], v[70:71], v[78:79], v[138:139] op_sel_hi:[1,0,1]
    ds_read_b128 v[64:67], v26 offset:1152
    v_pk_mul_f32 v[144:145], v[104:105], v[104:105]
    v_pk_mul_f32 v[146:147], v[106:107], v[106:107]
    v_pk_mul_f32 v[148:149], v[108:109], v[108:109]
    v_pk_mul_f32 v[150:151], v[110:111], v[110:111]
    v_pk_mul_f32 v[152:153], v[132:133], v[132:133]
    v_pk_mul_f32 v[154:155], v[134:135], v[134:135]
    v_pk_mul_f32 v[156:157], v[136:137], v[136:137]
    v_pk_mul_f32 v[158:159], v[138:139], v[138:139]
    v_pk_fma_f32 v[144:145], v[144:145], v[74:75], v[74:75] op_sel:[0,0,1] op_sel_hi:[1,0,1]
    v_pk_fma_f32 v[146:147], v[146:147], v[74:75], v[74:75] op_sel:[0,0,1] op_sel_hi:[1,0,1]
    v_pk_fma_f32 v[148:149], v[148:149], v[74:75], v[74:75] op_sel:[0,0,1] op_sel_hi:[1,0,1]
    v_pk_fma_f32 v[150:151], v[150:151], v[74:75], v[74:75] op_sel:[0,0,1] op_sel_hi:[1,0,1]
    v_pk_fma_f32 v[152:153], v[152:153], v[80:81], v[80:81] op_sel:[0,0,1] op_sel_hi:[1,0,1]
    v_pk_fma_f32 v[154:155], v[154:155], v[80:81], v[80:81] op_sel:[0,0,1] op_sel_hi:[1,0,1]
    v_pk_fma_f32 v[156:157], v[156:157], v[80:81], v[80:81] op_sel:[0,0,1] op_sel_hi:[1,0,1]
    v_pk_fma_f32 v[158:159], v[158:159], v[80:81], v[80:81] op_sel:[0,0,1] op_sel_hi:[1,0,1]
    v_pk_mul_f32 v[144:145], v[144:145], v[104:105]
    v_pk_mul_f32 v[146:147], v[146:147], v[106:107]
    v_pk_mul_f32 v[148:149], v[148:149], v[108:109]
    v_pk_mul_f32 v[150:151], v[150:151], v[110:111]
    v_pk_mul_f32 v[152:153], v[152:153], v[132:133]
    v_pk_mul_f32 v[154:155], v[154:155], v[134:135]
    v_pk_mul_f32 v[156:157], v[156:157], v[136:137]
    v_pk_mul_f32 v[158:159], v[158:159], v[138:139]
    v_exp_f32 v144, v144
    v_exp_f32 v145, v145
    v_exp_f32 v146, v146
    v_exp_f32 v147, v147
    v_exp_f32 v148, v148
    v_exp_f32 v149, v149
    v_exp_f32 v150, v150
    v_exp_f32 v151, v151
    v_exp_f32 v152, v152
    v_exp_f32 v153, v153
    v_exp_f32 v154, v154
    v_exp_f32 v155, v155
    v_exp_f32 v156, v156
    v_exp_f32 v157, v157
    v_exp_f32 v158, v158
    v_exp_f32 v159, v159
    s_nop 0
    v_pk_fma_f32 v[144:145], v[144:145], v[76:77], v[76:77] op_sel_hi:[1,0,0]
    v_pk_fma_f32 v[146:147], v[146:147], v[76:77], v[76:77] op_sel_hi:[1,0,0]
    v_pk_fma_f32 v[148:149], v[148:149], v[76:77], v[76:77] op_sel_hi:[1,0,0]
    v_pk_fma_f32 v[150:151], v[150:151], v[76:77], v[76:77] op_sel_hi:[1,0,0]
    v_pk_fma_f32 v[152:153], v[152:153], v[82:83], v[82:83] op_sel_hi:[1,0,0]
    v_pk_fma_f32 v[154:155], v[154:155], v[82:83], v[82:83] op_sel_hi:[1,0,0]
    v_pk_fma_f32 v[156:157], v[156:157], v[82:83], v[82:83] op_sel_hi:[1,0,0]
    v_pk_fma_f32 v[158:159], v[158:159], v[82:83], v[82:83] op_sel_hi:[1,0,0]
    v_rcp_f32 v144, v144
    v_rcp_f32 v145, v145
    v_rcp_f32 v146, v146
    v_rcp_f32 v147, v147
    v_rcp_f32 v148, v148
    v_rcp_f32 v149, v149
    v_rcp_f32 v150, v150
    v_rcp_f32 v151, v151
    v_rcp_f32 v152, v152
    v_rcp_f32 v153, v153
    v_rcp_f32 v154, v154
    v_rcp_f32 v155, v155
    v_rcp_f32 v156, v156
    v_rcp_f32 v157, v157
    v_rcp_f32 v158, v158
    v_rcp_f32 v159, v159
    s_nop 0
    v_pk_mul_f32 v[104:105], v[104:105], v[144:145]
    v_pk_mul_f32 v[106:107], v[106:107], v[146:147]
    v_pk_mul_f32 v[108:109], v[108:109], v[148:149]
    v_pk_mul_f32 v[110:111], v[110:111], v[150:151]
    v_pk_mul_f32 v[132:133], v[132:133], v[152:153]
    v_pk_mul_f32 v[134:135], v[134:135], v[154:155]
    v_pk_mul_f32 v[136:137], v[136:137], v[156:157]
    v_pk_mul_f32 v[138:139], v[138:139], v[158:159]
    v_cvt_pk_bf16_f32 v144, v104, v105
    v_cvt_pk_bf16_f32 v145, v106, v107
    v_cvt_pk_bf16_f32 v146, v108, v109
    v_cvt_pk_bf16_f32 v147, v110, v111
    v_cvt_pk_bf16_f32 v148, v132, v133
    v_cvt_pk_bf16_f32 v149, v134, v135
    v_cvt_pk_bf16_f32 v150, v136, v137
    v_cvt_pk_bf16_f32 v151, v138, v139
    s_cmp_eq_u32 s36, 0
    s_cbranch_scc1 L_sequential_preLN__sliding_local_dilated__mixer_s_mlp__prompt_kernel_alt_247
    buffer_store_dwordx4 v[144:147], v24, s[48:51], s15 offen offset:2048
    buffer_store_dwordx4 v[148:151], v24, s[48:51], s66 offen offset:2048
L_sequential_preLN__sliding_local_dilated__mixer_s_mlp__prompt_kernel_altb_248:
    s_waitcnt lgkmcnt(0)
    v_pk_fma_f32 v[112:113], v[64:65], v[72:73], v[112:113] op_sel_hi:[1,0,1]
    v_pk_fma_f32 v[114:115], v[66:67], v[72:73], v[114:115] op_sel_hi:[1,0,1]
    v_pk_fma_f32 v[140:141], v[64:65], v[78:79], v[140:141] op_sel_hi:[1,0,1]
    v_pk_fma_f32 v[142:143], v[66:67], v[78:79], v[142:143] op_sel_hi:[1,0,1]
    v_pk_mul_f32 v[144:145], v[112:113], v[112:113]
    v_pk_mul_f32 v[146:147], v[114:115], v[114:115]
    v_pk_mul_f32 v[148:149], v[140:141], v[140:141]
    v_pk_mul_f32 v[150:151], v[142:143], v[142:143]
    v_pk_fma_f32 v[144:145], v[144:145], v[74:75], v[74:75] op_sel:[0,0,1] op_sel_hi:[1,0,1]
    v_pk_fma_f32 v[146:147], v[146:147], v[74:75], v[74:75] op_sel:[0,0,1] op_sel_hi:[1,0,1]
    v_pk_fma_f32 v[148:149], v[148:149], v[80:81], v[80:81] op_sel:[0,0,1] op_sel_hi:[1,0,1]
    v_pk_fma_f32 v[150:151], v[150:151], v[80:81], v[80:81] op_sel:[0,0,1] op_sel_hi:[1,0,1]
    v_pk_mul_f32 v[144:145], v[144:145], v[112:113]
    v_pk_mul_f32 v[146:147], v[146:147], v[114:115]
    v_pk_mul_f32 v[148:149], v[148:149], v[140:141]
    v_pk_mul_f32 v[150:151], v[150:151], v[142:143]
    v_exp_f32 v144, v144
    v_exp_f32 v145, v145
    v_exp_f32 v146, v146
    v_exp_f32 v147, v147
    v_exp_f32 v148, v148
    v_exp_f32 v149, v149
    v_exp_f32 v150, v150
    v_exp_f32 v151, v151
    s_nop 0
    v_pk_fma_f32 v[144:145], v[144:145], v[76:77], v[76:77] op_sel_hi:[1,0,0]
    v_pk_fma_f32 v[146:147], v[146:147], v[76:77], v[76:77] op_sel_hi:[1,0,0]
    v_pk_fma_f32 v[148:149], v[148:149], v[82:83], v[82:83] op_sel_hi:[1,0,0]
    v_pk_fma_f32 v[150:151], v[150:151], v[82:83], v[82:83] op_sel_hi:[1,0,0]
    v_rcp_f32 v144, v144
    v_rcp_f32 v145, v145
    v_rcp_f32 v146, v146
    v_rcp_f32 v147, v147
    v_rcp_f32 v148, v148
    v_rcp_f32 v149, v149
    v_rcp_f32 v150, v150
    v_rcp_f32 v151, v151
    s_nop 0
    v_pk_mul_f32 v[112:113], v[112:113], v[144:145]
    v_pk_mul_f32 v[114:115], v[114:115], v[146:147]
    v_pk_mul_f32 v[140:141], v[140:141], v[148:149]
    v_pk_mul_f32 v[142:143], v[142:143], v[150:151]
    v_cvt_pk_bf16_f32 v144, v112, v113
    v_cvt_pk_bf16_f32 v145, v114, v115
    v_cvt_pk_bf16_f32 v146, v140, v141
    v_cvt_pk_bf16_f32 v147, v142, v143
    s_add_u32 s66, s16, 0xe000
    s_cmp_eq_u32 s36, 0
    s_cbranch_scc1 L_sequential_preLN__sliding_local_dilated__mixer_s_mlp__prompt_kernel_alt_249
    buffer_store_dwordx2 v[144:145], v24, s[48:51], s16 offen
    buffer_store_dwordx2 v[146:147], v24, s[48:51], s66 offen
L_sequential_preLN__sliding_local_dilated__mixer_s_mlp__prompt_kernel_altb_250:
    s_mov_b32 s5, 0
    v_add_u32 v65, 0xc000, v27
    v_add_u32 v66, 0xc000, v28
    v_add_u32 v67, 0xc000, v29
    v_add_u32 v68, 0xc000, v30
    v_add_u32 v69, 0x18000, v27
    v_add_u32 v70, 0x18000, v28
    v_add_u32 v71, 0x18000, v29
    v_add_u32 v72, 0x18000, v30
    s_mul_i32 s33, s64, 57344
    s_add_u32 s33, s33, 0x800000
    v_add_u32 v73, s33, v24
    s_lshl_b32 s33, s64, 7
    s_add_u32 s33, s33, 0xfe0000
    v_lshl_add_u32 v64, v1, 2, s33
    s_mov_b32 s4, 0xffff
    s_waitcnt vmcnt(0)
    s_cmp_eq_u32 s36, 0
    s_cbranch_scc1 L_sequential_preLN__sliding_local_dilated__mixer_s_mlp__prompt_kernel_alt_251
    s_mov_b64 exec, 3
    buffer_store_dword v6, v54, s[48:51], s17 offen
    s_mov_b64 exec, -1
L_sequential_preLN__sliding_local_dilated__mixer_s_mlp__prompt_kernel_altb_252:
    v_lshlrev_b32 v88, 16, v32
    v_and_b32 v89, 0xffff0000, v32
    v_lshlrev_b32 v90, 16, v33
    v_and_b32 v91, 0xffff0000, v33
    v_lshlrev_b32 v92, 16, v34
    v_and_b32 v93, 0xffff0000, v34
    v_lshlrev_b32 v94, 16, v35
    v_and_b32 v95, 0xffff0000, v35
    v_lshlrev_b32 v96, 16, v36
    v_and_b32 v97, 0xffff0000, v36
    v_lshlrev_b32 v98, 16, v37
    v_and_b32 v99, 0xffff0000, v37
    v_lshlrev_b32 v100, 16, v38
    v_and_b32 v101, 0xffff0000, v38
    v_lshlrev_b32 v102, 16, v39
    v_and_b32 v103, 0xffff0000, v39
    v_lshlrev_b32 v104, 16, v40
    v_and_b32 v105, 0xffff0000, v40
    v_lshlrev_b32 v106, 16, v41
    v_and_b32 v107, 0xffff0000, v41
    v_lshlrev_b32 v108, 16, v42
    v_and_b32 v109, 0xffff0000, v42
    v_lshlrev_b32 v110, 16, v43
    v_and_b32 v111, 0xffff0000, v43
    v_lshlrev_b32 v112, 16, v44
    v_and_b32 v113, 0xffff0000, v44
    v_lshlrev_b32 v114, 16, v45
    v_and_b32 v115, 0xffff0000, v45
    v_lshlrev_b32 v116, 16, v46
    v_and_b32 v117, 0xffff0000, v46
    v_lshlrev_b32 v118, 16, v47
    v_and_b32 v119, 0xffff0000, v47
    v_pk_add_f32 v[88:89], v[88:89], v[104:105]
    v_pk_add_f32 v[90:91], v[90:91], v[106:107]
    v_pk_add_f32 v[92:93], v[92:93], v[108:109]
    v_pk_add_f32 v[94:95], v[94:95], v[110:111]
    v_pk_add_f32 v[96:97], v[96:97], v[112:113]
    v_pk_add_f32 v[98:99], v[98:99], v[114:115]
    v_pk_add_f32 v[100:101], v[100:101], v[116:117]
    v_pk_add_f32 v[102:103], v[102:103], v[118:119]
    s_mov_b32 s60, s20
    s_mov_b32 s61, s21
    s_mov_b32 s62, 0x200000
    s_cmp_lt_u32 s52, 25
    s_cbranch_scc1 L_sequential_preLN__sliding_local_dilated__mixer_s_mlp__prompt_kernel_lws_254
L_sequential_preLN__sliding_local_dilated__mixer_s_mlp__prompt_kernel_lwb_253:
    ds_read_b64_tr_b16 a[48:49], v69 offset:16384
    ds_read_b64_tr_b16 a[50:51], v69 offset:18432
    ds_read_b64_tr_b16 a[52:53], v70 offset:16384
    ds_read_b64_tr_b16 a[54:55], v70 offset:18432
    ds_read_b64_tr_b16 a[56:57], v71 offset:16384
    ds_read_b64_tr_b16 a[58:59], v71 offset:18432
    ds_read_b64_tr_b16 a[60:61], v72 offset:16384
    ds_read_b64_tr_b16 a[62:63], v72 offset:18432
    ds_read_b64_tr_b16 a[64:65], v69 offset:20480
    ds_read_b64_tr_b16 a[66:67], v69 offset:22528
    ds_read_b64_tr_b16 a[68:69], v70 offset:20480
    ds_read_b64_tr_b16 a[70:71], v70 offset:22528
    ds_read_b64_tr_b16 a[72:73], v71 offset:20480
    ds_read_b64_tr_b16 a[74:75], v71 offset:22528
    ds_read_b64_tr_b16 a[76:77], v72 offset:20480
    ds_read_b64_tr_b16 a[78:79], v72 offset:22528
    ds_read_b64_tr_b16 a[80:81], v69 offset:24576
    ds_read_b64_tr_b16 a[82:83], v69 offset:26624
    ds_read_b64_tr_b16 a[84:85], v70 offset:24576
    ds_read_b64_tr_b16 a[86:87], v70 offset:26624
    ds_read_b64_tr_b16 a[88:89], v71 offset:24576
    ds_read_b64_tr_b16 a[90:91], v71 offset:26624
    ds_read_b64_tr_b16 a[92:93], v72 offset:24576
    ds_read_b64_tr_b16 a[94:95], v72 offset:26624
    s_branch L_sequential_preLN__sliding_local_dilated__mixer_s_mlp__prompt_kernel_isl_256
L_sequential_preLN__sliding_local_dilated__mixer_s_mlp__prompt_kernel_nopeek_236_d:
    s_mov_b64 exec, 1
    ds_read_b128 v[8:11], v4 offset:0
    s_waitcnt lgkmcnt(0)
    v_min3_u32 v8, v8, v9, v10
    v_min_u32 v8, v8, v11
    s_nop 0
    v_readfirstlane_b32 s52, v8
    s_mov_b64 exec, -1
    s_branch L_sequential_preLN__sliding_local_dilated__mixer_s_mlp__prompt_kernel_nopeek_236
L_sequential_preLN__sliding_local_dilated__mixer_s_mlp__prompt_kernel_lws_238:
    s_movk_i32 s42, 22
    s_call_b64 s[44:45], L_wait_c_0_52_0
    s_branch L_sequential_preLN__sliding_local_dilated__mixer_s_mlp__prompt_kernel_lwb_237
L_sequential_preLN__sliding_local_dilated__mixer_s_mlp__prompt_kernel_nopeek_239_d:
    s_mov_b64 exec, 1
    ds_read_b128 v[8:11], v4 offset:0
    s_waitcnt lgkmcnt(0)
    v_min3_u32 v8, v8, v9, v10
    v_min_u32 v8, v8, v11
    s_nop 0
    v_readfirstlane_b32 s52, v8
    s_mov_b64 exec, -1
    s_branch L_sequential_preLN__sliding_local_dilated__mixer_s_mlp__prompt_kernel_nopeek_239
L_sequential_preLN__sliding_local_dilated__mixer_s_mlp__prompt_kernel_lws_241:
    s_movk_i32 s42, 23
    s_call_b64 s[44:45], L_wait_c_0_52_0
    s_branch L_sequential_preLN__sliding_local_dilated__mixer_s_mlp__prompt_kernel_lwb_240
L_sequential_preLN__sliding_local_dilated__mixer_s_mlp__prompt_kernel_nopeek_242_d:
    s_mov_b64 exec, 1
    ds_read_b128 v[8:11], v4 offset:0
    s_waitcnt lgkmcnt(0)
    v_min3_u32 v8, v8, v9, v10
    v_min_u32 v8, v8, v11
    s_nop 0
    v_readfirstlane_b32 s52, v8
    s_mov_b64 exec, -1
    s_branch L_sequential_preLN__sliding_local_dilated__mixer_s_mlp__prompt_kernel_nopeek_242
L_sequential_preLN__sliding_local_dilated__mixer_s_mlp__prompt_kernel_lws_244:
    s_movk_i32 s42, 24
    s_call_b64 s[44:45], L_wait_c_0_52_0
    s_branch L_sequential_preLN__sliding_local_dilated__mixer_s_mlp__prompt_kernel_lwb_243
L_sequential_preLN__sliding_local_dilated__mixer_s_mlp__prompt_kernel_lws_246:
    s_movk_i32 s42, 3
    s_call_b64 s[44:45], L_wait_c_64_53_0
    s_branch L_sequential_preLN__sliding_local_dilated__mixer_s_mlp__prompt_kernel_lwb_245
L_sequential_preLN__sliding_local_dilated__mixer_s_mlp__prompt_kernel_alt_247:
    buffer_store_dwordx4 v[144:147], v24, s[48:51], s15 offen offset:2048 sc1
    buffer_store_dwordx4 v[148:151], v24, s[48:51], s66 offen offset:2048 sc1
    s_branch L_sequential_preLN__sliding_local_dilated__mixer_s_mlp__prompt_kernel_altb_248
L_sequential_preLN__sliding_local_dilated__mixer_s_mlp__prompt_kernel_alt_249:
    buffer_store_dwordx2 v[144:145], v24, s[48:51], s16 offen sc1
    buffer_store_dwordx2 v[146:147], v24, s[48:51], s66 offen sc1
    s_branch L_sequential_preLN__sliding_local_dilated__mixer_s_mlp__prompt_kernel_altb_250
L_sequential_preLN__sliding_local_dilated__mixer_s_mlp__prompt_kernel_alt_251:
    s_mov_b64 exec, 3
    buffer_store_dword v6, v54, s[48:51], s17 offen sc1
    s_mov_b64 exec, -1
    s_branch L_sequential_preLN__sliding_local_dilated__mixer_s_mlp__prompt_kernel_altb_252
L_sequential_preLN__sliding_local_dilated__mixer_s_mlp__prompt_kernel_lws_254:
    s_movk_i32 s42, 25
    s_call_b64 s[44:45], L_wait_c_0_52_0
    s_branch L_sequential_preLN__sliding_local_dilated__mixer_s_mlp__prompt_kernel_lwb_253
L_sequential_preLN__sliding_local_dilated__mixer_s_mlp__prompt_kernel_psub_255:
    s_mov_b32 s27, 0
    s_mov_b64 exec, s[4:5]
L_sequential_preLN__sliding_local_dilated__mixer_s_mlp__prompt_kernel_psub_255_t:
    buffer_load_dword v21, v64, s[48:51], 0 offen sc1
    s_waitcnt vmcnt(0)
    v_cmp_eq_u32 vcc, s35, v21
    s_nop 0
    s_or_b32 s70, vcc_lo, s71
    s_andn2_b32 s33, s42, s70
    s_cbranch_scc0 L_sequential_preLN__sliding_local_dilated__mixer_s_mlp__prompt_kernel_psub_255_o
    s_sleep 2
    s_add_u32 s27, s27, 1
    s_cmp_lt_u32 s27, 0x40000
    s_cbranch_scc1 L_sequential_preLN__sliding_local_dilated__mixer_s_mlp__prompt_kernel_psub_255_t
L_sequential_preLN__sliding_local_dilated__mixer_s_mlp__prompt_kernel_psub_255_o:
    s_mov_b64 exec, -1
    s_setpc_b64 s[44:45]
L_sequential_preLN__sliding_local_dilated__mixer_s_mlp__prompt_kernel_isl_256:
    s_mov_b32 s27, 0
    s_mov_b64 exec, s[4:5]
L_sequential_preLN__sliding_local_dilated__mixer_s_mlp__prompt_kernel_gpoll_257:
    buffer_load_dword v8, v64, s[48:51], 0 offen sc1
    s_waitcnt vmcnt(0)
    v_cmp_ne_u32 vcc, s35, v8
    s_nop 0
    s_cmp_eq_u64 vcc, 0
    s_cbranch_scc1 L_sequential_preLN__sliding_local_dilated__mixer_s_mlp__prompt_kernel_gok_258
    s_sleep 2
    s_add_u32 s27, s27, 1
    s_cmp_lt_u32 s27, 0x40000
    s_cbranch_scc1 L_sequential_preLN__sliding_local_dilated__mixer_s_mlp__prompt_kernel_gpoll_257
L_sequential_preLN__sliding_local_dilated__mixer_s_mlp__prompt_kernel_gok_258:
    s_mov_b64 exec, -1
    s_mov_b32 s66, 0x0
    buffer_load_dwordx4 a[0:3], v73, s[48:51], s66 offen offset:0 sc1
    buffer_load_dwordx4 a[4:7], v73, s[48:51], s66 offen offset:1024 sc1
    buffer_load_dwordx4 a[8:11], v73, s[48:51], s66 offen offset:2048 sc1
    buffer_load_dwordx4 a[12:15], v73, s[48:51], s66 offen offset:3072 sc1
    s_mov_b32 s66, 0x1000
    buffer_load_dwordx4 a[16:19], v73, s[48:51], s66 offen offset:0 sc1
    buffer_load_dwordx4 a[20:23], v73, s[48:51], s66 offen offset:1024 sc1
    buffer_load_dwordx4 a[24:27], v73, s[48:51], s66 offen offset:2048 sc1
    buffer_load_dwordx4 a[28:31], v73, s[48:51], s66 offen offset:3072 sc1
    s_mov_b32 s66, 0x2000
    buffer_load_dwordx4 a[32:35], v73, s[48:51], s66 offen offset:0 sc1
    buffer_load_dwordx4 a[36:39], v73, s[48:51], s66 offen offset:1024 sc1
    s_waitcnt vmcnt(9) lgkmcnt(15)
    v_mfma_f32_16x16x32_bf16 v[88:91], a[48:51], a[0:3], v[88:91]
    ds_read_b64_tr_b16 a[48:49], v69 offset:28672
    ds_read_b64_tr_b16 a[50:51], v69 offset:30720
    v_mfma_f32_16x16x32_bf16 v[92:95], a[52:55], a[0:3], v[92:95]
    ds_read_b64_tr_b16 a[52:53], v70 offset:28672
    ds_read_b64_tr_b16 a[54:55], v70 offset:30720
    v_mfma_f32_16x16x32_bf16 v[96:99], a[56:59], a[0:3], v[96:99]
    ds_read_b64_tr_b16 a[56:57], v71 offset:28672
    ds_read_b64_tr_b16 a[58:59], v71 offset:30720
    v_mfma_f32_16x16x32_bf16 v[100:103], a[60:63], a[0:3], v[100:103]
    ds_read_b64_tr_b16 a[60:61], v72 offset:28672
    ds_read_b64_tr_b16 a[62:63], v72 offset:30720
    buffer_load_dwordx4 a[40:43], v73, s[48:51], s66 offen offset:2048 sc1
    s_waitcnt vmcnt(9) lgkmcnt(15)
    v_mfma_f32_16x16x32_bf16 v[88:91], a[64:67], a[4:7], v[88:91]
    s_cmp_lt_u32 s52, 26
    s_cbranch_scc1 L_sequential_preLN__sliding_local_dilated__mixer_s_mlp__prompt_kernel_lws_260
L_sequential_preLN__sliding_local_dilated__mixer_s_mlp__prompt_kernel_lwb_259:
    ds_read_b64_tr_b16 a[64:65], v69 offset:32768
    ds_read_b64_tr_b16 a[66:67], v69 offset:34816
    v_mfma_f32_16x16x32_bf16 v[92:95], a[68:71], a[4:7], v[92:95]
    ds_read_b64_tr_b16 a[68:69], v70 offset:32768
    ds_read_b64_tr_b16 a[70:71], v70 offset:34816
    v_mfma_f32_16x16x32_bf16 v[96:99], a[72:75], a[4:7], v[96:99]
    ds_read_b64_tr_b16 a[72:73], v71 offset:32768
    ds_read_b64_tr_b16 a[74:75], v71 offset:34816
    v_mfma_f32_16x16x32_bf16 v[100:103], a[76:79], a[4:7], v[100:103]
    ds_read_b64_tr_b16 a[76:77], v72 offset:32768
    ds_read_b64_tr_b16 a[78:79], v72 offset:34816
    buffer_load_dwordx4 a[44:47], v73, s[48:51], s66 offen offset:3072 sc1
    s_waitcnt vmcnt(9) lgkmcnt(15)
    v_mfma_f32_16x16x32_bf16 v[88:91], a[80:83], a[8:11], v[88:91]
    ds_read_b64_tr_b16 a[80:81], v69 offset:36864
    ds_read_b64_tr_b16 a[82:83], v69 offset:38912
    v_mfma_f32_16x16x32_bf16 v[92:95], a[84:87], a[8:11], v[92:95]
    ds_read_b64_tr_b16 a[84:85], v70 offset:36864
    ds_read_b64_tr_b16 a[86:87], v70 offset:38912
    v_mfma_f32_16x16x32_bf16 v[96:99], a[88:91], a[8:11], v[96:99]
    ds_read_b64_tr_b16 a[88:89], v71 offset:36864
    ds_read_b64_tr_b16 a[90:91], v71 offset:38912
    v_mfma_f32_16x16x32_bf16 v[100:103], a[92:95], a[8:11], v[100:103]
    ds_read_b64_tr_b16 a[92:93], v72 offset:36864
    ds_read_b64_tr_b16 a[94:95], v72 offset:38912
    s_mov_b32 s66, 0x3000
    buffer_load_dwordx4 a[0:3], v73, s[48:51], s66 offen offset:0 sc1
    s_waitcnt vmcnt(9) lgkmcnt(15)
    v_mfma_f32_16x16x32_bf16 v[88:91], a[48:51], a[12:15], v[88:91]
    ds_read_b64_tr_b16 a[48:49], v69 offset:40960
    ds_read_b64_tr_b16 a[50:51], v69 offset:43008
    v_mfma_f32_16x16x32_bf16 v[92:95], a[52:55], a[12:15], v[92:95]
    ds_read_b64_tr_b16 a[52:53], v70 offset:40960
    ds_read_b64_tr_b16 a[54:55], v70 offset:43008
    s_cmp_ge_u32 s52, 27
    s_cbranch_scc0 L_sequential_preLN__sliding_local_dilated__mixer_s_mlp__prompt_kernel_nopeek_261_d
L_sequential_preLN__sliding_local_dilated__mixer_s_mlp__prompt_kernel_nopeek_261:
    v_mfma_f32_16x16x32_bf16 v[96:99], a[56:59], a[12:15], v[96:99]
    ds_read_b64_tr_b16 a[56:57], v71 offset:40960
    ds_read_b64_tr_b16 a[58:59], v71 offset:43008
    v_mfma_f32_16x16x32_bf16 v[100:103], a[60:63], a[12:15], v[100:103]
    ds_read_b64_tr_b16 a[60:61], v72 offset:40960
    ds_read_b64_tr_b16 a[62:63], v72 offset:43008
    v_mov_b32 v12, 25
    s_mov_b64 exec, 1
    ds_max_u32 v5, v12 offset:16
    s_mov_b64 exec, -1
    buffer_load_dwordx4 a[4:7], v73, s[48:51], s66 offen offset:1024 sc1
    s_waitcnt vmcnt(9) lgkmcnt(15)
    v_mfma_f32_16x16x32_bf16 v[88:91], a[64:67], a[16:19], v[88:91]
    ds_read_b64_tr_b16 a[64:65], v69 offset:45056
    ds_read_b64_tr_b16 a[66:67], v69 offset:47104
    v_mfma_f32_16x16x32_bf16 v[92:95], a[68:71], a[16:19], v[92:95]
    ds_read_b64_tr_b16 a[68:69], v70 offset:45056
    ds_read_b64_tr_b16 a[70:71], v70 offset:47104
    v_mfma_f32_16x16x32_bf16 v[96:99], a[72:75], a[16:19], v[96:99]
    ds_read_b64_tr_b16 a[72:73], v71 offset:45056
    ds_read_b64_tr_b16 a[74:75], v71 offset:47104
    v_mfma_f32_16x16x32_bf16 v[100:103], a[76:79], a[16:19], v[100:103]
    ds_read_b64_tr_b16 a[76:77], v72 offset:45056
    ds_read_b64_tr_b16 a[78:79], v72 offset:47104
    buffer_load_dwordx4 a[8:11], v73, s[48:51], s66 offen offset:2048 sc1
    s_waitcnt vmcnt(9) lgkmcnt(15)
    v_mfma_f32_16x16x32_bf16 v[88:91], a[80:83], a[20:23], v[88:91]
    s_cmp_lt_u32 s52, 27
    s_cbranch_scc1 L_sequential_preLN__sliding_local_dilated__mixer_s_mlp__prompt_kernel_lws_263
L_sequential_preLN__sliding_local_dilated__mixer_s_mlp__prompt_kernel_lwb_262:
    ds_read_b64_tr_b16 a[80:81], v27 offset:0
    ds_read_b64_tr_b16 a[82:83], v27 offset:2048
    v_mfma_f32_16x16x32_bf16 v[92:95], a[84:87], a[20:23], v[92:95]
    ds_read_b64_tr_b16 a[84:85], v28 offset:0
    ds_read_b64_tr_b16 a[86:87], v28 offset:2048
    v_mfma_f32_16x16x32_bf16 v[96:99], a[88:91], a[20:23], v[96:99]
    ds_read_b64_tr_b16 a[88:89], v29 offset:0
    ds_read_b64_tr_b16 a[90:91], v29 offset:2048
    v_mfma_f32_16x16x32_bf16 v[100:103], a[92:95], a[20:23], v[100:103]
    ds_read_b64_tr_b16 a[92:93], v30 offset:0
    ds_read_b64_tr_b16 a[94:95], v30 offset:2048
    buffer_load_dwordx4 a[12:15], v73, s[48:51], s66 offen offset:3072 sc1
    s_waitcnt vmcnt(9) lgkmcnt(15)
    v_mfma_f32_16x16x32_bf16 v[88:91], a[48:51], a[24:27], v[88:91]
    ds_read_b64_tr_b16 a[48:49], v27 offset:4096
    ds_read_b64_tr_b16 a[50:51], v27 offset:6144
    v_mfma_f32_16x16x32_bf16 v[92:95], a[52:55], a[24:27], v[92:95]
    ds_read_b64_tr_b16 a[52:53], v28 offset:4096
    ds_read_b64_tr_b16 a[54:55], v28 offset:6144
    v_mfma_f32_16x16x32_bf16 v[96:99], a[56:59], a[24:27], v[96:99]
    ds_read_b64_tr_b16 a[56:57], v29 offset:4096
    ds_read_b64_tr_b16 a[58:59], v29 offset:6144
    v_mfma_f32_16x16x32_bf16 v[100:103], a[60:63], a[24:27], v[100:103]
    ds_read_b64_tr_b16 a[60:61], v30 offset:4096
    ds_read_b64_tr_b16 a[62:63], v30 offset:6144
    s_mov_b32 s66, 0x4000
    buffer_load_dwordx4 a[16:19], v73, s[48:51], s66 offen offset:0 sc1
    s_waitcnt vmcnt(9) lgkmcnt(15)
    v_mfma_f32_16x16x32_bf16 v[88:91], a[64:67], a[28:31], v[88:91]
    ds_read_b64_tr_b16 a[64:65], v27 offset:8192
    ds_read_b64_tr_b16 a[66:67], v27 offset:10240
    v_mfma_f32_16x16x32_bf16 v[92:95], a[68:71], a[28:31], v[92:95]
    ds_read_b64_tr_b16 a[68:69], v28 offset:8192
    ds_read_b64_tr_b16 a[70:71], v28 offset:10240
    s_cmp_ge_u32 s52, 28
    s_cbranch_scc0 L_sequential_preLN__sliding_local_dilated__mixer_s_mlp__prompt_kernel_nopeek_264_d
L_sequential_preLN__sliding_local_dilated__mixer_s_mlp__prompt_kernel_nopeek_264:
    v_mfma_f32_16x16x32_bf16 v[96:99], a[72:75], a[28:31], v[96:99]
    ds_read_b64_tr_b16 a[72:73], v29 offset:8192
    ds_read_b64_tr_b16 a[74:75], v29 offset:10240
    v_mfma_f32_16x16x32_bf16 v[100:103], a[76:79], a[28:31], v[100:103]
    ds_read_b64_tr_b16 a[76:77], v30 offset:8192
    ds_read_b64_tr_b16 a[78:79], v30 offset:10240
    v_mov_b32 v12, 26
    s_mov_b64 exec, 1
    ds_max_u32 v5, v12 offset:16
    s_mov_b64 exec, -1
    buffer_load_dwordx4 a[20:23], v73, s[48:51], s66 offen offset:1024 sc1
    s_waitcnt vmcnt(9) lgkmcnt(15)
    v_mfma_f32_16x16x32_bf16 v[88:91], a[80:83], a[32:35], v[88:91]
    ds_read_b64_tr_b16 a[80:81], v27 offset:12288
    ds_read_b64_tr_b16 a[82:83], v27 offset:14336
    v_mfma_f32_16x16x32_bf16 v[92:95], a[84:87], a[32:35], v[92:95]
    ds_read_b64_tr_b16 a[84:85], v28 offset:12288
    ds_read_b64_tr_b16 a[86:87], v28 offset:14336
    v_mfma_f32_16x16x32_bf16 v[96:99], a[88:91], a[32:35], v[96:99]
    ds_read_b64_tr_b16 a[88:89], v29 offset:12288
    ds_read_b64_tr_b16 a[90:91], v29 offset:14336
    v_mfma_f32_16x16x32_bf16 v[100:103], a[92:95], a[32:35], v[100:103]
    ds_read_b64_tr_b16 a[92:93], v30 offset:12288
    ds_read_b64_tr_b16 a[94:95], v30 offset:14336
    buffer_load_dwordx4 a[24:27], v73, s[48:51], s66 offen offset:2048 sc1
    s_waitcnt vmcnt(9) lgkmcnt(15)
    v_mfma_f32_16x16x32_bf16 v[88:91], a[48:51], a[36:39], v[88:91]
    s_cmp_lt_u32 s52, 28
    s_cbranch_scc1 L_sequential_preLN__sliding_local_dilated__mixer_s_mlp__prompt_kernel_lws_266
L_sequential_preLN__sliding_local_dilated__mixer_s_mlp__prompt_kernel_lwb_265:
    ds_read_b64_tr_b16 a[48:49], v27 offset:16384
    ds_read_b64_tr_b16 a[50:51], v27 offset:18432
    v_mfma_f32_16x16x32_bf16 v[92:95], a[52:55], a[36:39], v[92:95]
    ds_read_b64_tr_b16 a[52:53], v28 offset:16384
    ds_read_b64_tr_b16 a[54:55], v28 offset:18432
    v_mfma_f32_16x16x32_bf16 v[96:99], a[56:59], a[36:39], v[96:99]
    ds_read_b64_tr_b16 a[56:57], v29 offset:16384
    ds_read_b64_tr_b16 a[58:59], v29 offset:18432
    v_mfma_f32_16x16x32_bf16 v[100:103], a[60:63], a[36:39], v[100:103]
    ds_read_b64_tr_b16 a[60:61], v30 offset:16384
    ds_read_b64_tr_b16 a[62:63], v30 offset:18432
    buffer_load_dwordx4 a[28:31], v73, s[48:51], s66 offen offset:3072 sc1
    s_waitcnt vmcnt(9) lgkmcnt(15)
    v_mfma_f32_16x16x32_bf16 v[88:91], a[64:67], a[40:43], v[88:91]
    ds_read_b64_tr_b16 a[64:65], v27 offset:20480
    ds_read_b64_tr_b16 a[66:67], v27 offset:22528
    v_mfma_f32_16x16x32_bf16 v[92:95], a[68:71], a[40:43], v[92:95]
    ds_read_b64_tr_b16 a[68:69], v28 offset:20480
    ds_read_b64_tr_b16 a[70:71], v28 offset:22528
    v_mfma_f32_16x16x32_bf16 v[96:99], a[72:75], a[40:43], v[96:99]
    ds_read_b64_tr_b16 a[72:73], v29 offset:20480
    ds_read_b64_tr_b16 a[74:75], v29 offset:22528
    v_mfma_f32_16x16x32_bf16 v[100:103], a[76:79], a[40:43], v[100:103]
    ds_read_b64_tr_b16 a[76:77], v30 offset:20480
    ds_read_b64_tr_b16 a[78:79], v30 offset:22528
    s_mov_b32 s66, 0x5000
    buffer_load_dwordx4 a[32:35], v73, s[48:51], s66 offen offset:0 sc1
    s_waitcnt vmcnt(9) lgkmcnt(15)
    v_mfma_f32_16x16x32_bf16 v[88:91], a[80:83], a[44:47], v[88:91]
    ds_read_b64_tr_b16 a[80:81], v27 offset:24576
    ds_read_b64_tr_b16 a[82:83], v27 offset:26624
    v_mfma_f32_16x16x32_bf16 v[92:95], a[84:87], a[44:47], v[92:95]
    ds_read_b64_tr_b16 a[84:85], v28 offset:24576
    ds_read_b64_tr_b16 a[86:87], v28 offset:26624
    s_cmp_ge_u32 s52, 29
    s_cbranch_scc0 L_sequential_preLN__sliding_local_dilated__mixer_s_mlp__prompt_kernel_nopeek_267_d
L_sequential_preLN__sliding_local_dilated__mixer_s_mlp__prompt_kernel_nopeek_267:
    v_mfma_f32_16x16x32_bf16 v[96:99], a[88:91], a[44:47], v[96:99]
    ds_read_b64_tr_b16 a[88:89], v29 offset:24576
    ds_read_b64_tr_b16 a[90:91], v29 offset:26624
    v_mfma_f32_16x16x32_bf16 v[100:103], a[92:95], a[44:47], v[100:103]
    ds_read_b64_tr_b16 a[92:93], v30 offset:24576
    ds_read_b64_tr_b16 a[94:95], v30 offset:26624
    v_mov_b32 v12, 27
    s_mov_b64 exec, 1
    ds_max_u32 v5, v12 offset:16
    s_mov_b64 exec, -1
    buffer_load_dwordx4 a[36:39], v73, s[48:51], s66 offen offset:1024 sc1
    s_waitcnt vmcnt(9) lgkmcnt(15)
    v_mfma_f32_16x16x32_bf16 v[88:91], a[48:51], a[0:3], v[88:91]
    ds_read_b64_tr_b16 a[48:49], v27 offset:28672
    ds_read_b64_tr_b16 a[50:51], v27 offset:30720
    v_mfma_f32_16x16x32_bf16 v[92:95], a[52:55], a[0:3], v[92:95]
    ds_read_b64_tr_b16 a[52:53], v28 offset:28672
    ds_read_b64_tr_b16 a[54:55], v28 offset:30720
    v_mfma_f32_16x16x32_bf16 v[96:99], a[56:59], a[0:3], v[96:99]
    ds_read_b64_tr_b16 a[56:57], v29 offset:28672
    ds_read_b64_tr_b16 a[58:59], v29 offset:30720
    v_mfma_f32_16x16x32_bf16 v[100:103], a[60:63], a[0:3], v[100:103]
    ds_read_b64_tr_b16 a[60:61], v30 offset:28672
    ds_read_b64_tr_b16 a[62:63], v30 offset:30720
    buffer_load_dwordx4 a[40:43], v73, s[48:51], s66 offen offset:2048 sc1
    s_waitcnt vmcnt(9) lgkmcnt(15)
    v_mfma_f32_16x16x32_bf16 v[88:91], a[64:67], a[4:7], v[88:91]
    s_cmp_lt_u32 s52, 29
    s_cbranch_scc1 L_sequential_preLN__sliding_local_dilated__mixer_s_mlp__prompt_kernel_lws_269
L_sequential_preLN__sliding_local_dilated__mixer_s_mlp__prompt_kernel_lwb_268:
    ds_read_b64_tr_b16 a[64:65], v27 offset:32768
    ds_read_b64_tr_b16 a[66:67], v27 offset:34816
    v_mfma_f32_16x16x32_bf16 v[92:95], a[68:71], a[4:7], v[92:95]
    ds_read_b64_tr_b16 a[68:69], v28 offset:32768
    ds_read_b64_tr_b16 a[70:71], v28 offset:34816
    v_mfma_f32_16x16x32_bf16 v[96:99], a[72:75], a[4:7], v[96:99]
    ds_read_b64_tr_b16 a[72:73], v29 offset:32768
    ds_read_b64_tr_b16 a[74:75], v29 offset:34816
    v_mfma_f32_16x16x32_bf16 v[100:103], a[76:79], a[4:7], v[100:103]
    ds_read_b64_tr_b16 a[76:77], v30 offset:32768
    ds_read_b64_tr_b16 a[78:79], v30 offset:34816
    buffer_load_dwordx4 a[44:47], v73, s[48:51], s66 offen offset:3072 sc1
    s_waitcnt vmcnt(9) lgkmcnt(15)
    v_mfma_f32_16x16x32_bf16 v[88:91], a[80:83], a[8:11], v[88:91]
    ds_read_b64_tr_b16 a[80:81], v27 offset:36864
    ds_read_b64_tr_b16 a[82:83], v27 offset:38912
    v_mfma_f32_16x16x32_bf16 v[92:95], a[84:87], a[8:11], v[92:95]
    ds_read_b64_tr_b16 a[84:85], v28 offset:36864
    ds_read_b64_tr_b16 a[86:87], v28 offset:38912
    v_mfma_f32_16x16x32_bf16 v[96:99], a[88:91], a[8:11], v[96:99]
    ds_read_b64_tr_b16 a[88:89], v29 offset:36864
    ds_read_b64_tr_b16 a[90:91], v29 offset:38912
    v_mfma_f32_16x16x32_bf16 v[100:103], a[92:95], a[8:11], v[100:103]
    ds_read_b64_tr_b16 a[92:93], v30 offset:36864
    ds_read_b64_tr_b16 a[94:95], v30 offset:38912
    s_mov_b32 s66, 0x6000
    buffer_load_dwordx4 a[0:3], v73, s[48:51], s66 offen offset:0 sc1
    s_waitcnt vmcnt(9) lgkmcnt(15)
    v_mfma_f32_16x16x32_bf16 v[88:91], a[48:51], a[12:15], v[88:91]
    ds_read_b64_tr_b16 a[48:49], v27 offset:40960
    ds_read_b64_tr_b16 a[50:51], v27 offset:43008
    v_mfma_f32_16x16x32_bf16 v[92:95], a[52:55], a[12:15], v[92:95]
    ds_read_b64_tr_b16 a[52:53], v28 offset:40960
    ds_read_b64_tr_b16 a[54:55], v28 offset:43008
    s_cmp_ge_u32 s52, 30
    s_cbranch_scc0 L_sequential_preLN__sliding_local_dilated__mixer_s_mlp__prompt_kernel_nopeek_270_d
L_sequential_preLN__sliding_local_dilated__mixer_s_mlp__prompt_kernel_nopeek_270:
    v_mfma_f32_16x16x32_bf16 v[96:99], a[56:59], a[12:15], v[96:99]
    ds_read_b64_tr_b16 a[56:57], v29 offset:40960
    ds_read_b64_tr_b16 a[58:59], v29 offset:43008
    v_mfma_f32_16x16x32_bf16 v[100:103], a[60:63], a[12:15], v[100:103]
    ds_read_b64_tr_b16 a[60:61], v30 offset:40960
    ds_read_b64_tr_b16 a[62:63], v30 offset:43008
    v_mov_b32 v12, 28
    s_mov_b64 exec, 1
    ds_max_u32 v5, v12 offset:16
    s_mov_b64 exec, -1
    buffer_load_dwordx4 a[4:7], v73, s[48:51], s66 offen offset:1024 sc1
    s_waitcnt vmcnt(9) lgkmcnt(15)
    v_mfma_f32_16x16x32_bf16 v[88:91], a[64:67], a[16:19], v[88:91]
    ds_read_b64_tr_b16 a[64:65], v27 offset:45056
    ds_read_b64_tr_b16 a[66:67], v27 offset:47104
    v_mfma_f32_16x16x32_bf16 v[92:95], a[68:71], a[16:19], v[92:95]
    ds_read_b64_tr_b16 a[68:69], v28 offset:45056
    ds_read_b64_tr_b16 a[70:71], v28 offset:47104
    v_mfma_f32_16x16x32_bf16 v[96:99], a[72:75], a[16:19], v[96:99]
    ds_read_b64_tr_b16 a[72:73], v29 offset:45056
    ds_read_b64_tr_b16 a[74:75], v29 offset:47104
    v_mfma_f32_16x16x32_bf16 v[100:103], a[76:79], a[16:19], v[100:103]
    ds_read_b64_tr_b16 a[76:77], v30 offset:45056
    ds_read_b64_tr_b16 a[78:79], v30 offset:47104
    buffer_load_dwordx4 a[8:11], v73, s[48:51], s66 offen offset:2048 sc1
    s_waitcnt vmcnt(9) lgkmcnt(15)
    v_mfma_f32_16x16x32_bf16 v[88:91], a[80:83], a[20:23], v[88:91]
    s_cmp_lt_u32 s52, 30
    s_cbranch_scc1 L_sequential_preLN__sliding_local_dilated__mixer_s_mlp__prompt_kernel_lws_272
L_sequential_preLN__sliding_local_dilated__mixer_s_mlp__prompt_kernel_lwb_271:
    ds_read_b64_tr_b16 a[80:81], v65 offset:0
    ds_read_b64_tr_b16 a[82:83], v65 offset:2048
    v_mfma_f32_16x16x32_bf16 v[92:95], a[84:87], a[20:23], v[92:95]
    ds_read_b64_tr_b16 a[84:85], v66 offset:0
    ds_read_b64_tr_b16 a[86:87], v66 offset:2048
    v_mfma_f32_16x16x32_bf16 v[96:99], a[88:91], a[20:23], v[96:99]
    ds_read_b64_tr_b16 a[88:89], v67 offset:0
    ds_read_b64_tr_b16 a[90:91], v67 offset:2048
    v_mfma_f32_16x16x32_bf16 v[100:103], a[92:95], a[20:23], v[100:103]
    ds_read_b64_tr_b16 a[92:93], v68 offset:0
    ds_read_b64_tr_b16 a[94:95], v68 offset:2048
    buffer_load_dwordx4 a[12:15], v73, s[48:51], s66 offen offset:3072 sc1
    s_waitcnt vmcnt(9) lgkmcnt(15)
    v_mfma_f32_16x16x32_bf16 v[88:91], a[48:51], a[24:27], v[88:91]
    ds_read_b64_tr_b16 a[48:49], v65 offset:4096
    ds_read_b64_tr_b16 a[50:51], v65 offset:6144
    v_mfma_f32_16x16x32_bf16 v[92:95], a[52:55], a[24:27], v[92:95]
    ds_read_b64_tr_b16 a[52:53], v66 offset:4096
    ds_read_b64_tr_b16 a[54:55], v66 offset:6144
    v_mfma_f32_16x16x32_bf16 v[96:99], a[56:59], a[24:27], v[96:99]
    ds_read_b64_tr_b16 a[56:57], v67 offset:4096
    ds_read_b64_tr_b16 a[58:59], v67 offset:6144
    v_mfma_f32_16x16x32_bf16 v[100:103], a[60:63], a[24:27], v[100:103]
    ds_read_b64_tr_b16 a[60:61], v68 offset:4096
    ds_read_b64_tr_b16 a[62:63], v68 offset:6144
    s_mov_b32 s66, 0x7000
    buffer_load_dwordx4 a[16:19], v73, s[48:51], s66 offen offset:0 sc1
    s_waitcnt vmcnt(9) lgkmcnt(15)
    v_mfma_f32_16x16x32_bf16 v[88:91], a[64:67], a[28:31], v[88:91]
    ds_read_b64_tr_b16 a[64:65], v65 offset:8192
    ds_read_b64_tr_b16 a[66:67], v65 offset:10240
    v_mfma_f32_16x16x32_bf16 v[92:95], a[68:71], a[28:31], v[92:95]
    ds_read_b64_tr_b16 a[68:69], v66 offset:8192
    ds_read_b64_tr_b16 a[70:71], v66 offset:10240
    s_cmp_ge_u32 s52, 31
    s_cbranch_scc0 L_sequential_preLN__sliding_local_dilated__mixer_s_mlp__prompt_kernel_nopeek_273_d
L_sequential_preLN__sliding_local_dilated__mixer_s_mlp__prompt_kernel_nopeek_273:
    v_mfma_f32_16x16x32_bf16 v[96:99], a[72:75], a[28:31], v[96:99]
    ds_read_b64_tr_b16 a[72:73], v67 offset:8192
    ds_read_b64_tr_b16 a[74:75], v67 offset:10240
    v_mfma_f32_16x16x32_bf16 v[100:103], a[76:79], a[28:31], v[100:103]
    ds_read_b64_tr_b16 a[76:77], v68 offset:8192
    ds_read_b64_tr_b16 a[78:79], v68 offset:10240
    v_mov_b32 v12, 29
    s_mov_b64 exec, 1
    ds_max_u32 v5, v12 offset:16
    s_mov_b64 exec, -1
    buffer_load_dwordx4 a[20:23], v73, s[48:51], s66 offen offset:1024 sc1
    s_waitcnt vmcnt(9) lgkmcnt(15)
    v_mfma_f32_16x16x32_bf16 v[88:91], a[80:83], a[32:35], v[88:91]
    ds_read_b64_tr_b16 a[80:81], v65 offset:12288
    ds_read_b64_tr_b16 a[82:83], v65 offset:14336
    v_mfma_f32_16x16x32_bf16 v[92:95], a[84:87], a[32:35], v[92:95]
    ds_read_b64_tr_b16 a[84:85], v66 offset:12288
    ds_read_b64_tr_b16 a[86:87], v66 offset:14336
    v_mfma_f32_16x16x32_bf16 v[96:99], a[88:91], a[32:35], v[96:99]
    ds_read_b64_tr_b16 a[88:89], v67 offset:12288
    ds_read_b64_tr_b16 a[90:91], v67 offset:14336
    v_mfma_f32_16x16x32_bf16 v[100:103], a[92:95], a[32:35], v[100:103]
    ds_read_b64_tr_b16 a[92:93], v68 offset:12288
    ds_read_b64_tr_b16 a[94:95], v68 offset:14336
    buffer_load_dwordx4 a[24:27], v73, s[48:51], s66 offen offset:2048 sc1
    s_waitcnt vmcnt(9) lgkmcnt(15)
    v_mfma_f32_16x16x32_bf16 v[88:91], a[48:51], a[36:39], v[88:91]
    s_cmp_lt_u32 s52, 31
    s_cbranch_scc1 L_sequential_preLN__sliding_local_dilated__mixer_s_mlp__prompt_kernel_lws_275
L_sequential_preLN__sliding_local_dilated__mixer_s_mlp__prompt_kernel_lwb_274:
    ds_read_b64_tr_b16 a[48:49], v65 offset:16384
    ds_read_b64_tr_b16 a[50:51], v65 offset:18432
    v_mfma_f32_16x16x32_bf16 v[92:95], a[52:55], a[36:39], v[92:95]
    ds_read_b64_tr_b16 a[52:53], v66 offset:16384
    ds_read_b64_tr_b16 a[54:55], v66 offset:18432
    v_mfma_f32_16x16x32_bf16 v[96:99], a[56:59], a[36:39], v[96:99]
    ds_read_b64_tr_b16 a[56:57], v67 offset:16384
    ds_read_b64_tr_b16 a[58:59], v67 offset:18432
    v_mfma_f32_16x16x32_bf16 v[100:103], a[60:63], a[36:39], v[100:103]
    ds_read_b64_tr_b16 a[60:61], v68 offset:16384
    ds_read_b64_tr_b16 a[62:63], v68 offset:18432
    buffer_load_dwordx4 a[28:31], v73, s[48:51], s66 offen offset:3072 sc1
    s_waitcnt vmcnt(9) lgkmcnt(15)
    v_mfma_f32_16x16x32_bf16 v[88:91], a[64:67], a[40:43], v[88:91]
    ds_read_b64_tr_b16 a[64:65], v65 offset:20480
    ds_read_b64_tr_b16 a[66:67], v65 offset:22528
    v_mfma_f32_16x16x32_bf16 v[92:95], a[68:71], a[40:43], v[92:95]
    ds_read_b64_tr_b16 a[68:69], v66 offset:20480
    ds_read_b64_tr_b16 a[70:71], v66 offset:22528
    v_mfma_f32_16x16x32_bf16 v[96:99], a[72:75], a[40:43], v[96:99]
    ds_read_b64_tr_b16 a[72:73], v67 offset:20480
    ds_read_b64_tr_b16 a[74:75], v67 offset:22528
    v_mfma_f32_16x16x32_bf16 v[100:103], a[76:79], a[40:43], v[100:103]
    ds_read_b64_tr_b16 a[76:77], v68 offset:20480
    ds_read_b64_tr_b16 a[78:79], v68 offset:22528
    s_mov_b32 s66, 0x8000
    buffer_load_dwordx4 a[32:35], v73, s[48:51], s66 offen offset:0 sc1
    s_waitcnt vmcnt(9) lgkmcnt(15)
    v_mfma_f32_16x16x32_bf16 v[88:91], a[80:83], a[44:47], v[88:91]
    ds_read_b64_tr_b16 a[80:81], v65 offset:24576
    ds_read_b64_tr_b16 a[82:83], v65 offset:26624
    v_mfma_f32_16x16x32_bf16 v[92:95], a[84:87], a[44:47], v[92:95]
    ds_read_b64_tr_b16 a[84:85], v66 offset:24576
    ds_read_b64_tr_b16 a[86:87], v66 offset:26624
    s_cmp_ge_u32 s52, 32
    s_cbranch_scc0 L_sequential_preLN__sliding_local_dilated__mixer_s_mlp__prompt_kernel_nopeek_276_d
L_sequential_preLN__sliding_local_dilated__mixer_s_mlp__prompt_kernel_nopeek_276:
    v_mfma_f32_16x16x32_bf16 v[96:99], a[88:91], a[44:47], v[96:99]
    ds_read_b64_tr_b16 a[88:89], v67 offset:24576
    ds_read_b64_tr_b16 a[90:91], v67 offset:26624
    v_mfma_f32_16x16x32_bf16 v[100:103], a[92:95], a[44:47], v[100:103]
    ds_read_b64_tr_b16 a[92:93], v68 offset:24576
    ds_read_b64_tr_b16 a[94:95], v68 offset:26624
    buffer_load_dwordx4 a[36:39], v73, s[48:51], s66 offen offset:1024 sc1
    s_waitcnt vmcnt(9) lgkmcnt(15)
    v_mfma_f32_16x16x32_bf16 v[88:91], a[48:51], a[0:3], v[88:91]
    ds_read_b64_tr_b16 a[48:49], v65 offset:28672
    ds_read_b64_tr_b16 a[50:51], v65 offset:30720
    v_mfma_f32_16x16x32_bf16 v[92:95], a[52:55], a[0:3], v[92:95]
    ds_read_b64_tr_b16 a[52:53], v66 offset:28672
    ds_read_b64_tr_b16 a[54:55], v66 offset:30720
    v_mfma_f32_16x16x32_bf16 v[96:99], a[56:59], a[0:3], v[96:99]
    ds_read_b64_tr_b16 a[56:57], v67 offset:28672
    ds_read_b64_tr_b16 a[58:59], v67 offset:30720
    v_mfma_f32_16x16x32_bf16 v[100:103], a[60:63], a[0:3], v[100:103]
    ds_read_b64_tr_b16 a[60:61], v68 offset:28672
    ds_read_b64_tr_b16 a[62:63], v68 offset:30720
    buffer_load_dwordx4 a[40:43], v73, s[48:51], s66 offen offset:2048 sc1
    s_waitcnt vmcnt(9) lgkmcnt(15)
    v_mfma_f32_16x16x32_bf16 v[88:91], a[64:67], a[4:7], v[88:91]
    s_cmp_lt_u32 s52, 32
    s_cbranch_scc1 L_sequential_preLN__sliding_local_dilated__mixer_s_mlp__prompt_kernel_lws_278
L_sequential_preLN__sliding_local_dilated__mixer_s_mlp__prompt_kernel_lwb_277:
    ds_read_b64_tr_b16 a[64:65], v65 offset:32768
    ds_read_b64_tr_b16 a[66:67], v65 offset:34816
    v_mfma_f32_16x16x32_bf16 v[92:95], a[68:71], a[4:7], v[92:95]
    ds_read_b64_tr_b16 a[68:69], v66 offset:32768
    ds_read_b64_tr_b16 a[70:71], v66 offset:34816
    v_mfma_f32_16x16x32_bf16 v[96:99], a[72:75], a[4:7], v[96:99]
    ds_read_b64_tr_b16 a[72:73], v67 offset:32768
    ds_read_b64_tr_b16 a[74:75], v67 offset:34816
    v_mfma_f32_16x16x32_bf16 v[100:103], a[76:79], a[4:7], v[100:103]
    ds_read_b64_tr_b16 a[76:77], v68 offset:32768
    ds_read_b64_tr_b16 a[78:79], v68 offset:34816
    buffer_load_dwordx4 a[44:47], v73, s[48:51], s66 offen offset:3072 sc1
    s_waitcnt vmcnt(9) lgkmcnt(15)
    v_mfma_f32_16x16x32_bf16 v[88:91], a[80:83], a[8:11], v[88:91]
    ds_read_b64_tr_b16 a[80:81], v65 offset:36864
    ds_read_b64_tr_b16 a[82:83], v65 offset:38912
    v_mfma_f32_16x16x32_bf16 v[92:95], a[84:87], a[8:11], v[92:95]
    ds_read_b64_tr_b16 a[84:85], v66 offset:36864
    ds_read_b64_tr_b16 a[86:87], v66 offset:38912
    v_mfma_f32_16x16x32_bf16 v[96:99], a[88:91], a[8:11], v[96:99]
    ds_read_b64_tr_b16 a[88:89], v67 offset:36864
    ds_read_b64_tr_b16 a[90:91], v67 offset:38912
    v_mfma_f32_16x16x32_bf16 v[100:103], a[92:95], a[8:11], v[100:103]
    ds_read_b64_tr_b16 a[92:93], v68 offset:36864
    ds_read_b64_tr_b16 a[94:95], v68 offset:38912
    s_mov_b32 s66, 0x9000
    buffer_load_dwordx4 a[0:3], v73, s[48:51], s66 offen offset:0 sc1
    s_waitcnt vmcnt(9) lgkmcnt(15)
    v_mfma_f32_16x16x32_bf16 v[88:91], a[48:51], a[12:15], v[88:91]
    ds_read_b64_tr_b16 a[48:49], v65 offset:40960
    ds_read_b64_tr_b16 a[50:51], v65 offset:43008
    v_mfma_f32_16x16x32_bf16 v[92:95], a[52:55], a[12:15], v[92:95]
    ds_read_b64_tr_b16 a[52:53], v66 offset:40960
    ds_read_b64_tr_b16 a[54:55], v66 offset:43008
    s_cmp_ge_u32 s52, 33
    s_cbranch_scc0 L_sequential_preLN__sliding_local_dilated__mixer_s_mlp__prompt_kernel_nopeek_279_d
L_sequential_preLN__sliding_local_dilated__mixer_s_mlp__prompt_kernel_nopeek_279:
    v_mfma_f32_16x16x32_bf16 v[96:99], a[56:59], a[12:15], v[96:99]
    ds_read_b64_tr_b16 a[56:57], v67 offset:40960
    ds_read_b64_tr_b16 a[58:59], v67 offset:43008
    v_mfma_f32_16x16x32_bf16 v[100:103], a[60:63], a[12:15], v[100:103]
    ds_read_b64_tr_b16 a[60:61], v68 offset:40960
    ds_read_b64_tr_b16 a[62:63], v68 offset:43008
    buffer_load_dwordx4 a[4:7], v73, s[48:51], s66 offen offset:1024 sc1
    s_waitcnt vmcnt(9) lgkmcnt(15)
    v_mfma_f32_16x16x32_bf16 v[88:91], a[64:67], a[16:19], v[88:91]
    ds_read_b64_tr_b16 a[64:65], v65 offset:45056
    ds_read_b64_tr_b16 a[66:67], v65 offset:47104
    v_mfma_f32_16x16x32_bf16 v[92:95], a[68:71], a[16:19], v[92:95]
    ds_read_b64_tr_b16 a[68:69], v66 offset:45056
    ds_read_b64_tr_b16 a[70:71], v66 offset:47104
    v_mfma_f32_16x16x32_bf16 v[96:99], a[72:75], a[16:19], v[96:99]
    ds_read_b64_tr_b16 a[72:73], v67 offset:45056
    ds_read_b64_tr_b16 a[74:75], v67 offset:47104
    v_mfma_f32_16x16x32_bf16 v[100:103], a[76:79], a[16:19], v[100:103]
    ds_read_b64_tr_b16 a[76:77], v68 offset:45056
    ds_read_b64_tr_b16 a[78:79], v68 offset:47104
    buffer_load_dwordx4 a[8:11], v73, s[48:51], s66 offen offset:2048 sc1
    s_waitcnt vmcnt(9) lgkmcnt(15)
    v_mfma_f32_16x16x32_bf16 v[88:91], a[80:83], a[20:23], v[88:91]
    s_cmp_lt_u32 s52, 33
    s_cbranch_scc1 L_sequential_preLN__sliding_local_dilated__mixer_s_mlp__prompt_kernel_lws_281
L_sequential_preLN__sliding_local_dilated__mixer_s_mlp__prompt_kernel_lwb_280:
    ds_read_b64_tr_b16 a[80:81], v69 offset:0
    ds_read_b64_tr_b16 a[82:83], v69 offset:2048
    v_mfma_f32_16x16x32_bf16 v[92:95], a[84:87], a[20:23], v[92:95]
    ds_read_b64_tr_b16 a[84:85], v70 offset:0
    ds_read_b64_tr_b16 a[86:87], v70 offset:2048
    v_mfma_f32_16x16x32_bf16 v[96:99], a[88:91], a[20:23], v[96:99]
    ds_read_b64_tr_b16 a[88:89], v71 offset:0
    ds_read_b64_tr_b16 a[90:91], v71 offset:2048
    v_mfma_f32_16x16x32_bf16 v[100:103], a[92:95], a[20:23], v[100:103]
    ds_read_b64_tr_b16 a[92:93], v72 offset:0
    ds_read_b64_tr_b16 a[94:95], v72 offset:2048
    buffer_load_dwordx4 a[12:15], v73, s[48:51], s66 offen offset:3072 sc1
    s_waitcnt vmcnt(9) lgkmcnt(15)
    v_mfma_f32_16x16x32_bf16 v[88:91], a[48:51], a[24:27], v[88:91]
    ds_read_b64_tr_b16 a[48:49], v69 offset:4096
    ds_read_b64_tr_b16 a[50:51], v69 offset:6144
    v_mfma_f32_16x16x32_bf16 v[92:95], a[52:55], a[24:27], v[92:95]
    ds_read_b64_tr_b16 a[52:53], v70 offset:4096
    ds_read_b64_tr_b16 a[54:55], v70 offset:6144
    v_mfma_f32_16x16x32_bf16 v[96:99], a[56:59], a[24:27], v[96:99]
    ds_read_b64_tr_b16 a[56:57], v71 offset:4096
    ds_read_b64_tr_b16 a[58:59], v71 offset:6144
    v_mfma_f32_16x16x32_bf16 v[100:103], a[60:63], a[24:27], v[100:103]
    ds_read_b64_tr_b16 a[60:61], v72 offset:4096
    ds_read_b64_tr_b16 a[62:63], v72 offset:6144
    s_mov_b32 s66, 0xa000
    buffer_load_dwordx4 a[16:19], v73, s[48:51], s66 offen offset:0 sc1
    s_waitcnt vmcnt(9) lgkmcnt(15)
    v_mfma_f32_16x16x32_bf16 v[88:91], a[64:67], a[28:31], v[88:91]
    ds_read_b64_tr_b16 a[64:65], v69 offset:8192
    ds_read_b64_tr_b16 a[66:67], v69 offset:10240
    v_mfma_f32_16x16x32_bf16 v[92:95], a[68:71], a[28:31], v[92:95]
    ds_read_b64_tr_b16 a[68:69], v70 offset:8192
    ds_read_b64_tr_b16 a[70:71], v70 offset:10240
    s_cmp_ge_u32 s52, 34
    s_cbranch_scc0 L_sequential_preLN__sliding_local_dilated__mixer_s_mlp__prompt_kernel_nopeek_282_d
L_sequential_preLN__sliding_local_dilated__mixer_s_mlp__prompt_kernel_nopeek_282:
    v_mfma_f32_16x16x32_bf16 v[96:99], a[72:75], a[28:31], v[96:99]
    ds_read_b64_tr_b16 a[72:73], v71 offset:8192
    ds_read_b64_tr_b16 a[74:75], v71 offset:10240
    v_mfma_f32_16x16x32_bf16 v[100:103], a[76:79], a[28:31], v[100:103]
    ds_read_b64_tr_b16 a[76:77], v72 offset:8192
    ds_read_b64_tr_b16 a[78:79], v72 offset:10240
    buffer_load_dwordx4 a[20:23], v73, s[48:51], s66 offen offset:1024 sc1
    s_waitcnt vmcnt(9) lgkmcnt(15)
    v_mfma_f32_16x16x32_bf16 v[88:91], a[80:83], a[32:35], v[88:91]
    ds_read_b64_tr_b16 a[80:81], v69 offset:12288
    ds_read_b64_tr_b16 a[82:83], v69 offset:14336
    v_mfma_f32_16x16x32_bf16 v[92:95], a[84:87], a[32:35], v[92:95]
    ds_read_b64_tr_b16 a[84:85], v70 offset:12288
    ds_read_b64_tr_b16 a[86:87], v70 offset:14336
    v_mfma_f32_16x16x32_bf16 v[96:99], a[88:91], a[32:35], v[96:99]
    ds_read_b64_tr_b16 a[88:89], v71 offset:12288
    ds_read_b64_tr_b16 a[90:91], v71 offset:14336
    v_mfma_f32_16x16x32_bf16 v[100:103], a[92:95], a[32:35], v[100:103]
    ds_read_b64_tr_b16 a[92:93], v72 offset:12288
    ds_read_b64_tr_b16 a[94:95], v72 offset:14336
    buffer_load_dwordx4 a[24:27], v73, s[48:51], s66 offen offset:2048 sc1
    s_waitcnt vmcnt(9) lgkmcnt(15)
    v_mfma_f32_16x16x32_bf16 v[88:91], a[48:51], a[36:39], v[88:91]
    s_cmp_lt_u32 s52, 34
    s_cbranch_scc1 L_sequential_preLN__sliding_local_dilated__mixer_s_mlp__prompt_kernel_lws_284
L_sequential_preLN__sliding_local_dilated__mixer_s_mlp__prompt_kernel_lwb_283:
    ds_read_b64_tr_b16 a[48:49], v69 offset:16384
    ds_read_b64_tr_b16 a[50:51], v69 offset:18432
    v_mfma_f32_16x16x32_bf16 v[92:95], a[52:55], a[36:39], v[92:95]
    ds_read_b64_tr_b16 a[52:53], v70 offset:16384
    ds_read_b64_tr_b16 a[54:55], v70 offset:18432
    v_mfma_f32_16x16x32_bf16 v[96:99], a[56:59], a[36:39], v[96:99]
    ds_read_b64_tr_b16 a[56:57], v71 offset:16384
    ds_read_b64_tr_b16 a[58:59], v71 offset:18432
    v_mfma_f32_16x16x32_bf16 v[100:103], a[60:63], a[36:39], v[100:103]
    ds_read_b64_tr_b16 a[60:61], v72 offset:16384
    ds_read_b64_tr_b16 a[62:63], v72 offset:18432
    buffer_load_dwordx4 a[28:31], v73, s[48:51], s66 offen offset:3072 sc1
    s_waitcnt vmcnt(9) lgkmcnt(15)
    v_mfma_f32_16x16x32_bf16 v[88:91], a[64:67], a[40:43], v[88:91]
    ds_read_b64_tr_b16 a[64:65], v69 offset:20480
    ds_read_b64_tr_b16 a[66:67], v69 offset:22528
    v_mfma_f32_16x16x32_bf16 v[92:95], a[68:71], a[40:43], v[92:95]
    ds_read_b64_tr_b16 a[68:69], v70 offset:20480
    ds_read_b64_tr_b16 a[70:71], v70 offset:22528
    v_mfma_f32_16x16x32_bf16 v[96:99], a[72:75], a[40:43], v[96:99]
    ds_read_b64_tr_b16 a[72:73], v71 offset:20480
    ds_read_b64_tr_b16 a[74:75], v71 offset:22528
    v_mfma_f32_16x16x32_bf16 v[100:103], a[76:79], a[40:43], v[100:103]
    ds_read_b64_tr_b16 a[76:77], v72 offset:20480
    ds_read_b64_tr_b16 a[78:79], v72 offset:22528
    s_mov_b32 s66, 0xb000
    buffer_load_dwordx4 a[32:35], v73, s[48:51], s66 offen offset:0 sc1
    s_waitcnt vmcnt(9) lgkmcnt(15)
    v_mfma_f32_16x16x32_bf16 v[88:91], a[80:83], a[44:47], v[88:91]
    ds_read_b64_tr_b16 a[80:81], v69 offset:24576
    ds_read_b64_tr_b16 a[82:83], v69 offset:26624
    v_mfma_f32_16x16x32_bf16 v[92:95], a[84:87], a[44:47], v[92:95]
    ds_read_b64_tr_b16 a[84:85], v70 offset:24576
    ds_read_b64_tr_b16 a[86:87], v70 offset:26624
    s_cmp_ge_u32 s52, 35
    s_cbranch_scc0 L_sequential_preLN__sliding_local_dilated__mixer_s_mlp__prompt_kernel_nopeek_285_d
L_sequential_preLN__sliding_local_dilated__mixer_s_mlp__prompt_kernel_nopeek_285:
    v_mfma_f32_16x16x32_bf16 v[96:99], a[88:91], a[44:47], v[96:99]
    ds_read_b64_tr_b16 a[88:89], v71 offset:24576
    ds_read_b64_tr_b16 a[90:91], v71 offset:26624
    v_mfma_f32_16x16x32_bf16 v[100:103], a[92:95], a[44:47], v[100:103]
    ds_read_b64_tr_b16 a[92:93], v72 offset:24576
    ds_read_b64_tr_b16 a[94:95], v72 offset:26624
    buffer_load_dwordx4 a[36:39], v73, s[48:51], s66 offen offset:1024 sc1
    s_waitcnt vmcnt(9) lgkmcnt(15)
    v_mfma_f32_16x16x32_bf16 v[88:91], a[48:51], a[0:3], v[88:91]
    ds_read_b64_tr_b16 a[48:49], v69 offset:28672
    ds_read_b64_tr_b16 a[50:51], v69 offset:30720
    v_mfma_f32_16x16x32_bf16 v[92:95], a[52:55], a[0:3], v[92:95]
    ds_read_b64_tr_b16 a[52:53], v70 offset:28672
    ds_read_b64_tr_b16 a[54:55], v70 offset:30720
    v_mfma_f32_16x16x32_bf16 v[96:99], a[56:59], a[0:3], v[96:99]
    ds_read_b64_tr_b16 a[56:57], v71 offset:28672
    ds_read_b64_tr_b16 a[58:59], v71 offset:30720
    v_mfma_f32_16x16x32_bf16 v[100:103], a[60:63], a[0:3], v[100:103]
    ds_read_b64_tr_b16 a[60:61], v72 offset:28672
    ds_read_b64_tr_b16 a[62:63], v72 offset:30720
    buffer_load_dwordx4 a[40:43], v73, s[48:51], s66 offen offset:2048 sc1
    s_waitcnt vmcnt(9) lgkmcnt(15)
    v_mfma_f32_16x16x32_bf16 v[88:91], a[64:67], a[4:7], v[88:91]
    s_cmp_lt_u32 s52, 35
    s_cbranch_scc1 L_sequential_preLN__sliding_local_dilated__mixer_s_mlp__prompt_kernel_lws_287
L_sequential_preLN__sliding_local_dilated__mixer_s_mlp__prompt_kernel_lwb_286:
    ds_read_b64_tr_b16 a[64:65], v69 offset:32768
    ds_read_b64_tr_b16 a[66:67], v69 offset:34816
    v_mfma_f32_16x16x32_bf16 v[92:95], a[68:71], a[4:7], v[92:95]
    ds_read_b64_tr_b16 a[68:69], v70 offset:32768
    ds_read_b64_tr_b16 a[70:71], v70 offset:34816
    v_mfma_f32_16x16x32_bf16 v[96:99], a[72:75], a[4:7], v[96:99]
    ds_read_b64_tr_b16 a[72:73], v71 offset:32768
    ds_read_b64_tr_b16 a[74:75], v71 offset:34816
    v_mfma_f32_16x16x32_bf16 v[100:103], a[76:79], a[4:7], v[100:103]
    ds_read_b64_tr_b16 a[76:77], v72 offset:32768
    ds_read_b64_tr_b16 a[78:79], v72 offset:34816
    buffer_load_dwordx4 a[44:47], v73, s[48:51], s66 offen offset:3072 sc1
    s_waitcnt vmcnt(9) lgkmcnt(15)
    v_mfma_f32_16x16x32_bf16 v[88:91], a[80:83], a[8:11], v[88:91]
    ds_read_b64_tr_b16 a[80:81], v69 offset:36864
    ds_read_b64_tr_b16 a[82:83], v69 offset:38912
    v_mfma_f32_16x16x32_bf16 v[92:95], a[84:87], a[8:11], v[92:95]
    ds_read_b64_tr_b16 a[84:85], v70 offset:36864
    ds_read_b64_tr_b16 a[86:87], v70 offset:38912
    v_mfma_f32_16x16x32_bf16 v[96:99], a[88:91], a[8:11], v[96:99]
    ds_read_b64_tr_b16 a[88:89], v71 offset:36864
    ds_read_b64_tr_b16 a[90:91], v71 offset:38912
    v_mfma_f32_16x16x32_bf16 v[100:103], a[92:95], a[8:11], v[100:103]
    ds_read_b64_tr_b16 a[92:93], v72 offset:36864
    ds_read_b64_tr_b16 a[94:95], v72 offset:38912
    s_mov_b32 s66, 0xc000
    buffer_load_dwordx4 a[0:3], v73, s[48:51], s66 offen offset:0 sc1
    s_waitcnt vmcnt(9) lgkmcnt(15)
    v_mfma_f32_16x16x32_bf16 v[88:91], a[48:51], a[12:15], v[88:91]
    ds_read_b64_tr_b16 a[48:49], v69 offset:40960
    ds_read_b64_tr_b16 a[50:51], v69 offset:43008
    v_mfma_f32_16x16x32_bf16 v[92:95], a[52:55], a[12:15], v[92:95]
    ds_read_b64_tr_b16 a[52:53], v70 offset:40960
    ds_read_b64_tr_b16 a[54:55], v70 offset:43008
    s_cmp_ge_u32 s52, 36
    s_cbranch_scc0 L_sequential_preLN__sliding_local_dilated__mixer_s_mlp__prompt_kernel_nopeek_288_d
L_sequential_preLN__sliding_local_dilated__mixer_s_mlp__prompt_kernel_nopeek_288:
    v_mfma_f32_16x16x32_bf16 v[96:99], a[56:59], a[12:15], v[96:99]
    ds_read_b64_tr_b16 a[56:57], v71 offset:40960
    ds_read_b64_tr_b16 a[58:59], v71 offset:43008
    v_mfma_f32_16x16x32_bf16 v[100:103], a[60:63], a[12:15], v[100:103]
    ds_read_b64_tr_b16 a[60:61], v72 offset:40960
    ds_read_b64_tr_b16 a[62:63], v72 offset:43008
    buffer_load_dwordx4 a[4:7], v73, s[48:51], s66 offen offset:1024 sc1
    s_waitcnt vmcnt(9) lgkmcnt(15)
    v_mfma_f32_16x16x32_bf16 v[88:91], a[64:67], a[16:19], v[88:91]
    ds_read_b64_tr_b16 a[64:65], v69 offset:45056
    ds_read_b64_tr_b16 a[66:67], v69 offset:47104
    v_mfma_f32_16x16x32_bf16 v[92:95], a[68:71], a[16:19], v[92:95]
    ds_read_b64_tr_b16 a[68:69], v70 offset:45056
    ds_read_b64_tr_b16 a[70:71], v70 offset:47104
    v_mfma_f32_16x16x32_bf16 v[96:99], a[72:75], a[16:19], v[96:99]
    ds_read_b64_tr_b16 a[72:73], v71 offset:45056
    ds_read_b64_tr_b16 a[74:75], v71 offset:47104
    v_mfma_f32_16x16x32_bf16 v[100:103], a[76:79], a[16:19], v[100:103]
    ds_read_b64_tr_b16 a[76:77], v72 offset:45056
    ds_read_b64_tr_b16 a[78:79], v72 offset:47104
    buffer_load_dwordx4 a[8:11], v73, s[48:51], s66 offen offset:2048 sc1
    s_waitcnt vmcnt(9) lgkmcnt(15)
    v_mfma_f32_16x16x32_bf16 v[88:91], a[80:83], a[20:23], v[88:91]
    s_cmp_lt_u32 s52, 36
    s_cbranch_scc1 L_sequential_preLN__sliding_local_dilated__mixer_s_mlp__prompt_kernel_lws_290
L_sequential_preLN__sliding_local_dilated__mixer_s_mlp__prompt_kernel_lwb_289:
    ds_read_b64_tr_b16 a[80:81], v27 offset:0
    ds_read_b64_tr_b16 a[82:83], v27 offset:2048
    v_mfma_f32_16x16x32_bf16 v[92:95], a[84:87], a[20:23], v[92:95]
    ds_read_b64_tr_b16 a[84:85], v28 offset:0
    ds_read_b64_tr_b16 a[86:87], v28 offset:2048
    v_mfma_f32_16x16x32_bf16 v[96:99], a[88:91], a[20:23], v[96:99]
    ds_read_b64_tr_b16 a[88:89], v29 offset:0
    ds_read_b64_tr_b16 a[90:91], v29 offset:2048
    v_mfma_f32_16x16x32_bf16 v[100:103], a[92:95], a[20:23], v[100:103]
    ds_read_b64_tr_b16 a[92:93], v30 offset:0
    ds_read_b64_tr_b16 a[94:95], v30 offset:2048
    buffer_load_dwordx4 a[12:15], v73, s[48:51], s66 offen offset:3072 sc1
    s_waitcnt vmcnt(9) lgkmcnt(15)
    v_mfma_f32_16x16x32_bf16 v[88:91], a[48:51], a[24:27], v[88:91]
    ds_read_b64_tr_b16 a[48:49], v27 offset:4096
    ds_read_b64_tr_b16 a[50:51], v27 offset:6144
    v_mfma_f32_16x16x32_bf16 v[92:95], a[52:55], a[24:27], v[92:95]
    ds_read_b64_tr_b16 a[52:53], v28 offset:4096
    ds_read_b64_tr_b16 a[54:55], v28 offset:6144
    v_mfma_f32_16x16x32_bf16 v[96:99], a[56:59], a[24:27], v[96:99]
    ds_read_b64_tr_b16 a[56:57], v29 offset:4096
    ds_read_b64_tr_b16 a[58:59], v29 offset:6144
    v_mfma_f32_16x16x32_bf16 v[100:103], a[60:63], a[24:27], v[100:103]
    ds_read_b64_tr_b16 a[60:61], v30 offset:4096
    ds_read_b64_tr_b16 a[62:63], v30 offset:6144
    s_mov_b32 s66, 0xd000
    buffer_load_dwordx4 a[16:19], v73, s[48:51], s66 offen offset:0 sc1
    s_waitcnt vmcnt(9) lgkmcnt(15)
    v_mfma_f32_16x16x32_bf16 v[88:91], a[64:67], a[28:31], v[88:91]
    ds_read_b64_tr_b16 a[64:65], v27 offset:8192
    ds_read_b64_tr_b16 a[66:67], v27 offset:10240
    v_mfma_f32_16x16x32_bf16 v[92:95], a[68:71], a[28:31], v[92:95]
    ds_read_b64_tr_b16 a[68:69], v28 offset:8192
    ds_read_b64_tr_b16 a[70:71], v28 offset:10240
    s_cmp_ge_u32 s52, 37
    s_cbranch_scc0 L_sequential_preLN__sliding_local_dilated__mixer_s_mlp__prompt_kernel_nopeek_291_d
L_sequential_preLN__sliding_local_dilated__mixer_s_mlp__prompt_kernel_nopeek_291:
    v_mfma_f32_16x16x32_bf16 v[96:99], a[72:75], a[28:31], v[96:99]
    ds_read_b64_tr_b16 a[72:73], v29 offset:8192
    ds_read_b64_tr_b16 a[74:75], v29 offset:10240
    v_mfma_f32_16x16x32_bf16 v[100:103], a[76:79], a[28:31], v[100:103]
    ds_read_b64_tr_b16 a[76:77], v30 offset:8192
    ds_read_b64_tr_b16 a[78:79], v30 offset:10240
    buffer_load_dwordx4 a[20:23], v73, s[48:51], s66 offen offset:1024 sc1
    s_waitcnt vmcnt(9) lgkmcnt(15)
    v_mfma_f32_16x16x32_bf16 v[88:91], a[80:83], a[32:35], v[88:91]
    ds_read_b64_tr_b16 a[80:81], v27 offset:12288
    ds_read_b64_tr_b16 a[82:83], v27 offset:14336
    v_mfma_f32_16x16x32_bf16 v[92:95], a[84:87], a[32:35], v[92:95]
    ds_read_b64_tr_b16 a[84:85], v28 offset:12288
    ds_read_b64_tr_b16 a[86:87], v28 offset:14336
    v_mfma_f32_16x16x32_bf16 v[96:99], a[88:91], a[32:35], v[96:99]
    ds_read_b64_tr_b16 a[88:89], v29 offset:12288
    ds_read_b64_tr_b16 a[90:91], v29 offset:14336
    v_mfma_f32_16x16x32_bf16 v[100:103], a[92:95], a[32:35], v[100:103]
    ds_read_b64_tr_b16 a[92:93], v30 offset:12288
    ds_read_b64_tr_b16 a[94:95], v30 offset:14336
    buffer_load_dwordx4 a[24:27], v73, s[48:51], s66 offen offset:2048 sc1
    s_waitcnt vmcnt(9) lgkmcnt(15)
    v_mfma_f32_16x16x32_bf16 v[88:91], a[48:51], a[36:39], v[88:91]
    s_cmp_lt_u32 s52, 37
    s_cbranch_scc1 L_sequential_preLN__sliding_local_dilated__mixer_s_mlp__prompt_kernel_lws_293
L_sequential_preLN__sliding_local_dilated__mixer_s_mlp__prompt_kernel_lwb_292:
    ds_read_b64_tr_b16 a[48:49], v27 offset:16384
    ds_read_b64_tr_b16 a[50:51], v27 offset:18432
    v_mfma_f32_16x16x32_bf16 v[92:95], a[52:55], a[36:39], v[92:95]
    ds_read_b64_tr_b16 a[52:53], v28 offset:16384
    ds_read_b64_tr_b16 a[54:55], v28 offset:18432
    v_mfma_f32_16x16x32_bf16 v[96:99], a[56:59], a[36:39], v[96:99]
    ds_read_b64_tr_b16 a[56:57], v29 offset:16384
    ds_read_b64_tr_b16 a[58:59], v29 offset:18432
    v_mfma_f32_16x16x32_bf16 v[100:103], a[60:63], a[36:39], v[100:103]
    ds_read_b64_tr_b16 a[60:61], v30 offset:16384
    ds_read_b64_tr_b16 a[62:63], v30 offset:18432
    buffer_load_dwordx4 a[28:31], v73, s[48:51], s66 offen offset:3072 sc1
    s_waitcnt vmcnt(9) lgkmcnt(15)
    v_mfma_f32_16x16x32_bf16 v[88:91], a[64:67], a[40:43], v[88:91]
    ds_read_b64_tr_b16 a[64:65], v27 offset:20480
    ds_read_b64_tr_b16 a[66:67], v27 offset:22528
    v_mfma_f32_16x16x32_bf16 v[92:95], a[68:71], a[40:43], v[92:95]
    ds_read_b64_tr_b16 a[68:69], v28 offset:20480
    ds_read_b64_tr_b16 a[70:71], v28 offset:22528
    v_mfma_f32_16x16x32_bf16 v[96:99], a[72:75], a[40:43], v[96:99]
    ds_read_b64_tr_b16 a[72:73], v29 offset:20480
    ds_read_b64_tr_b16 a[74:75], v29 offset:22528
    v_mfma_f32_16x16x32_bf16 v[100:103], a[76:79], a[40:43], v[100:103]
    ds_read_b64_tr_b16 a[76:77], v30 offset:20480
    ds_read_b64_tr_b16 a[78:79], v30 offset:22528
    s_waitcnt vmcnt(8) lgkmcnt(15)
    v_mfma_f32_16x16x32_bf16 v[88:91], a[80:83], a[44:47], v[88:91]
    ds_read_b64_tr_b16 a[80:81], v27 offset:24576
    ds_read_b64_tr_b16 a[82:83], v27 offset:26624
    v_mfma_f32_16x16x32_bf16 v[92:95], a[84:87], a[44:47], v[92:95]
    ds_read_b64_tr_b16 a[84:85], v28 offset:24576
    ds_read_b64_tr_b16 a[86:87], v28 offset:26624
    s_cmp_ge_u32 s52, 38
    s_cbranch_scc0 L_sequential_preLN__sliding_local_dilated__mixer_s_mlp__prompt_kernel_nopeek_294_d
L_sequential_preLN__sliding_local_dilated__mixer_s_mlp__prompt_kernel_nopeek_294:
    v_mfma_f32_16x16x32_bf16 v[96:99], a[88:91], a[44:47], v[96:99]
    ds_read_b64_tr_b16 a[88:89], v29 offset:24576
    ds_read_b64_tr_b16 a[90:91], v29 offset:26624
    v_mfma_f32_16x16x32_bf16 v[100:103], a[92:95], a[44:47], v[100:103]
    ds_read_b64_tr_b16 a[92:93], v30 offset:24576
    ds_read_b64_tr_b16 a[94:95], v30 offset:26624
    s_waitcnt vmcnt(7) lgkmcnt(15)
    v_mfma_f32_16x16x32_bf16 v[88:91], a[48:51], a[0:3], v[88:91]
    ds_read_b64_tr_b16 a[48:49], v27 offset:28672
    ds_read_b64_tr_b16 a[50:51], v27 offset:30720
    v_mfma_f32_16x16x32_bf16 v[92:95], a[52:55], a[0:3], v[92:95]
    ds_read_b64_tr_b16 a[52:53], v28 offset:28672
    ds_read_b64_tr_b16 a[54:55], v28 offset:30720
    v_mfma_f32_16x16x32_bf16 v[96:99], a[56:59], a[0:3], v[96:99]
    ds_read_b64_tr_b16 a[56:57], v29 offset:28672
    ds_read_b64_tr_b16 a[58:59], v29 offset:30720
    v_mfma_f32_16x16x32_bf16 v[100:103], a[60:63], a[0:3], v[100:103]
    ds_read_b64_tr_b16 a[60:61], v30 offset:28672
    ds_read_b64_tr_b16 a[62:63], v30 offset:30720
    s_waitcnt vmcnt(6) lgkmcnt(15)
    v_mfma_f32_16x16x32_bf16 v[88:91], a[64:67], a[4:7], v[88:91]
    s_cmp_lt_u32 s52, 38
    s_cbranch_scc1 L_sequential_preLN__sliding_local_dilated__mixer_s_mlp__prompt_kernel_lws_296
L_sequential_preLN__sliding_local_dilated__mixer_s_mlp__prompt_kernel_lwb_295:
    ds_read_b64_tr_b16 a[64:65], v27 offset:32768
    ds_read_b64_tr_b16 a[66:67], v27 offset:34816
    v_mfma_f32_16x16x32_bf16 v[92:95], a[68:71], a[4:7], v[92:95]
    ds_read_b64_tr_b16 a[68:69], v28 offset:32768
    ds_read_b64_tr_b16 a[70:71], v28 offset:34816
    v_mfma_f32_16x16x32_bf16 v[96:99], a[72:75], a[4:7], v[96:99]
    ds_read_b64_tr_b16 a[72:73], v29 offset:32768
    ds_read_b64_tr_b16 a[74:75], v29 offset:34816
    v_mfma_f32_16x16x32_bf16 v[100:103], a[76:79], a[4:7], v[100:103]
    ds_read_b64_tr_b16 a[76:77], v30 offset:32768
    ds_read_b64_tr_b16 a[78:79], v30 offset:34816
    s_waitcnt vmcnt(5) lgkmcnt(15)
    v_mfma_f32_16x16x32_bf16 v[88:91], a[80:83], a[8:11], v[88:91]
    ds_read_b64_tr_b16 a[80:81], v27 offset:36864
    ds_read_b64_tr_b16 a[82:83], v27 offset:38912
    v_mfma_f32_16x16x32_bf16 v[92:95], a[84:87], a[8:11], v[92:95]
    ds_read_b64_tr_b16 a[84:85], v28 offset:36864
    ds_read_b64_tr_b16 a[86:87], v28 offset:38912
    v_mfma_f32_16x16x32_bf16 v[96:99], a[88:91], a[8:11], v[96:99]
    ds_read_b64_tr_b16 a[88:89], v29 offset:36864
    ds_read_b64_tr_b16 a[90:91], v29 offset:38912
    v_mfma_f32_16x16x32_bf16 v[100:103], a[92:95], a[8:11], v[100:103]
    ds_read_b64_tr_b16 a[92:93], v30 offset:36864
    ds_read_b64_tr_b16 a[94:95], v30 offset:38912
    s_waitcnt vmcnt(4) lgkmcnt(15)
    v_mfma_f32_16x16x32_bf16 v[88:91], a[48:51], a[12:15], v[88:91]
    ds_read_b64_tr_b16 a[48:49], v27 offset:40960
    ds_read_b64_tr_b16 a[50:51], v27 offset:43008
    v_mfma_f32_16x16x32_bf16 v[92:95], a[52:55], a[12:15], v[92:95]
    ds_read_b64_tr_b16 a[52:53], v28 offset:40960
    ds_read_b64_tr_b16 a[54:55], v28 offset:43008
    v_mfma_f32_16x16x32_bf16 v[96:99], a[56:59], a[12:15], v[96:99]
    ds_read_b64_tr_b16 a[56:57], v29 offset:40960
    ds_read_b64_tr_b16 a[58:59], v29 offset:43008
    v_mfma_f32_16x16x32_bf16 v[100:103], a[60:63], a[12:15], v[100:103]
    ds_read_b64_tr_b16 a[60:61], v30 offset:40960
    ds_read_b64_tr_b16 a[62:63], v30 offset:43008
    s_waitcnt vmcnt(3) lgkmcnt(15)
    v_mfma_f32_16x16x32_bf16 v[88:91], a[64:67], a[16:19], v[88:91]
    ds_read_b64_tr_b16 a[64:65], v27 offset:45056
    ds_read_b64_tr_b16 a[66:67], v27 offset:47104
    v_mfma_f32_16x16x32_bf16 v[92:95], a[68:71], a[16:19], v[92:95]
    ds_read_b64_tr_b16 a[68:69], v28 offset:45056
    ds_read_b64_tr_b16 a[70:71], v28 offset:47104
    v_mfma_f32_16x16x32_bf16 v[96:99], a[72:75], a[16:19], v[96:99]
    ds_read_b64_tr_b16 a[72:73], v29 offset:45056
    ds_read_b64_tr_b16 a[74:75], v29 offset:47104
    v_mfma_f32_16x16x32_bf16 v[100:103], a[76:79], a[16:19], v[100:103]
    ds_read_b64_tr_b16 a[76:77], v30 offset:45056
    ds_read_b64_tr_b16 a[78:79], v30 offset:47104
    s_waitcnt vmcnt(2) lgkmcnt(15)
    v_mfma_f32_16x16x32_bf16 v[88:91], a[80:83], a[20:23], v[88:91]
    v_mfma_f32_16x16x32_bf16 v[92:95], a[84:87], a[20:23], v[92:95]
    v_mfma_f32_16x16x32_bf16 v[96:99], a[88:91], a[20:23], v[96:99]
    v_mfma_f32_16x16x32_bf16 v[100:103], a[92:95], a[20:23], v[100:103]
    s_waitcnt vmcnt(1) lgkmcnt(8)
    v_mfma_f32_16x16x32_bf16 v[88:91], a[48:51], a[24:27], v[88:91]
    v_mfma_f32_16x16x32_bf16 v[92:95], a[52:55], a[24:27], v[92:95]
    v_mfma_f32_16x16x32_bf16 v[96:99], a[56:59], a[24:27], v[96:99]
    v_mfma_f32_16x16x32_bf16 v[100:103], a[60:63], a[24:27], v[100:103]
    s_waitcnt vmcnt(0) lgkmcnt(0)
    v_mfma_f32_16x16x32_bf16 v[88:91], a[64:67], a[28:31], v[88:91]
    v_mfma_f32_16x16x32_bf16 v[92:95], a[68:71], a[28:31], v[92:95]
    v_mfma_f32_16x16x32_bf16 v[96:99], a[72:75], a[28:31], v[96:99]
    v_mfma_f32_16x16x32_bf16 v[100:103], a[76:79], a[28:31], v[100:103]
    s_nop 4
    s_lshl_b32 s33, s32, 7
    v_cvt_pk_bf16_f32 v120, v88, v89
    v_cvt_pk_bf16_f32 v121, v90, v91
    v_cvt_pk_bf16_f32 v122, v92, v93
    v_cvt_pk_bf16_f32 v123, v94, v95
    v_cvt_pk_bf16_f32 v124, v96, v97
    v_cvt_pk_bf16_f32 v125, v98, v99
    v_cvt_pk_bf16_f32 v126, v100, v101
    v_cvt_pk_bf16_f32 v127, v102, v103
    s_nop 0
    v_permlane16_swap_b32 v120, v122
    v_permlane16_swap_b32 v121, v123
    v_permlane16_swap_b32 v124, v126
    v_permlane16_swap_b32 v125, v127
    buffer_store_dwordx4 v[120:123], v25, s[60:63], s33 offen offset:0
    buffer_store_dwordx4 v[124:127], v25, s[60:63], s33 offen offset:64
L_end:
    s_endpgm
L_sequential_preLN__sliding_local_dilated__mixer_s_mlp__prompt_kernel_lws_260:
    s_movk_i32 s42, 26
    s_call_b64 s[44:45], L_wait_c_0_52_0
    s_branch L_sequential_preLN__sliding_local_dilated__mixer_s_mlp__prompt_kernel_lwb_259
L_sequential_preLN__sliding_local_dilated__mixer_s_mlp__prompt_kernel_nopeek_261_d:
    s_mov_b64 exec, 1
    ds_read_b128 v[8:11], v4 offset:0
    s_waitcnt lgkmcnt(0)
    v_min3_u32 v8, v8, v9, v10
    v_min_u32 v8, v8, v11
    s_nop 0
    v_readfirstlane_b32 s52, v8
    s_mov_b64 exec, -1
    s_branch L_sequential_preLN__sliding_local_dilated__mixer_s_mlp__prompt_kernel_nopeek_261
L_sequential_preLN__sliding_local_dilated__mixer_s_mlp__prompt_kernel_lws_263:
    s_movk_i32 s42, 27
    s_call_b64 s[44:45], L_wait_c_0_52_0
    s_branch L_sequential_preLN__sliding_local_dilated__mixer_s_mlp__prompt_kernel_lwb_262
L_sequential_preLN__sliding_local_dilated__mixer_s_mlp__prompt_kernel_nopeek_264_d:
    s_mov_b64 exec, 1
    ds_read_b128 v[8:11], v4 offset:0
    s_waitcnt lgkmcnt(0)
    v_min3_u32 v8, v8, v9, v10
    v_min_u32 v8, v8, v11
    s_nop 0
    v_readfirstlane_b32 s52, v8
    s_mov_b64 exec, -1
    s_branch L_sequential_preLN__sliding_local_dilated__mixer_s_mlp__prompt_kernel_nopeek_264
L_sequential_preLN__sliding_local_dilated__mixer_s_mlp__prompt_kernel_lws_266:
    s_movk_i32 s42, 28
    s_call_b64 s[44:45], L_wait_c_0_52_0
    s_branch L_sequential_preLN__sliding_local_dilated__mixer_s_mlp__prompt_kernel_lwb_265
L_sequential_preLN__sliding_local_dilated__mixer_s_mlp__prompt_kernel_nopeek_267_d:
    s_mov_b64 exec, 1
    ds_read_b128 v[8:11], v4 offset:0
    s_waitcnt lgkmcnt(0)
    v_min3_u32 v8, v8, v9, v10
    v_min_u32 v8, v8, v11
    s_nop 0
    v_readfirstlane_b32 s52, v8
    s_mov_b64 exec, -1
    s_branch L_sequential_preLN__sliding_local_dilated__mixer_s_mlp__prompt_kernel_nopeek_267
L_sequential_preLN__sliding_local_dilated__mixer_s_mlp__prompt_kernel_lws_269:
    s_movk_i32 s42, 29
    s_call_b64 s[44:45], L_wait_c_0_52_0
    s_branch L_sequential_preLN__sliding_local_dilated__mixer_s_mlp__prompt_kernel_lwb_268
L_sequential_preLN__sliding_local_dilated__mixer_s_mlp__prompt_kernel_nopeek_270_d:
    s_mov_b64 exec, 1
    ds_read_b128 v[8:11], v4 offset:0
    s_waitcnt lgkmcnt(0)
    v_min3_u32 v8, v8, v9, v10
    v_min_u32 v8, v8, v11
    s_nop 0
    v_readfirstlane_b32 s52, v8
    s_mov_b64 exec, -1
    s_branch L_sequential_preLN__sliding_local_dilated__mixer_s_mlp__prompt_kernel_nopeek_270
L_sequential_preLN__sliding_local_dilated__mixer_s_mlp__prompt_kernel_lws_272:
    s_movk_i32 s42, 30
    s_call_b64 s[44:45], L_wait_c_0_52_0
    s_branch L_sequential_preLN__sliding_local_dilated__mixer_s_mlp__prompt_kernel_lwb_271
L_sequential_preLN__sliding_local_dilated__mixer_s_mlp__prompt_kernel_nopeek_273_d:
    s_mov_b64 exec, 1
    ds_read_b128 v[8:11], v4 offset:0
    s_waitcnt lgkmcnt(0)
    v_min3_u32 v8, v8, v9, v10
    v_min_u32 v8, v8, v11
    s_nop 0
    v_readfirstlane_b32 s52, v8
    s_mov_b64 exec, -1
    s_branch L_sequential_preLN__sliding_local_dilated__mixer_s_mlp__prompt_kernel_nopeek_273
L_sequential_preLN__sliding_local_dilated__mixer_s_mlp__prompt_kernel_lws_275:
    s_movk_i32 s42, 31
    s_call_b64 s[44:45], L_wait_c_0_52_0
    s_branch L_sequential_preLN__sliding_local_dilated__mixer_s_mlp__prompt_kernel_lwb_274
L_sequential_preLN__sliding_local_dilated__mixer_s_mlp__prompt_kernel_nopeek_276_d:
    s_mov_b64 exec, 1
    ds_read_b128 v[8:11], v4 offset:0
    s_waitcnt lgkmcnt(0)
    v_min3_u32 v8, v8, v9, v10
    v_min_u32 v8, v8, v11
    s_nop 0
    v_readfirstlane_b32 s52, v8
    s_mov_b64 exec, -1
    s_branch L_sequential_preLN__sliding_local_dilated__mixer_s_mlp__prompt_kernel_nopeek_276
L_sequential_preLN__sliding_local_dilated__mixer_s_mlp__prompt_kernel_lws_278:
    s_movk_i32 s42, 32
    s_call_b64 s[44:45], L_wait_c_0_52_0
    s_branch L_sequential_preLN__sliding_local_dilated__mixer_s_mlp__prompt_kernel_lwb_277
L_sequential_preLN__sliding_local_dilated__mixer_s_mlp__prompt_kernel_nopeek_279_d:
    s_mov_b64 exec, 1
    ds_read_b128 v[8:11], v4 offset:0
    s_waitcnt lgkmcnt(0)
    v_min3_u32 v8, v8, v9, v10
    v_min_u32 v8, v8, v11
    s_nop 0
    v_readfirstlane_b32 s52, v8
    s_mov_b64 exec, -1
    s_branch L_sequential_preLN__sliding_local_dilated__mixer_s_mlp__prompt_kernel_nopeek_279
L_sequential_preLN__sliding_local_dilated__mixer_s_mlp__prompt_kernel_lws_281:
    s_movk_i32 s42, 33
    s_call_b64 s[44:45], L_wait_c_0_52_0
    s_branch L_sequential_preLN__sliding_local_dilated__mixer_s_mlp__prompt_kernel_lwb_280
L_sequential_preLN__sliding_local_dilated__mixer_s_mlp__prompt_kernel_nopeek_282_d:
    s_mov_b64 exec, 1
    ds_read_b128 v[8:11], v4 offset:0
    s_waitcnt lgkmcnt(0)
    v_min3_u32 v8, v8, v9, v10
    v_min_u32 v8, v8, v11
    s_nop 0
    v_readfirstlane_b32 s52, v8
    s_mov_b64 exec, -1
    s_branch L_sequential_preLN__sliding_local_dilated__mixer_s_mlp__prompt_kernel_nopeek_282
L_sequential_preLN__sliding_local_dilated__mixer_s_mlp__prompt_kernel_lws_284:
    s_movk_i32 s42, 34
    s_call_b64 s[44:45], L_wait_c_0_52_0
    s_branch L_sequential_preLN__sliding_local_dilated__mixer_s_mlp__prompt_kernel_lwb_283
L_sequential_preLN__sliding_local_dilated__mixer_s_mlp__prompt_kernel_nopeek_285_d:
    s_mov_b64 exec, 1
    ds_read_b128 v[8:11], v4 offset:0
    s_waitcnt lgkmcnt(0)
    v_min3_u32 v8, v8, v9, v10
    v_min_u32 v8, v8, v11
    s_nop 0
    v_readfirstlane_b32 s52, v8
    s_mov_b64 exec, -1
    s_branch L_sequential_preLN__sliding_local_dilated__mixer_s_mlp__prompt_kernel_nopeek_285
L_sequential_preLN__sliding_local_dilated__mixer_s_mlp__prompt_kernel_lws_287:
    s_movk_i32 s42, 35
    s_call_b64 s[44:45], L_wait_c_0_52_0
    s_branch L_sequential_preLN__sliding_local_dilated__mixer_s_mlp__prompt_kernel_lwb_286
L_sequential_preLN__sliding_local_dilated__mixer_s_mlp__prompt_kernel_nopeek_288_d:
    s_mov_b64 exec, 1
    ds_read_b128 v[8:11], v4 offset:0
    s_waitcnt lgkmcnt(0)
    v_min3_u32 v8, v8, v9, v10
    v_min_u32 v8, v8, v11
    s_nop 0
    v_readfirstlane_b32 s52, v8
    s_mov_b64 exec, -1
    s_branch L_sequential_preLN__sliding_local_dilated__mixer_s_mlp__prompt_kernel_nopeek_288
L_sequential_preLN__sliding_local_dilated__mixer_s_mlp__prompt_kernel_lws_290:
    s_movk_i32 s42, 36
    s_call_b64 s[44:45], L_wait_c_0_52_0
    s_branch L_sequential_preLN__sliding_local_dilated__mixer_s_mlp__prompt_kernel_lwb_289
L_sequential_preLN__sliding_local_dilated__mixer_s_mlp__prompt_kernel_nopeek_291_d:
    s_mov_b64 exec, 1
    ds_read_b128 v[8:11], v4 offset:0
    s_waitcnt lgkmcnt(0)
    v_min3_u32 v8, v8, v9, v10
    v_min_u32 v8, v8, v11
    s_nop 0
    v_readfirstlane_b32 s52, v8
    s_mov_b64 exec, -1
    s_branch L_sequential_preLN__sliding_local_dilated__mixer_s_mlp__prompt_kernel_nopeek_291
L_sequential_preLN__sliding_local_dilated__mixer_s_mlp__prompt_kernel_lws_293:
    s_movk_i32 s42, 37
    s_call_b64 s[44:45], L_wait_c_0_52_0
    s_branch L_sequential_preLN__sliding_local_dilated__mixer_s_mlp__prompt_kernel_lwb_292
L_sequential_preLN__sliding_local_dilated__mixer_s_mlp__prompt_kernel_nopeek_294_d:
    s_mov_b64 exec, 1
    ds_read_b128 v[8:11], v4 offset:0
    s_waitcnt lgkmcnt(0)
    v_min3_u32 v8, v8, v9, v10
    v_min_u32 v8, v8, v11
    s_nop 0
    v_readfirstlane_b32 s52, v8
    s_mov_b64 exec, -1
    s_branch L_sequential_preLN__sliding_local_dilated__mixer_s_mlp__prompt_kernel_nopeek_294
L_sequential_preLN__sliding_local_dilated__mixer_s_mlp__prompt_kernel_lws_296:
    s_movk_i32 s42, 38
    s_call_b64 s[44:45], L_wait_c_0_52_0
    s_branch L_sequential_preLN__sliding_local_dilated__mixer_s_mlp__prompt_kernel_lwb_295
L_wait_c_0_52_0:
    s_mov_b32 s27, 0
    s_mov_b64 exec, 1
L_wait_c_0_52_0_t:
    ds_read_b128 v[8:11], v4 offset:0
    s_waitcnt lgkmcnt(0)
    v_min3_u32 v8, v8, v9, v10
    v_min_u32 v8, v8, v11
    s_nop 0
    v_readfirstlane_b32 s52, v8
    s_cmp_ge_u32 s52, s42
    s_cbranch_scc1 L_wait_c_0_52_0_o
    s_add_u32 s27, s27, 1
    s_cmp_lt_u32 s27, 0x40000
    s_cbranch_scc1 L_wait_c_0_52_0_t
L_wait_c_0_52_0_o:
    s_mov_b64 exec, -1
    s_setpc_b64 s[44:45]
L_wait_c_64_53_0:
    s_mov_b32 s27, 0
    s_mov_b64 exec, 1
L_wait_c_64_53_0_t:
    ds_read_b128 v[8:11], v4 offset:64
    s_waitcnt lgkmcnt(0)
    v_min3_u32 v8, v8, v9, v10
    v_min_u32 v8, v8, v11
    s_nop 0
    v_readfirstlane_b32 s53, v8
    s_cmp_ge_u32 s53, s42
    s_cbranch_scc1 L_wait_c_64_53_0_o
    s_add_u32 s27, s27, 1
    s_cmp_lt_u32 s27, 0x40000
    s_cbranch_scc1 L_wait_c_64_53_0_t
L_wait_c_64_53_0_o:
    s_mov_b64 exec, -1
    s_setpc_b64 s[44:45]
L_code_end:
    s_endpgm

.section .rodata,"a"
.p2align 6
.amdhsa_kernel sequential_preLN__sliding_local_dilated__mixer_s_mlp__prompt_kernel
  .amdhsa_next_free_vgpr 256
  .amdhsa_next_free_sgpr 80
  .amdhsa_accum_offset 160
  .amdhsa_group_segment_fixed_size 0
  .amdhsa_kernarg_size 88
  .amdhsa_user_sgpr_count 2
  .amdhsa_user_sgpr_kernarg_segment_ptr 1
  .amdhsa_system_sgpr_workgroup_id_x 1
.end_amdhsa_kernel
```
